```python
import torch

def _softmax(x, axis=-1):
    return torch.softmax(x, dim=axis)
def _gelu(x):
    return torch.nn.functional.gelu(x, approximate="tanh")
def _silu(x):
    return torch.nn.functional.silu(x)
def _sigmoid(x):
    return torch.sigmoid(x)
def _layernorm(x, axis=-1, eps=1e-5):
    m = x.mean(dim=axis, keepdim=True)
    v = x.var(dim=axis, keepdim=True, unbiased=False)
    return (x - m) / torch.sqrt(v + eps)
def _scatter_add(tgt, idx, src, axis=0):
    return tgt.clone().index_add_(axis, idx, src)
def _segment_sum(src, seg, n):
    out = torch.zeros((n,) + src.shape[1:], dtype=src.dtype)
    return out.index_add_(0, seg, src)
def _pad(x, pw):
    flat = tuple(v for pair in reversed(pw) for v in pair)
    return torch.nn.functional.pad(x, flat)

kernel_name = 'parallel_sum__sliding_block__glu_gated_glu__prompt'

def setup_inputs():

    _w = (lambda a: (lambda t: t.to(torch.bfloat16) if t.is_floating_point() else t)(torch.as_tensor(a)))
    def _A_setup():
        B, S, D = 1, 2048, 512
        return {
            "x": _w((lambda *s: torch.randn(*s, dtype=torch.bfloat16) * 0.05)(B, S, D)),
            "wqkv": _w((lambda *s: torch.randn(*s, dtype=torch.bfloat16) * 0.05)(D, 3 * D)),
            "wo": _w((lambda *s: torch.randn(*s, dtype=torch.bfloat16) * 0.05)(D, D)),
        }
    _A_in = _A_setup()

    def _B_setup():
        B, S, D, F = 1, 2048, 512, 1792
        return {
            "x": _w((lambda *s: torch.randn(*s, dtype=torch.bfloat16) * 0.05)(B, S, D)),
            "w_gate": _w((lambda *s: torch.randn(*s, dtype=torch.bfloat16) * 0.05)(D, F)),
            "w_up": _w((lambda *s: torch.randn(*s, dtype=torch.bfloat16) * 0.05)(D, F)),
            "w_down": _w((lambda *s: torch.randn(*s, dtype=torch.bfloat16) * 0.05)(F, D)),
        }
    _B_in = _B_setup()

    return {
        "A_x": _A_in["x"],
        "A_wqkv": _A_in["wqkv"],
        "A_wo": _A_in["wo"],
        "B_x": _B_in["x"],
        "B_w_gate": _B_in["w_gate"],
        "B_w_up": _B_in["w_up"],
        "B_w_down": _B_in["w_down"],
    }

def reference(A_x, A_wqkv, A_wo, B_x, B_w_gate, B_w_up, B_w_down):
    def _A_ref(x, wqkv, wo):
        B, S, D = x.shape
        H = 32; Dh = D // H; W = 256
        qkv = (lambda x, *d: x.permute(*d))((x @ wqkv).reshape(B, S, 3, H, Dh), 2, 0, 3, 1, 4)
        q, k, v = qkv[0], qkv[1], qkv[2]
        scores = torch.einsum("bhqd,bhkd->bhqk", q, k) * (Dh ** -0.5)
        idx = torch.arange(S)
        mask = (idx[:, None] - idx[None, :] >= 0) & (idx[:, None] - idx[None, :] < W)
        scores = torch.where(mask[None, None], scores, -1e9)
        p = _softmax(scores, axis=-1)
        o = torch.einsum("bhqk,bhkd->bhqd", p, v)
        return (lambda x, *d: x.permute(*d))(o, 0, 2, 1, 3).reshape(B, S, D) @ wo

    def _B_ref(x, w_gate, w_up, w_down):
        g = torch.einsum("bsd,df->bsf", x, w_gate)
        u = torch.einsum("bsd,df->bsf", x, w_up)
        h = _sigmoid(g) * u
        return torch.einsum("bsf,fd->bsd", h, w_down)

    x = A_x
    xn = _layernorm(x, axis=-1)
    return x + _A_ref(xn, A_wqkv, A_wo) + _B_ref(xn, B_w_gate, B_w_up, B_w_down)
```

```asm
; @launch kernel=k1_kernel grid=(256,1,1) block=(256,1,1) lds=163840
; @launch kernel=k2_kernel grid=(256,1,1) block=(512,1,1) lds=69632
.amdgcn_target "amdgcn-amd-amdhsa--gfx950"
.text
.globl k1_kernel
.p2align 8
.type k1_kernel,@function
k1_kernel:
  s_cmp_ge_u32 s2, 256
  s_cbranch_scc1 K1_END
s_nop 0
  s_load_dwordx16 s[64:79], s[0:1], 0
  s_load_dwordx4 s[80:83], s[0:1], 64
  s_and_b32 s3, s2, 7
  s_lshr_b32 s4, s2, 3
  s_and_b32 s5, s3, 1
  s_lshl_b32 s5, s5, 3
  s_and_b32 s6, s4, 7
  s_add_u32 s58, s5, s6
  s_lshr_b32 s59, s3, 1
  s_lshr_b32 s60, s4, 3
  v_and_b32_e32 v160, 63, v0
  s_getpc_b64 s[90:91]
K1_PF:
  v_lshrrev_b32_e32 v255, 6, v0
  s_lshl_b32 s92, s4, 2
  v_add_u32_e64 v255, s92, v255
  v_min_u32 v255, (CODE_END-K1_PF)/1024-1, v255
  v_lshlrev_b32_e64 v255, 10, v255
  v_lshl_add_u32 v255, v160, 4, v255
  global_load_dwordx4 v[248:251], v255, s[90:91]
  v_lshrrev_b32_e32 v161, 6, v0
  s_nop 0
  v_readfirstlane_b32 s57, v161
s_nop 0
  s_mov_b32 s46, 0xffff0000
  s_mov_b32 s44, 0x3b000000
  s_lshr_b32 s45, s57, 1
  s_and_b32 s47, s57, 1
  s_lshl_b32 s42, s57, 11
  s_lshl_b32 s41, s58, 17
  s_lshl_b32 s63, s45, 11
s_nop 0
  s_mov_b32 s55, 0x3f803f80
  v_lshlrev_b32_e32 v10, 4, v160
  v_lshrrev_b32_e32 v166, 3, v160
  v_lshrrev_b32_e32 v164, 4, v160
  v_and_b32_e32 v165, 7, v160
  s_lshl_b32 s43, s57, 4
  v_add_u32_e32 v166, s43, v166
  v_add_u32_e32 v161, 0, v164
  v_and_b32_e32 v161, 7, v161
  v_xor_b32_e32 v161, v165, v161
  v_lshlrev_b32_e32 v161, 4, v161
  v_lshl_add_u32 v5, v166, 10, v161
  v_add_u32_e32 v161, 4, v164
  v_and_b32_e32 v161, 7, v161
  v_xor_b32_e32 v161, v165, v161
  v_lshlrev_b32_e32 v161, 4, v161
  v_lshl_add_u32 v6, v166, 10, v161
  v_add_u32_e32 v6, 7168, v6
  v_lshrrev_b32_e32 v161, 2, v160
  v_xor_b32_e32 v161, v161, v164
  v_and_b32_e32 v161, 1, v161
  v_lshlrev_b32_e32 v161, 6, v161
  v_and_b32_e64 v162, 3, v160
  v_lshl_add_u32 v161, v162, 4, v161
  s_mov_b32 s43, 3584
  v_mul_lo_u32 v162, v166, s43
  v_add_u32_e64 v1, v162, v161
  v_add_u32_e32 v2, 27648, v1
  s_mov_b32 s43, 3072
  v_mul_lo_u32 v162, v166, s43
  v_add_u32_e64 v3, v162, v161
  v_add_u32_e32 v4, 23552, v3
  v_and_b32_e32 v167, 31, v160
  v_lshrrev_b32_e32 v168, 5, v160
  v_lshrrev_b32_e32 v161, 1, v167
  v_and_b32_e32 v161, 7, v161
  s_lshl_b32 s43, s45, 13
  v_lshlrev_b32_e32 v162, 7, v167
  v_add_u32_e32 v162, s43, v162
  v_add_u32_e32 v163, 0, v168
  v_xor_b32_e64 v163, v163, v161
  v_lshl_add_u32 v60, v163, 4, v162
  v_add_u32_e32 v163, 2, v168
  v_xor_b32_e32 v163, v163, v161
  v_lshl_add_u32 v61, v163, 4, v162
  v_add_u32_e32 v163, 4, v168
  v_xor_b32_e32 v163, v163, v161
  v_lshl_add_u32 v62, v163, 4, v162
  v_add_u32_e32 v163, 6, v168
  v_xor_b32_e32 v163, v163, v161
  v_lshl_add_u32 v63, v163, 4, v162
  s_cmp_eq_u32 s47, 1
  s_cselect_b64 vcc, -1, 0
  v_cndmask_b32_e32 v72, v60, v61, vcc
  v_cndmask_b32_e32 v73, v62, v63, vcc
  v_add_u32_e32 v64, 65536, v60
  v_add_u32_e32 v65, 65536, v61
  v_add_u32_e32 v66, 65536, v62
  v_add_u32_e32 v67, 65536, v63
  v_add_u32_e32 v74, 65536, v72
  v_add_u32_e32 v75, 65536, v73
  v_add_u32_e32 v68, 131072, v60
  v_add_u32_e32 v69, 131072, v61
  v_add_u32_e32 v70, 131072, v62
  v_add_u32_e32 v71, 131072, v63
  v_add_u32_e32 v76, 131072, v72
  v_add_u32_e32 v77, 131072, v73
  v_bfe_u32 v161, v160, 2, 2
  v_lshl_add_u32 v162, v168, 3, v161
  v_lshlrev_b32_e32 v162, 7, v162
  v_lshrrev_b32_e32 v163, 1, v161
  v_xor_b32_e64 v163, s47, v163
  v_lshl_add_u32 v162, v163, 6, v162
  v_and_b32_e64 v163, 1, v164
  v_lshl_add_u32 v162, v163, 5, v162
  v_and_b32_e64 v163, 3, v160
  v_lshl_add_u32 v7, v163, 3, v162
  v_add_u32_e32 v8, 0x10000, v7
  v_add_u32_e32 v9, 0x20000, v7
  v_and_b32_e32 v161, 15, v160
  v_lshlrev_b32_e32 v161, 4, v161
  v_lshl_add_u32 v161, v168, 8, v161
  v_and_b32_e64 v163, 1, v164
  v_lshl_add_u32 v11, v163, 16, v161
  s_lshl_b32 s43, s45, 6
  v_add_u32_e32 v161, s43, v167
  v_lshlrev_b32_e32 v162, 5, v161
  v_add_u32_e32 v40, 0, v162
  v_lshlrev_b32_e64 v162, 2, v161
  v_add_u32_e32 v43, 7168, v162
  s_lshl_b32 s43, s45, 8
  v_lshlrev_b32_e32 v162, 4, v168
  v_add_u32_e64 v162, s43, v162
  v_add_u32_e32 v44, 7168, v162
  s_lshl_b32 s43, s47, 8
  v_lshlrev_b32_e32 v162, 3, v167
  v_add_u32_e32 v42, s43, v162
  s_lshl_b32 s43, s45, 2
  v_add_u32_e32 v41, s43, v42
  v_lshrrev_b32_e32 v161, 2, v160
  v_xor_b32_e32 v161, v161, v164
  v_and_b32_e32 v161, 1, v161
  v_and_b32_e32 v162, 3, v160
  v_or_b32_e32 v161, v161, v162
  v_cmp_eq_u32_e64 vcc, 0, v161
  v_mov_b32_e32 v162, 0x3f803f80
s_nop 0
  v_cndmask_b32_e32 v12, 0, v162, vcc
  v_mov_b32_e32 v13, v12
  v_mov_b32_e32 v14, v12
  v_mov_b32_e32 v15, v12
  v_cmp_eq_u32_e32 vcc, 0, v168
  v_mov_b32_e32 v162, -1.0
s_nop 0
  v_cndmask_b32_e32 v45, 0, v162, vcc
  v_and_b32_e32 v161, 15, v160
  v_lshlrev_b32_e64 v161, 4, v161
  v_lshl_add_u32 v161, v164, 10, v161
  s_lshl_b32 s43, s57, 8
  v_add_u32_e32 v47, s43, v161
  v_bfe_u32 v161, v160, 2, 2
  v_lshl_add_u32 v161, v168, 2, v161
  v_lshlrev_b32_e32 v161, 8, v161
  v_and_b32_e32 v163, 1, v164
  v_lshl_add_u32 v161, v163, 5, v161
  v_and_b32_e64 v163, 3, v160
  v_lshl_add_u32 v161, v163, 3, v161
  s_lshl_b32 s43, s57, 12
s_nop 0
  s_add_u32 s43, s43, 8192
  v_add_u32_e32 v46, s43, v161
  s_waitcnt lgkmcnt(0)
  s_mov_b32 s8, s64
s_nop 0
  s_and_b32 s9, s65, 0xffff
  s_mov_b32 s10, 2097152
  s_mov_b32 s11, 0x20000
  s_mov_b32 s12, s66
s_nop 0
  s_and_b32 s13, s67, 0xffff
  s_mov_b32 s14, 1572864
  s_mov_b32 s15, 0x20000
  s_mov_b32 s16, s72
s_nop 0
  s_and_b32 s17, s73, 0xffff
  s_mov_b32 s18, 1835008
  s_mov_b32 s19, 0x20000
  s_mov_b32 s20, s74
s_nop 0
  s_and_b32 s21, s75, 0xffff
  s_mov_b32 s22, 1835008
  s_mov_b32 s23, 0x20000
  s_mov_b32 s24, s82
s_nop 0
  s_and_b32 s25, s83, 0xffff
  s_mov_b32 s26, 20971520
  s_mov_b32 s27, 0x20000
  s_mov_b32 s28, s76
s_nop 0
  s_and_b32 s29, s77, 0xffff
  s_mov_b32 s30, 1835008
  s_mov_b32 s31, 0x20000
  s_mov_b32 s32, s68
s_nop 0
  s_and_b32 s33, s69, 0xffff
  s_mov_b32 s34, 524288
  s_mov_b32 s35, 0x20000
  s_lshl_b32 s61, s58, 2
  s_lshl_b32 s43, s45, 1
  s_add_u32 s61, s61, s43
  s_lshl_b32 s94, s2, 11
  s_lshl_b32 s95, s57, 8
  s_add_u32 s94, s94, s95
  s_add_u32 s94, s94, 19922944
  s_cmp_ge_u32 s2, 32
  s_cbranch_scc1 K1_NOFLAG
  s_lshl_b32 s43, s2, 7
s_nop 0
  s_add_u32 s43, s43, 18874368
  v_mov_b32_e64 v160, 0
  buffer_store_dword v160, v160, s[24:27], s43 offen sc1
K1_NOFLAG:
  s_cmp_eq_u32 s60, 3
  s_cbranch_scc1 K1_TYPEB
  s_mul_i32 s84, s59, 3
  s_add_u32 s84, s84, s60
  s_lshl_b32 s85, s84, 1
  s_add_u32 s86, s85, 1
  s_lshl_b32 s36, s85, 7
  s_mov_b32 s37, s36
  s_lshl_b32 s38, s86, 7
  s_mov_b32 s39, s38
  s_lshl_b32 s40, s84, 7
  s_lshl_b32 s43, s85, 1
  s_add_u32 s43, s43, s47
  s_lshl_b32 s43, s43, 1
  s_mul_i32 s62, s61, 144
  s_add_u32 s43, s43, s62
  s_lshl_b32 s43, s43, 10
  s_add_u32 s48, s43, 6291456
  s_add_u32 s49, s48, 147456
  s_lshl_b32 s43, s86, 1
  s_add_u32 s43, s43, s47
  s_lshl_b32 s43, s43, 1
s_nop 0
  s_mul_i32 s62, s61, 144
  s_add_u32 s43, s43, s62
  s_lshl_b32 s43, s43, 10
  s_add_u32 s50, s43, 6291456
  s_add_u32 s51, s50, 147456
  s_lshl_b32 s43, s84, 1
  s_add_u32 s43, s43, s47
  s_lshl_b32 s43, s43, 17
  s_lshl_b32 s62, s61, 10
  s_add_u32 s52, s43, s62
s_nop 0
  s_add_u32 s53, s52, 65536
  s_cmp_lt_u32 s84, 8
s_nop 0
  s_cselect_b32 s56, 0x3eb8aa3b, 1.0
  s_add_u32 s43, s36, 0
s_nop 0
  s_add_u32 m0, s42, 155648
s_nop 0
s_nop 0
  buffer_load_dwordx4 v1, s[16:19], s43 offen lds
  buffer_load_dwordx4 v2, s[16:19], s43 offen offset:1024 lds
  s_add_u32 s43, s41, 0
  s_add_u32 m0, s42, 0
s_nop 0
s_nop 0
  buffer_load_dwordx4 v5, s[8:11], s43 offen lds
  buffer_load_dwordx4 v6, s[8:11], s43 offen offset:1024 lds
  s_add_u32 s43, s41, 65536
  s_add_u32 m0, s42, 8192
s_nop 0
s_nop 0
  buffer_load_dwordx4 v5, s[8:11], s43 offen lds
  buffer_load_dwordx4 v6, s[8:11], s43 offen offset:1024 lds
  s_add_u32 s43, s37, 0
s_nop 0
  s_add_u32 m0, s42, 147456
s_nop 0
s_nop 0
  buffer_load_dwordx4 v1, s[20:23], s43 offen lds
  buffer_load_dwordx4 v2, s[20:23], s43 offen offset:1024 lds
  s_add_u32 s43, s36, 229376
  s_add_u32 m0, s42, 139264
s_nop 0
s_nop 0
  buffer_load_dwordx4 v1, s[16:19], s43 offen lds
  buffer_load_dwordx4 v2, s[16:19], s43 offen offset:1024 lds
  s_add_u32 s43, s41, 128
  s_add_u32 m0, s42, 16384
s_nop 0
s_nop 0
  buffer_load_dwordx4 v5, s[8:11], s43 offen lds
  buffer_load_dwordx4 v6, s[8:11], s43 offen offset:1024 lds
  s_add_u32 s43, s41, 65664
  s_add_u32 m0, s42, 24576
s_nop 0
s_nop 0
  buffer_load_dwordx4 v5, s[8:11], s43 offen lds
  buffer_load_dwordx4 v6, s[8:11], s43 offen offset:1024 lds
  s_add_u32 s43, s37, 229376
  s_add_u32 m0, s42, 131072
s_nop 0
s_nop 0
  buffer_load_dwordx4 v1, s[20:23], s43 offen lds
  buffer_load_dwordx4 v2, s[20:23], s43 offen offset:1024 lds
  s_add_u32 s43, s36, 458752
  s_add_u32 m0, s42, 122880
s_nop 0
s_nop 0
  buffer_load_dwordx4 v1, s[16:19], s43 offen lds
  buffer_load_dwordx4 v2, s[16:19], s43 offen offset:1024 lds
  v_lshrrev_b32_e32 v240, 4, v10
  v_lshrrev_b32_e32 v241, 3, v240
  v_and_b32_e32 v242, 7, v240
  v_lshlrev_b32_e32 v241, 10, v241
  v_lshl_add_u32 v241, v242, 7, v241
  s_lshl_b32 s43, s60, 15
  s_lshl_b32 s62, s57, 13
  s_add_u32 s43, s43, s62
  s_add_u32 s43, s43, s41
  buffer_load_dword v244, v241, s[8:11], s43 offen
  s_and_b32 s62, s58, 7
  s_lshl_b32 s62, s62, 6
  v_add_u32_e32 v242, s62, v240
  s_cmp_lg_u32 s57, 0
  s_cbranch_scc1 K1A_tch1
s_nop 0
  s_mov_b32 s43, 3584
  v_mul_lo_u32 v243, v242, s43
  buffer_load_dword v245, v243, s[20:23], s37 offen
K1A_tch1:
  s_cmp_lg_u32 s57, 1
  s_cbranch_scc1 K1A_tch2
  s_mov_b32 s43, 3584
  v_mul_lo_u32 v243, v242, s43
  buffer_load_dword v245, v243, s[16:19], s38 offen
K1A_tch2:
  s_cmp_lg_u32 s57, 2
  s_cbranch_scc1 K1A_tch3
  s_mov_b32 s43, 3584
  v_mul_lo_u32 v243, v242, s43
  buffer_load_dword v245, v243, s[20:23], s39 offen
K1A_tch3:
  s_cmp_lg_u32 s57, 3
  s_cbranch_scc1 K1A_tch4
  s_mov_b32 s43, 3072
  v_mul_lo_u32 v243, v242, s43
  buffer_load_dword v245, v243, s[12:15], s40 offen
K1A_tch4:
  v_mov_b32_e32 v80, 0
  v_mov_b32_e32 v81, 0
  v_mov_b32_e32 v82, 0
  v_mov_b32_e32 v83, 0
  v_mov_b32_e32 v84, 0
  v_mov_b32_e32 v85, 0
  v_mov_b32_e32 v86, 0
  v_mov_b32_e32 v87, 0
s_waitcnt vmcnt(11)
  s_barrier
  ds_read_b128 a[0:3], v60 offset:0
  ds_read_b128 a[128:131], v60 offset:4096
  ds_read_b64_tr_b16 v[112:113], v9 offset:24576
  ds_read_b64_tr_b16 v[114:115], v9 offset:25088
  ds_read_b64_tr_b16 v[116:117], v9 offset:16384
  ds_read_b64_tr_b16 v[118:119], v9 offset:16896
  ds_read_b128 a[4:7], v61 offset:0
  ds_read_b128 a[132:135], v61 offset:4096
  ds_read_b64_tr_b16 v[120:121], v9 offset:26624
  ds_read_b64_tr_b16 v[122:123], v9 offset:27136
  ds_read_b64_tr_b16 v[124:125], v9 offset:18432
  ds_read_b64_tr_b16 v[126:127], v9 offset:18944
  ds_read_b128 a[8:11], v62 offset:0
  ds_read_b128 a[136:139], v62 offset:4096
  ds_read_b64_tr_b16 v[128:129], v9 offset:28672
  ds_read_b64_tr_b16 v[130:131], v9 offset:29184
  ds_read_b64_tr_b16 v[132:133], v9 offset:20480
  ds_read_b64_tr_b16 v[134:135], v9 offset:20992
  ds_read_b128 v[92:95], v72 offset:0
  ds_read_b128 v[96:99], v72 offset:4096
s_waitcnt lgkmcnt(15)
s_nop 0
  v_mfma_f32_32x32x16_bf16 v[160:175], v[112:115], a[0:3], 0
  s_add_u32 s43, s41, 256
  s_add_u32 m0, s42, 32768
s_nop 0
s_nop 0
  buffer_load_dwordx4 v5, s[8:11], s43 offen lds
  buffer_load_dwordx4 v6, s[8:11], s43 offen offset:1024 lds
  ds_read_b128 a[12:15], v63 offset:0
  ds_read_b128 a[140:143], v63 offset:4096
  ds_read_b64_tr_b16 v[136:137], v9 offset:30720
  ds_read_b64_tr_b16 v[138:139], v9 offset:31232
  v_mfma_f32_32x32x16_bf16 v[176:191], v[112:115], a[128:131], 0
  v_add_u32_e64 v56, s63, v9
  ds_read_b64_tr_b16 v[152:153], v56 offset:24576
  ds_read_b64_tr_b16 v[154:155], v56 offset:25088
  ds_read_b64_tr_b16 v[156:157], v56 offset:28672
  ds_read_b64_tr_b16 v[158:159], v56 offset:29184
s_waitcnt lgkmcnt(15)
s_nop 0
  v_mfma_f32_32x32x16_bf16 v[192:207], v[116:119], a[0:3], 0
  s_add_u32 s43, s41, 65792
  s_add_u32 m0, s42, 40960
s_nop 0
s_nop 0
  buffer_load_dwordx4 v5, s[8:11], s43 offen lds
  buffer_load_dwordx4 v6, s[8:11], s43 offen offset:1024 lds
  ds_read_b64_tr_b16 v[140:141], v9 offset:22528
  v_mfma_f32_32x32x16_bf16 v[208:223], v[116:119], a[128:131], 0
  ds_read_b64_tr_b16 v[142:143], v9 offset:23040
s_waitcnt vmcnt(7)
  s_barrier
  v_mfma_f32_32x32x16_bf16 v[160:175], v[120:123], a[4:7], v[160:175]
  s_add_u32 s43, s37, 458752
  s_add_u32 m0, s42, 114688
s_nop 0
s_nop 0
  buffer_load_dwordx4 v1, s[20:23], s43 offen lds
  buffer_load_dwordx4 v2, s[20:23], s43 offen offset:1024 lds
  ds_read_b128 a[16:19], v60 offset:16384
  ds_read_b128 a[144:147], v60 offset:20480
  v_mfma_f32_32x32x16_bf16 v[176:191], v[120:123], a[132:135], v[176:191]
  ds_read_b64_tr_b16 v[144:145], v9 offset:8192
  ds_read_b64_tr_b16 v[146:147], v9 offset:8704
s_waitcnt lgkmcnt(8)
s_nop 0
  v_mfma_f32_16x16x32_bf16 v[24:27], v[12:15], v[152:155], 0
  v_dot2c_f32_bf16 v80, s55, v92
  v_dot2c_f32_bf16 v82, v92, v92
  v_dot2c_f32_bf16 v84, s55, v96
  v_dot2c_f32_bf16 v86, v96, v96
  v_dot2c_f32_bf16 v81, s55, v93
  v_dot2c_f32_bf16 v83, v93, v93
  v_dot2c_f32_bf16 v85, s55, v97
  v_dot2c_f32_bf16 v87, v97, v97
  v_dot2c_f32_bf16 v80, s55, v94
  v_dot2c_f32_bf16 v82, v94, v94
  v_dot2c_f32_bf16 v84, s55, v98
  v_dot2c_f32_bf16 v86, v98, v98
  v_dot2c_f32_bf16 v81, s55, v95
  v_dot2c_f32_bf16 v83, v95, v95
  v_dot2c_f32_bf16 v85, s55, v99
  v_dot2c_f32_bf16 v87, v99, v99
  v_mfma_f32_32x32x16_bf16 v[192:207], v[124:127], a[4:7], v[192:207]
  s_add_u32 s43, s36, 688128
  s_add_u32 m0, s42, 106496
s_nop 0
s_nop 0
  buffer_load_dwordx4 v1, s[16:19], s43 offen lds
  buffer_load_dwordx4 v2, s[16:19], s43 offen offset:1024 lds
  ds_read_b64_tr_b16 v[148:149], v9 offset:0
  v_mfma_f32_32x32x16_bf16 v[208:223], v[124:127], a[132:135], v[208:223]
  ds_read_b64_tr_b16 v[150:151], v9 offset:512
s_waitcnt lgkmcnt(8)
s_nop 0
  v_mfma_f32_16x16x32_bf16 v[24:27], v[12:15], v[156:159], v[24:27]
  ds_read_b128 v[100:103], v73 offset:0
  ds_read_b128 v[104:107], v73 offset:4096
  v_mfma_f32_32x32x16_bf16 v[160:175], v[128:131], a[8:11], v[160:175]
  s_add_u32 s43, s41, 384
  s_add_u32 m0, s42, 49152
s_nop 0
s_nop 0
  buffer_load_dwordx4 v5, s[8:11], s43 offen lds
  buffer_load_dwordx4 v6, s[8:11], s43 offen offset:1024 lds
  ds_read_b128 a[20:23], v61 offset:16384
  ds_read_b128 a[148:151], v61 offset:20480
  ds_read_b64_tr_b16 v[112:113], v9 offset:10240
  ds_read_b64_tr_b16 v[114:115], v9 offset:10752
  v_mfma_f32_32x32x16_bf16 v[176:191], v[128:131], a[136:139], v[176:191]
  v_add_u32_e64 v56, s63, v9
  ds_read_b64_tr_b16 v[152:153], v56 offset:16384
  ds_read_b64_tr_b16 v[154:155], v56 offset:16896
  ds_read_b64_tr_b16 v[156:157], v56 offset:20480
  ds_read_b64_tr_b16 v[158:159], v56 offset:20992
  v_mfma_f32_32x32x16_bf16 v[192:207], v[132:135], a[8:11], v[192:207]
  s_add_u32 s43, s41, 65920
  s_add_u32 m0, s42, 57344
s_nop 0
s_nop 0
  buffer_load_dwordx4 v5, s[8:11], s43 offen lds
  buffer_load_dwordx4 v6, s[8:11], s43 offen offset:1024 lds
  ds_read_b64_tr_b16 v[116:117], v9 offset:2048
  v_mfma_f32_32x32x16_bf16 v[208:223], v[132:135], a[136:139], v[208:223]
  ds_read_b64_tr_b16 v[118:119], v9 offset:2560
  v_mfma_f32_32x32x16_bf16 v[160:175], v[136:139], a[12:15], v[160:175]
  s_add_u32 s43, s37, 688128
  s_add_u32 m0, s42, 98304
s_nop 0
s_nop 0
  buffer_load_dwordx4 v1, s[20:23], s43 offen lds
  buffer_load_dwordx4 v2, s[20:23], s43 offen offset:1024 lds
  ds_read_b128 a[24:27], v62 offset:16384
  ds_read_b128 a[152:155], v62 offset:20480
  v_mfma_f32_32x32x16_bf16 v[176:191], v[136:139], a[140:143], v[176:191]
  ds_read_b64_tr_b16 v[120:121], v9 offset:12288
  ds_read_b64_tr_b16 v[122:123], v9 offset:12800
s_waitcnt lgkmcnt(8)
s_nop 0
  v_mfma_f32_16x16x32_bf16 v[108:111], v[12:15], v[152:155], 0
  v_dot2c_f32_bf16 v80, s55, v100
  v_dot2c_f32_bf16 v82, v100, v100
  v_dot2c_f32_bf16 v84, s55, v104
  v_dot2c_f32_bf16 v86, v104, v104
  v_dot2c_f32_bf16 v81, s55, v101
  v_dot2c_f32_bf16 v83, v101, v101
  v_dot2c_f32_bf16 v85, s55, v105
  v_dot2c_f32_bf16 v87, v105, v105
  v_dot2c_f32_bf16 v80, s55, v102
  v_dot2c_f32_bf16 v82, v102, v102
  v_dot2c_f32_bf16 v84, s55, v106
  v_dot2c_f32_bf16 v86, v106, v106
  v_dot2c_f32_bf16 v81, s55, v103
  v_dot2c_f32_bf16 v83, v103, v103
  v_dot2c_f32_bf16 v85, s55, v107
  v_dot2c_f32_bf16 v87, v107, v107
  v_mfma_f32_32x32x16_bf16 v[192:207], v[140:143], a[12:15], v[192:207]
  s_add_u32 s43, s36, 917504
  s_add_u32 m0, s42, 90112
s_nop 0
s_nop 0
  buffer_load_dwordx4 v1, s[16:19], s43 offen lds
  buffer_load_dwordx4 v2, s[16:19], s43 offen offset:1024 lds
  ds_read_b64_tr_b16 v[124:125], v9 offset:4096
  v_mfma_f32_32x32x16_bf16 v[208:223], v[140:143], a[140:143], v[208:223]
  ds_read_b64_tr_b16 v[126:127], v9 offset:4608
s_waitcnt lgkmcnt(8)
s_nop 0
  v_mfma_f32_16x16x32_bf16 v[108:111], v[12:15], v[156:159], v[108:111]
  ds_read_b128 v[92:95], v72 offset:16384
  ds_read_b128 v[96:99], v72 offset:20480
  v_mfma_f32_32x32x16_bf16 v[160:175], v[144:147], a[16:19], v[160:175]
  s_add_u32 s43, s41, 512
  s_add_u32 m0, s42, 65536
s_nop 0
s_nop 0
  buffer_load_dwordx4 v5, s[8:11], s43 offen lds
  buffer_load_dwordx4 v6, s[8:11], s43 offen offset:1024 lds
  ds_read_b128 a[28:31], v63 offset:16384
  ds_read_b128 a[156:159], v63 offset:20480
  ds_read_b64_tr_b16 v[128:129], v9 offset:14336
  ds_read_b64_tr_b16 v[130:131], v9 offset:14848
  v_mfma_f32_32x32x16_bf16 v[176:191], v[144:147], a[144:147], v[176:191]
  v_add_u32_e64 v56, s63, v9
  ds_read_b64_tr_b16 v[152:153], v56 offset:8192
  ds_read_b64_tr_b16 v[154:155], v56 offset:8704
  ds_read_b64_tr_b16 v[156:157], v56 offset:12288
  ds_read_b64_tr_b16 v[158:159], v56 offset:12800
  v_mfma_f32_32x32x16_bf16 v[192:207], v[148:151], a[16:19], v[192:207]
  s_add_u32 s43, s41, 66048
  s_add_u32 m0, s42, 73728
s_nop 0
s_nop 0
  buffer_load_dwordx4 v5, s[8:11], s43 offen lds
  buffer_load_dwordx4 v6, s[8:11], s43 offen offset:1024 lds
  ds_read_b64_tr_b16 v[132:133], v9 offset:6144
  v_mfma_f32_32x32x16_bf16 v[208:223], v[148:151], a[144:147], v[208:223]
  ds_read_b64_tr_b16 v[134:135], v9 offset:6656
s_waitcnt vmcnt(14)
  s_barrier
  v_mfma_f32_32x32x16_bf16 v[160:175], v[112:115], a[20:23], v[160:175]
  s_add_u32 s43, s37, 917504
  s_add_u32 m0, s42, 81920
s_nop 0
s_nop 0
  buffer_load_dwordx4 v1, s[20:23], s43 offen lds
  buffer_load_dwordx4 v2, s[20:23], s43 offen offset:1024 lds
  ds_read_b128 a[32:35], v60 offset:32768
  ds_read_b128 a[160:163], v60 offset:36864
  v_mfma_f32_32x32x16_bf16 v[176:191], v[112:115], a[148:151], v[176:191]
  ds_read_b64_tr_b16 v[136:137], v8 offset:57344
  ds_read_b64_tr_b16 v[138:139], v8 offset:57856
s_waitcnt lgkmcnt(8)
s_nop 0
  v_mfma_f32_16x16x32_bf16 v[24:27], v[12:15], v[152:155], v[24:27]
  v_dot2c_f32_bf16 v80, s55, v92
  v_dot2c_f32_bf16 v82, v92, v92
  v_dot2c_f32_bf16 v84, s55, v96
  v_dot2c_f32_bf16 v86, v96, v96
  v_dot2c_f32_bf16 v81, s55, v93
  v_dot2c_f32_bf16 v83, v93, v93
  v_dot2c_f32_bf16 v85, s55, v97
  v_dot2c_f32_bf16 v87, v97, v97
  v_dot2c_f32_bf16 v80, s55, v94
  v_dot2c_f32_bf16 v82, v94, v94
  v_dot2c_f32_bf16 v84, s55, v98
  v_dot2c_f32_bf16 v86, v98, v98
  v_dot2c_f32_bf16 v81, s55, v95
  v_dot2c_f32_bf16 v83, v95, v95
  v_dot2c_f32_bf16 v85, s55, v99
  v_dot2c_f32_bf16 v87, v99, v99
  v_mfma_f32_32x32x16_bf16 v[192:207], v[116:119], a[20:23], v[192:207]
  s_add_u32 s43, s36, 1146880
  s_add_u32 m0, s42, 155648
s_nop 0
s_nop 0
  buffer_load_dwordx4 v1, s[16:19], s43 offen lds
  buffer_load_dwordx4 v2, s[16:19], s43 offen offset:1024 lds
  ds_read_b64_tr_b16 v[140:141], v8 offset:49152
  v_mfma_f32_32x32x16_bf16 v[208:223], v[116:119], a[148:151], v[208:223]
  ds_read_b64_tr_b16 v[142:143], v8 offset:49664
s_waitcnt lgkmcnt(8)
s_nop 0
  v_mfma_f32_16x16x32_bf16 v[24:27], v[12:15], v[156:159], v[24:27]
  ds_read_b128 v[100:103], v73 offset:16384
  ds_read_b128 v[104:107], v73 offset:20480
  v_mfma_f32_32x32x16_bf16 v[160:175], v[120:123], a[24:27], v[160:175]
  ds_read_b128 a[36:39], v61 offset:32768
  ds_read_b128 a[164:167], v61 offset:36864
  ds_read_b64_tr_b16 v[144:145], v8 offset:59392
  ds_read_b64_tr_b16 v[146:147], v8 offset:59904
  v_mfma_f32_32x32x16_bf16 v[176:191], v[120:123], a[152:155], v[176:191]
  v_add_u32_e64 v56, s63, v9
  ds_read_b64_tr_b16 v[152:153], v56 offset:0
  ds_read_b64_tr_b16 v[154:155], v56 offset:512
  ds_read_b64_tr_b16 v[156:157], v56 offset:4096
  ds_read_b64_tr_b16 v[158:159], v56 offset:4608
  v_mfma_f32_32x32x16_bf16 v[192:207], v[124:127], a[24:27], v[192:207]
  ds_read_b64_tr_b16 v[148:149], v8 offset:51200
  v_mfma_f32_32x32x16_bf16 v[208:223], v[124:127], a[152:155], v[208:223]
  ds_read_b64_tr_b16 v[150:151], v8 offset:51712
  v_mfma_f32_32x32x16_bf16 v[160:175], v[128:131], a[28:31], v[160:175]
  ds_read_b128 a[40:43], v62 offset:32768
  ds_read_b128 a[168:171], v62 offset:36864
  v_mfma_f32_32x32x16_bf16 v[176:191], v[128:131], a[156:159], v[176:191]
  ds_read_b64_tr_b16 v[112:113], v8 offset:61440
  ds_read_b64_tr_b16 v[114:115], v8 offset:61952
s_waitcnt lgkmcnt(8)
s_nop 0
  v_mfma_f32_16x16x32_bf16 v[108:111], v[12:15], v[152:155], v[108:111]
  v_dot2c_f32_bf16 v80, s55, v100
  v_dot2c_f32_bf16 v82, v100, v100
  v_dot2c_f32_bf16 v84, s55, v104
  v_dot2c_f32_bf16 v86, v104, v104
  v_dot2c_f32_bf16 v81, s55, v101
  v_dot2c_f32_bf16 v83, v101, v101
  v_dot2c_f32_bf16 v85, s55, v105
  v_dot2c_f32_bf16 v87, v105, v105
  v_dot2c_f32_bf16 v80, s55, v102
  v_dot2c_f32_bf16 v82, v102, v102
  v_dot2c_f32_bf16 v84, s55, v106
  v_dot2c_f32_bf16 v86, v106, v106
  v_dot2c_f32_bf16 v81, s55, v103
  v_dot2c_f32_bf16 v83, v103, v103
  v_dot2c_f32_bf16 v85, s55, v107
  v_dot2c_f32_bf16 v87, v107, v107
  v_mfma_f32_32x32x16_bf16 v[192:207], v[132:135], a[28:31], v[192:207]
  ds_read_b64_tr_b16 v[116:117], v8 offset:53248
  v_mfma_f32_32x32x16_bf16 v[208:223], v[132:135], a[156:159], v[208:223]
  ds_read_b64_tr_b16 v[118:119], v8 offset:53760
s_waitcnt lgkmcnt(8)
s_nop 0
  v_mfma_f32_16x16x32_bf16 v[108:111], v[12:15], v[156:159], v[108:111]
  ds_read_b128 v[92:95], v72 offset:32768
  ds_read_b128 v[96:99], v72 offset:36864
  v_mfma_f32_32x32x16_bf16 v[160:175], v[136:139], a[32:35], v[160:175]
  ds_read_b128 a[44:47], v63 offset:32768
  ds_read_b128 a[172:175], v63 offset:36864
  ds_read_b64_tr_b16 v[120:121], v8 offset:63488
  ds_read_b64_tr_b16 v[122:123], v8 offset:64000
  v_mfma_f32_32x32x16_bf16 v[176:191], v[136:139], a[160:163], v[176:191]
  v_add_u32_e64 v56, s63, v8
  ds_read_b64_tr_b16 v[152:153], v56 offset:57344
  ds_read_b64_tr_b16 v[154:155], v56 offset:57856
  ds_read_b64_tr_b16 v[156:157], v56 offset:61440
  ds_read_b64_tr_b16 v[158:159], v56 offset:61952
  v_mfma_f32_32x32x16_bf16 v[192:207], v[140:143], a[32:35], v[192:207]
  ds_read_b64_tr_b16 v[124:125], v8 offset:55296
  v_mfma_f32_32x32x16_bf16 v[208:223], v[140:143], a[160:163], v[208:223]
  ds_read_b64_tr_b16 v[126:127], v8 offset:55808
s_waitcnt vmcnt(10)
  s_barrier
  v_mfma_f32_32x32x16_bf16 v[160:175], v[144:147], a[36:39], v[160:175]
  s_add_u32 s43, s41, 640
  s_add_u32 m0, s42, 131072
s_nop 0
s_nop 0
  buffer_load_dwordx4 v5, s[8:11], s43 offen lds
  buffer_load_dwordx4 v6, s[8:11], s43 offen offset:1024 lds
  ds_read_b128 a[48:51], v60 offset:49152
  ds_read_b128 a[176:179], v60 offset:53248
  v_mfma_f32_32x32x16_bf16 v[176:191], v[144:147], a[164:167], v[176:191]
  ds_read_b64_tr_b16 v[128:129], v8 offset:40960
  ds_read_b64_tr_b16 v[130:131], v8 offset:41472
s_waitcnt lgkmcnt(8)
s_nop 0
  v_mfma_f32_16x16x32_bf16 v[24:27], v[12:15], v[152:155], v[24:27]
  v_dot2c_f32_bf16 v80, s55, v92
  v_dot2c_f32_bf16 v82, v92, v92
  v_dot2c_f32_bf16 v84, s55, v96
  v_dot2c_f32_bf16 v86, v96, v96
  v_dot2c_f32_bf16 v81, s55, v93
  v_dot2c_f32_bf16 v83, v93, v93
  v_dot2c_f32_bf16 v85, s55, v97
  v_dot2c_f32_bf16 v87, v97, v97
  v_dot2c_f32_bf16 v80, s55, v94
  v_dot2c_f32_bf16 v82, v94, v94
  v_dot2c_f32_bf16 v84, s55, v98
  v_dot2c_f32_bf16 v86, v98, v98
  v_dot2c_f32_bf16 v81, s55, v95
  v_dot2c_f32_bf16 v83, v95, v95
  v_dot2c_f32_bf16 v85, s55, v99
  v_dot2c_f32_bf16 v87, v99, v99
  v_mfma_f32_32x32x16_bf16 v[192:207], v[148:151], a[36:39], v[192:207]
  s_add_u32 s43, s41, 66176
  s_add_u32 m0, s42, 139264
s_nop 0
s_nop 0
  buffer_load_dwordx4 v5, s[8:11], s43 offen lds
  buffer_load_dwordx4 v6, s[8:11], s43 offen offset:1024 lds
  ds_read_b64_tr_b16 v[132:133], v8 offset:32768
  v_mfma_f32_32x32x16_bf16 v[208:223], v[148:151], a[164:167], v[208:223]
  ds_read_b64_tr_b16 v[134:135], v8 offset:33280
s_waitcnt lgkmcnt(8)
s_nop 0
  v_mfma_f32_16x16x32_bf16 v[24:27], v[12:15], v[156:159], v[24:27]
  ds_read_b128 v[100:103], v73 offset:32768
  ds_read_b128 v[104:107], v73 offset:36864
  v_mfma_f32_32x32x16_bf16 v[160:175], v[112:115], a[40:43], v[160:175]
  s_add_u32 s43, s37, 1146880
  s_add_u32 m0, s42, 147456
s_nop 0
s_nop 0
  buffer_load_dwordx4 v1, s[20:23], s43 offen lds
  buffer_load_dwordx4 v2, s[20:23], s43 offen offset:1024 lds
  ds_read_b128 a[52:55], v61 offset:49152
  ds_read_b128 a[180:183], v61 offset:53248
  ds_read_b64_tr_b16 v[136:137], v8 offset:43008
  ds_read_b64_tr_b16 v[138:139], v8 offset:43520
  v_mfma_f32_32x32x16_bf16 v[176:191], v[112:115], a[168:171], v[176:191]
  v_add_u32_e64 v56, s63, v8
  ds_read_b64_tr_b16 v[152:153], v56 offset:49152
  ds_read_b64_tr_b16 v[154:155], v56 offset:49664
  ds_read_b64_tr_b16 v[156:157], v56 offset:53248
  ds_read_b64_tr_b16 v[158:159], v56 offset:53760
  v_mfma_f32_32x32x16_bf16 v[192:207], v[116:119], a[40:43], v[192:207]
  s_add_u32 s43, s36, 1376256
  s_add_u32 m0, s42, 24576
s_nop 0
s_nop 0
  buffer_load_dwordx4 v1, s[16:19], s43 offen lds
  buffer_load_dwordx4 v2, s[16:19], s43 offen offset:1024 lds
  ds_read_b64_tr_b16 v[140:141], v8 offset:34816
  v_mfma_f32_32x32x16_bf16 v[208:223], v[116:119], a[168:171], v[208:223]
  ds_read_b64_tr_b16 v[142:143], v8 offset:35328
  v_mfma_f32_32x32x16_bf16 v[160:175], v[120:123], a[44:47], v[160:175]
  ds_read_b128 a[56:59], v62 offset:49152
  ds_read_b128 a[184:187], v62 offset:53248
  v_mfma_f32_32x32x16_bf16 v[176:191], v[120:123], a[172:175], v[176:191]
  ds_read_b64_tr_b16 v[144:145], v8 offset:45056
  ds_read_b64_tr_b16 v[146:147], v8 offset:45568
s_waitcnt lgkmcnt(8)
s_nop 0
  v_mfma_f32_16x16x32_bf16 v[108:111], v[12:15], v[152:155], v[108:111]
  v_dot2c_f32_bf16 v80, s55, v100
  v_dot2c_f32_bf16 v82, v100, v100
  v_dot2c_f32_bf16 v84, s55, v104
  v_dot2c_f32_bf16 v86, v104, v104
  v_dot2c_f32_bf16 v81, s55, v101
  v_dot2c_f32_bf16 v83, v101, v101
  v_dot2c_f32_bf16 v85, s55, v105
  v_dot2c_f32_bf16 v87, v105, v105
  v_dot2c_f32_bf16 v80, s55, v102
  v_dot2c_f32_bf16 v82, v102, v102
  v_dot2c_f32_bf16 v84, s55, v106
  v_dot2c_f32_bf16 v86, v106, v106
  v_dot2c_f32_bf16 v81, s55, v103
  v_dot2c_f32_bf16 v83, v103, v103
  v_dot2c_f32_bf16 v85, s55, v107
  v_dot2c_f32_bf16 v87, v107, v107
  v_mfma_f32_32x32x16_bf16 v[192:207], v[124:127], a[44:47], v[192:207]
  ds_read_b64_tr_b16 v[148:149], v8 offset:36864
  v_mfma_f32_32x32x16_bf16 v[208:223], v[124:127], a[172:175], v[208:223]
  ds_read_b64_tr_b16 v[150:151], v8 offset:37376
s_waitcnt lgkmcnt(8)
s_nop 0
  v_mfma_f32_16x16x32_bf16 v[108:111], v[12:15], v[156:159], v[108:111]
  ds_read_b128 v[92:95], v72 offset:49152
  ds_read_b128 v[96:99], v72 offset:53248
  v_mfma_f32_32x32x16_bf16 v[160:175], v[128:131], a[48:51], v[160:175]
  ds_read_b128 a[60:63], v63 offset:49152
  ds_read_b128 a[188:191], v63 offset:53248
  ds_read_b64_tr_b16 v[112:113], v8 offset:47104
  ds_read_b64_tr_b16 v[114:115], v8 offset:47616
  v_mfma_f32_32x32x16_bf16 v[176:191], v[128:131], a[176:179], v[176:191]
  v_add_u32_e64 v56, s63, v8
  ds_read_b64_tr_b16 v[152:153], v56 offset:40960
  ds_read_b64_tr_b16 v[154:155], v56 offset:41472
  ds_read_b64_tr_b16 v[156:157], v56 offset:45056
  ds_read_b64_tr_b16 v[158:159], v56 offset:45568
  v_mfma_f32_32x32x16_bf16 v[192:207], v[132:135], a[48:51], v[192:207]
  ds_read_b64_tr_b16 v[116:117], v8 offset:38912
  v_mfma_f32_32x32x16_bf16 v[208:223], v[132:135], a[176:179], v[208:223]
  ds_read_b64_tr_b16 v[118:119], v8 offset:39424
s_waitcnt vmcnt(10)
  s_barrier
  v_mfma_f32_32x32x16_bf16 v[160:175], v[136:139], a[52:55], v[160:175]
  s_add_u32 s43, s41, 768
  s_add_u32 m0, s42, 32768
s_nop 0
s_nop 0
  buffer_load_dwordx4 v5, s[8:11], s43 offen lds
  buffer_load_dwordx4 v6, s[8:11], s43 offen offset:1024 lds
  ds_read_b128 a[64:67], v64 offset:0
  ds_read_b128 a[192:195], v64 offset:4096
  v_mfma_f32_32x32x16_bf16 v[176:191], v[136:139], a[180:183], v[176:191]
  ds_read_b64_tr_b16 v[120:121], v8 offset:24576
  ds_read_b64_tr_b16 v[122:123], v8 offset:25088
s_waitcnt lgkmcnt(8)
s_nop 0
  v_mfma_f32_16x16x32_bf16 v[24:27], v[12:15], v[152:155], v[24:27]
  v_dot2c_f32_bf16 v80, s55, v92
  v_dot2c_f32_bf16 v82, v92, v92
  v_dot2c_f32_bf16 v84, s55, v96
  v_dot2c_f32_bf16 v86, v96, v96
  v_dot2c_f32_bf16 v81, s55, v93
  v_dot2c_f32_bf16 v83, v93, v93
  v_dot2c_f32_bf16 v85, s55, v97
  v_dot2c_f32_bf16 v87, v97, v97
  v_dot2c_f32_bf16 v80, s55, v94
  v_dot2c_f32_bf16 v82, v94, v94
  v_dot2c_f32_bf16 v84, s55, v98
  v_dot2c_f32_bf16 v86, v98, v98
  v_dot2c_f32_bf16 v81, s55, v95
  v_dot2c_f32_bf16 v83, v95, v95
  v_dot2c_f32_bf16 v85, s55, v99
  v_dot2c_f32_bf16 v87, v99, v99
  v_mfma_f32_32x32x16_bf16 v[192:207], v[140:143], a[52:55], v[192:207]
  s_add_u32 s43, s41, 66304
  s_add_u32 m0, s42, 40960
s_nop 0
s_nop 0
  buffer_load_dwordx4 v5, s[8:11], s43 offen lds
  buffer_load_dwordx4 v6, s[8:11], s43 offen offset:1024 lds
  ds_read_b64_tr_b16 v[124:125], v8 offset:16384
  v_mfma_f32_32x32x16_bf16 v[208:223], v[140:143], a[180:183], v[208:223]
  ds_read_b64_tr_b16 v[126:127], v8 offset:16896
s_waitcnt lgkmcnt(8)
s_nop 0
  v_mfma_f32_16x16x32_bf16 v[24:27], v[12:15], v[156:159], v[24:27]
  ds_read_b128 v[100:103], v73 offset:49152
  ds_read_b128 v[104:107], v73 offset:53248
  v_mfma_f32_32x32x16_bf16 v[160:175], v[144:147], a[56:59], v[160:175]
  s_add_u32 s43, s37, 1376256
  s_add_u32 m0, s42, 122880
s_nop 0
s_nop 0
  buffer_load_dwordx4 v1, s[20:23], s43 offen lds
  buffer_load_dwordx4 v2, s[20:23], s43 offen offset:1024 lds
  ds_read_b128 a[68:71], v65 offset:0
  ds_read_b128 a[196:199], v65 offset:4096
  ds_read_b64_tr_b16 v[128:129], v8 offset:26624
  ds_read_b64_tr_b16 v[130:131], v8 offset:27136
  v_mfma_f32_32x32x16_bf16 v[176:191], v[144:147], a[184:187], v[176:191]
  v_add_u32_e64 v56, s63, v8
  ds_read_b64_tr_b16 v[152:153], v56 offset:32768
  ds_read_b64_tr_b16 v[154:155], v56 offset:33280
  ds_read_b64_tr_b16 v[156:157], v56 offset:36864
  ds_read_b64_tr_b16 v[158:159], v56 offset:37376
  v_mfma_f32_32x32x16_bf16 v[192:207], v[148:151], a[56:59], v[192:207]
  s_add_u32 s43, s36, 1605632
  s_add_u32 m0, s42, 114688
s_nop 0
s_nop 0
  buffer_load_dwordx4 v1, s[16:19], s43 offen lds
  buffer_load_dwordx4 v2, s[16:19], s43 offen offset:1024 lds
  ds_read_b64_tr_b16 v[132:133], v8 offset:18432
  v_mfma_f32_32x32x16_bf16 v[208:223], v[148:151], a[184:187], v[208:223]
  ds_read_b64_tr_b16 v[134:135], v8 offset:18944
  v_mfma_f32_32x32x16_bf16 v[160:175], v[112:115], a[60:63], v[160:175]
  ds_read_b128 a[72:75], v66 offset:0
  ds_read_b128 a[200:203], v66 offset:4096
  v_mfma_f32_32x32x16_bf16 v[176:191], v[112:115], a[188:191], v[176:191]
  ds_read_b64_tr_b16 v[136:137], v8 offset:28672
  ds_read_b64_tr_b16 v[138:139], v8 offset:29184
s_waitcnt lgkmcnt(8)
s_nop 0
  v_mfma_f32_16x16x32_bf16 v[108:111], v[12:15], v[152:155], v[108:111]
  v_dot2c_f32_bf16 v80, s55, v100
  v_dot2c_f32_bf16 v82, v100, v100
  v_dot2c_f32_bf16 v84, s55, v104
  v_dot2c_f32_bf16 v86, v104, v104
  v_dot2c_f32_bf16 v81, s55, v101
  v_dot2c_f32_bf16 v83, v101, v101
  v_dot2c_f32_bf16 v85, s55, v105
  v_dot2c_f32_bf16 v87, v105, v105
  v_dot2c_f32_bf16 v80, s55, v102
  v_dot2c_f32_bf16 v82, v102, v102
  v_dot2c_f32_bf16 v84, s55, v106
  v_dot2c_f32_bf16 v86, v106, v106
  v_dot2c_f32_bf16 v81, s55, v103
  v_dot2c_f32_bf16 v83, v103, v103
  v_dot2c_f32_bf16 v85, s55, v107
  v_dot2c_f32_bf16 v87, v107, v107
  v_mfma_f32_32x32x16_bf16 v[192:207], v[116:119], a[60:63], v[192:207]
  ds_read_b64_tr_b16 v[140:141], v8 offset:20480
  v_mfma_f32_32x32x16_bf16 v[208:223], v[116:119], a[188:191], v[208:223]
  ds_read_b64_tr_b16 v[142:143], v8 offset:20992
s_waitcnt lgkmcnt(8)
s_nop 0
  v_mfma_f32_16x16x32_bf16 v[108:111], v[12:15], v[156:159], v[108:111]
  ds_read_b128 v[92:95], v74 offset:0
  ds_read_b128 v[96:99], v74 offset:4096
  v_mfma_f32_32x32x16_bf16 v[160:175], v[120:123], a[64:67], v[160:175]
  ds_read_b128 a[76:79], v67 offset:0
  ds_read_b128 a[204:207], v67 offset:4096
  ds_read_b64_tr_b16 v[144:145], v8 offset:30720
  ds_read_b64_tr_b16 v[146:147], v8 offset:31232
  v_mfma_f32_32x32x16_bf16 v[176:191], v[120:123], a[192:195], v[176:191]
  v_add_u32_e64 v56, s63, v8
  ds_read_b64_tr_b16 v[152:153], v56 offset:24576
  ds_read_b64_tr_b16 v[154:155], v56 offset:25088
  ds_read_b64_tr_b16 v[156:157], v56 offset:28672
  ds_read_b64_tr_b16 v[158:159], v56 offset:29184
  v_mfma_f32_32x32x16_bf16 v[192:207], v[124:127], a[64:67], v[192:207]
  ds_read_b64_tr_b16 v[148:149], v8 offset:22528
  v_mfma_f32_32x32x16_bf16 v[208:223], v[124:127], a[192:195], v[208:223]
  ds_read_b64_tr_b16 v[150:151], v8 offset:23040
s_waitcnt vmcnt(10)
  s_barrier
  v_mfma_f32_32x32x16_bf16 v[160:175], v[128:131], a[68:71], v[160:175]
  s_add_u32 s43, s41, 896
  s_add_u32 m0, s42, 49152
s_nop 0
s_nop 0
  buffer_load_dwordx4 v5, s[8:11], s43 offen lds
  buffer_load_dwordx4 v6, s[8:11], s43 offen offset:1024 lds
  ds_read_b128 a[80:83], v68 offset:0
  ds_read_b128 a[208:211], v68 offset:4096
  v_mfma_f32_32x32x16_bf16 v[176:191], v[128:131], a[196:199], v[176:191]
  ds_read_b64_tr_b16 v[112:113], v9 offset:24576
  ds_read_b64_tr_b16 v[114:115], v9 offset:25088
s_waitcnt lgkmcnt(8)
s_nop 0
  v_mfma_f32_16x16x32_bf16 v[24:27], v[12:15], v[152:155], v[24:27]
  v_dot2c_f32_bf16 v80, s55, v92
  v_dot2c_f32_bf16 v82, v92, v92
  v_dot2c_f32_bf16 v84, s55, v96
  v_dot2c_f32_bf16 v86, v96, v96
  v_dot2c_f32_bf16 v81, s55, v93
  v_dot2c_f32_bf16 v83, v93, v93
  v_dot2c_f32_bf16 v85, s55, v97
  v_dot2c_f32_bf16 v87, v97, v97
  v_dot2c_f32_bf16 v80, s55, v94
  v_dot2c_f32_bf16 v82, v94, v94
  v_dot2c_f32_bf16 v84, s55, v98
  v_dot2c_f32_bf16 v86, v98, v98
  v_dot2c_f32_bf16 v81, s55, v95
  v_dot2c_f32_bf16 v83, v95, v95
  v_dot2c_f32_bf16 v85, s55, v99
  v_dot2c_f32_bf16 v87, v99, v99
  v_mfma_f32_32x32x16_bf16 v[192:207], v[132:135], a[68:71], v[192:207]
  s_add_u32 s43, s41, 66432
  s_add_u32 m0, s42, 57344
s_nop 0
s_nop 0
  buffer_load_dwordx4 v5, s[8:11], s43 offen lds
  buffer_load_dwordx4 v6, s[8:11], s43 offen offset:1024 lds
  ds_read_b64_tr_b16 v[116:117], v9 offset:16384
  v_mfma_f32_32x32x16_bf16 v[208:223], v[132:135], a[196:199], v[208:223]
  ds_read_b64_tr_b16 v[118:119], v9 offset:16896
s_waitcnt lgkmcnt(8)
s_nop 0
  v_mfma_f32_16x16x32_bf16 v[24:27], v[12:15], v[156:159], v[24:27]
  ds_read_b128 v[100:103], v75 offset:0
  ds_read_b128 v[104:107], v75 offset:4096
  v_mfma_f32_32x32x16_bf16 v[160:175], v[136:139], a[72:75], v[160:175]
  s_add_u32 s43, s37, 1605632
  s_add_u32 m0, s42, 106496
s_nop 0
s_nop 0
  buffer_load_dwordx4 v1, s[20:23], s43 offen lds
  buffer_load_dwordx4 v2, s[20:23], s43 offen offset:1024 lds
  ds_read_b128 a[84:87], v69 offset:0
  ds_read_b128 a[212:215], v69 offset:4096
  ds_read_b64_tr_b16 v[120:121], v9 offset:26624
  ds_read_b64_tr_b16 v[122:123], v9 offset:27136
  v_mfma_f32_32x32x16_bf16 v[176:191], v[136:139], a[200:203], v[176:191]
  v_add_u32_e64 v56, s63, v8
  ds_read_b64_tr_b16 v[152:153], v56 offset:16384
  ds_read_b64_tr_b16 v[154:155], v56 offset:16896
  ds_read_b64_tr_b16 v[156:157], v56 offset:20480
  ds_read_b64_tr_b16 v[158:159], v56 offset:20992
  v_mfma_f32_32x32x16_bf16 v[192:207], v[140:143], a[72:75], v[192:207]
  s_add_u32 s43, s38, 0
s_nop 0
  s_add_u32 m0, s42, 98304
s_nop 0
s_nop 0
  buffer_load_dwordx4 v1, s[16:19], s43 offen lds
  buffer_load_dwordx4 v2, s[16:19], s43 offen offset:1024 lds
  ds_read_b64_tr_b16 v[124:125], v9 offset:18432
  v_mfma_f32_32x32x16_bf16 v[208:223], v[140:143], a[200:203], v[208:223]
  ds_read_b64_tr_b16 v[126:127], v9 offset:18944
  v_mfma_f32_32x32x16_bf16 v[160:175], v[144:147], a[76:79], v[160:175]
  ds_read_b128 a[88:91], v70 offset:0
  ds_read_b128 a[216:219], v70 offset:4096
  v_mfma_f32_32x32x16_bf16 v[176:191], v[144:147], a[204:207], v[176:191]
  ds_read_b64_tr_b16 v[128:129], v9 offset:28672
  ds_read_b64_tr_b16 v[130:131], v9 offset:29184
s_waitcnt lgkmcnt(8)
s_nop 0
  v_mfma_f32_16x16x32_bf16 v[108:111], v[12:15], v[152:155], v[108:111]
  v_dot2c_f32_bf16 v80, s55, v100
  v_dot2c_f32_bf16 v82, v100, v100
  v_dot2c_f32_bf16 v84, s55, v104
  v_dot2c_f32_bf16 v86, v104, v104
  v_dot2c_f32_bf16 v81, s55, v101
  v_dot2c_f32_bf16 v83, v101, v101
  v_dot2c_f32_bf16 v85, s55, v105
  v_dot2c_f32_bf16 v87, v105, v105
  v_dot2c_f32_bf16 v80, s55, v102
  v_dot2c_f32_bf16 v82, v102, v102
  v_dot2c_f32_bf16 v84, s55, v106
  v_dot2c_f32_bf16 v86, v106, v106
  v_dot2c_f32_bf16 v81, s55, v103
  v_dot2c_f32_bf16 v83, v103, v103
  v_dot2c_f32_bf16 v85, s55, v107
  v_dot2c_f32_bf16 v87, v107, v107
  v_mfma_f32_32x32x16_bf16 v[192:207], v[148:151], a[76:79], v[192:207]
  ds_read_b64_tr_b16 v[132:133], v9 offset:20480
  v_mfma_f32_32x32x16_bf16 v[208:223], v[148:151], a[204:207], v[208:223]
  ds_read_b64_tr_b16 v[134:135], v9 offset:20992
s_waitcnt lgkmcnt(8)
s_nop 0
  v_mfma_f32_16x16x32_bf16 v[108:111], v[12:15], v[156:159], v[108:111]
  ds_read_b128 v[92:95], v76 offset:0
  ds_read_b128 v[96:99], v76 offset:4096
  v_mfma_f32_32x32x16_bf16 v[160:175], v[112:115], a[80:83], v[160:175]
  ds_read_b128 a[92:95], v71 offset:0
  ds_read_b128 a[220:223], v71 offset:4096
  ds_read_b64_tr_b16 v[136:137], v9 offset:30720
  ds_read_b64_tr_b16 v[138:139], v9 offset:31232
  v_mfma_f32_32x32x16_bf16 v[176:191], v[112:115], a[208:211], v[176:191]
  v_add_u32_e64 v56, s63, v9
  ds_read_b64_tr_b16 v[152:153], v56 offset:24576
  ds_read_b64_tr_b16 v[154:155], v56 offset:25088
  ds_read_b64_tr_b16 v[156:157], v56 offset:28672
  ds_read_b64_tr_b16 v[158:159], v56 offset:29184
  v_mfma_f32_32x32x16_bf16 v[192:207], v[116:119], a[80:83], v[192:207]
  ds_read_b64_tr_b16 v[140:141], v9 offset:22528
  v_mfma_f32_32x32x16_bf16 v[208:223], v[116:119], a[208:211], v[208:223]
  ds_read_b64_tr_b16 v[142:143], v9 offset:23040
s_waitcnt vmcnt(10)
  s_barrier
  v_mfma_f32_32x32x16_bf16 v[160:175], v[120:123], a[84:87], v[160:175]
  s_add_u32 s43, s38, 229376
  s_add_u32 m0, s42, 90112
s_nop 0
s_nop 0
  buffer_load_dwordx4 v1, s[16:19], s43 offen lds
  buffer_load_dwordx4 v2, s[16:19], s43 offen offset:1024 lds
  ds_read_b128 a[96:99], v60 offset:32768
  ds_read_b128 a[224:227], v60 offset:36864
  v_mfma_f32_32x32x16_bf16 v[176:191], v[120:123], a[212:215], v[176:191]
  ds_read_b64_tr_b16 v[144:145], v7 offset:24576
  ds_read_b64_tr_b16 v[146:147], v7 offset:25088
s_waitcnt lgkmcnt(8)
s_nop 0
  v_mfma_f32_16x16x32_bf16 v[24:27], v[12:15], v[152:155], v[24:27]
  v_dot2c_f32_bf16 v80, s55, v92
  v_dot2c_f32_bf16 v82, v92, v92
  v_dot2c_f32_bf16 v84, s55, v96
  v_dot2c_f32_bf16 v86, v96, v96
  v_dot2c_f32_bf16 v81, s55, v93
  v_dot2c_f32_bf16 v83, v93, v93
  v_dot2c_f32_bf16 v85, s55, v97
  v_dot2c_f32_bf16 v87, v97, v97
  v_dot2c_f32_bf16 v80, s55, v94
  v_dot2c_f32_bf16 v82, v94, v94
  v_dot2c_f32_bf16 v84, s55, v98
  v_dot2c_f32_bf16 v86, v98, v98
  v_dot2c_f32_bf16 v81, s55, v95
  v_dot2c_f32_bf16 v83, v95, v95
  v_dot2c_f32_bf16 v85, s55, v99
  v_dot2c_f32_bf16 v87, v99, v99
  v_mfma_f32_32x32x16_bf16 v[192:207], v[124:127], a[84:87], v[192:207]
  s_add_u32 s43, s38, 458752
  s_add_u32 m0, s42, 81920
s_nop 0
s_nop 0
  buffer_load_dwordx4 v1, s[16:19], s43 offen lds
  buffer_load_dwordx4 v2, s[16:19], s43 offen offset:1024 lds
  ds_read_b64_tr_b16 v[148:149], v8 offset:57344
  v_mfma_f32_32x32x16_bf16 v[208:223], v[124:127], a[212:215], v[208:223]
  ds_read_b64_tr_b16 v[150:151], v8 offset:57856
s_waitcnt lgkmcnt(8)
s_nop 0
  v_mfma_f32_16x16x32_bf16 v[24:27], v[12:15], v[156:159], v[24:27]
  ds_read_b128 v[100:103], v77 offset:0
  ds_read_b128 v[104:107], v77 offset:4096
  v_mfma_f32_32x32x16_bf16 v[160:175], v[128:131], a[88:91], v[160:175]
  s_add_u32 s43, s38, 688128
  s_add_u32 m0, s42, 73728
s_nop 0
s_nop 0
  buffer_load_dwordx4 v1, s[16:19], s43 offen lds
  buffer_load_dwordx4 v2, s[16:19], s43 offen offset:1024 lds
  ds_read_b128 a[100:103], v61 offset:32768
  ds_read_b128 a[228:231], v61 offset:36864
  ds_read_b64_tr_b16 v[112:113], v7 offset:26624
  ds_read_b64_tr_b16 v[114:115], v7 offset:27136
  v_mfma_f32_32x32x16_bf16 v[176:191], v[128:131], a[216:219], v[176:191]
  v_add_u32_e64 v56, s63, v9
  ds_read_b64_tr_b16 v[152:153], v56 offset:16384
  ds_read_b64_tr_b16 v[154:155], v56 offset:16896
  ds_read_b64_tr_b16 v[156:157], v56 offset:20480
  ds_read_b64_tr_b16 v[158:159], v56 offset:20992
  v_mfma_f32_32x32x16_bf16 v[192:207], v[132:135], a[88:91], v[192:207]
  s_add_u32 s43, s38, 917504
  s_add_u32 m0, s42, 65536
s_nop 0
s_nop 0
  buffer_load_dwordx4 v1, s[16:19], s43 offen lds
  buffer_load_dwordx4 v2, s[16:19], s43 offen offset:1024 lds
  ds_read_b64_tr_b16 v[116:117], v8 offset:59392
  v_mfma_f32_32x32x16_bf16 v[208:223], v[132:135], a[216:219], v[208:223]
  ds_read_b64_tr_b16 v[118:119], v8 offset:59904
  v_mfma_f32_32x32x16_bf16 v[160:175], v[136:139], a[92:95], v[160:175]
  ds_read_b128 a[104:107], v62 offset:32768
  ds_read_b128 a[232:235], v62 offset:36864
  v_mfma_f32_32x32x16_bf16 v[176:191], v[136:139], a[220:223], v[176:191]
  ds_read_b64_tr_b16 v[120:121], v7 offset:28672
  ds_read_b64_tr_b16 v[122:123], v7 offset:29184
s_waitcnt lgkmcnt(8)
s_nop 0
  v_mfma_f32_16x16x32_bf16 v[108:111], v[12:15], v[152:155], v[108:111]
  v_dot2c_f32_bf16 v80, s55, v100
  v_dot2c_f32_bf16 v82, v100, v100
  v_dot2c_f32_bf16 v84, s55, v104
  v_dot2c_f32_bf16 v86, v104, v104
  v_dot2c_f32_bf16 v81, s55, v101
  v_dot2c_f32_bf16 v83, v101, v101
  v_dot2c_f32_bf16 v85, s55, v105
  v_dot2c_f32_bf16 v87, v105, v105
  v_dot2c_f32_bf16 v80, s55, v102
  v_dot2c_f32_bf16 v82, v102, v102
  v_dot2c_f32_bf16 v84, s55, v106
  v_dot2c_f32_bf16 v86, v106, v106
  v_dot2c_f32_bf16 v81, s55, v103
  v_dot2c_f32_bf16 v83, v103, v103
  v_dot2c_f32_bf16 v85, s55, v107
  v_dot2c_f32_bf16 v87, v107, v107
  v_mfma_f32_32x32x16_bf16 v[192:207], v[140:143], a[92:95], v[192:207]
  ds_read_b64_tr_b16 v[124:125], v8 offset:61440
  v_mfma_f32_32x32x16_bf16 v[208:223], v[140:143], a[220:223], v[208:223]
  ds_read_b64_tr_b16 v[126:127], v8 offset:61952
s_waitcnt lgkmcnt(8)
s_nop 0
  v_mfma_f32_16x16x32_bf16 v[108:111], v[12:15], v[156:159], v[108:111]
  ds_read_b128 v[92:95], v72 offset:32768
  ds_read_b128 v[96:99], v72 offset:36864
  v_mfma_f32_32x32x16_bf16 v[160:175], v[144:147], a[96:99], v[160:175]
  ds_read_b128 a[108:111], v63 offset:32768
  ds_read_b128 a[236:239], v63 offset:36864
  ds_read_b64_tr_b16 v[128:129], v7 offset:30720
  ds_read_b64_tr_b16 v[130:131], v7 offset:31232
  v_mfma_f32_32x32x16_bf16 v[176:191], v[144:147], a[224:227], v[176:191]
  v_add_u32_e64 v56, s63, v7
  ds_read_b64_tr_b16 v[152:153], v56 offset:24576
  ds_read_b64_tr_b16 v[154:155], v56 offset:25088
  ds_read_b64_tr_b16 v[156:157], v56 offset:28672
  ds_read_b64_tr_b16 v[158:159], v56 offset:29184
  v_mfma_f32_32x32x16_bf16 v[192:207], v[148:151], a[96:99], v[192:207]
  ds_read_b64_tr_b16 v[132:133], v8 offset:63488
  v_mfma_f32_32x32x16_bf16 v[208:223], v[148:151], a[224:227], v[208:223]
  ds_read_b64_tr_b16 v[134:135], v8 offset:64000
s_waitcnt vmcnt(10)
  s_barrier
  v_mfma_f32_32x32x16_bf16 v[160:175], v[112:115], a[100:103], v[160:175]
  s_add_u32 s43, s38, 1146880
  s_add_u32 m0, s42, 155648
s_nop 0
s_nop 0
  buffer_load_dwordx4 v1, s[16:19], s43 offen lds
  buffer_load_dwordx4 v2, s[16:19], s43 offen offset:1024 lds
  ds_read_b128 a[112:115], v60 offset:49152
  ds_read_b128 a[240:243], v60 offset:53248
  v_mfma_f32_32x32x16_bf16 v[176:191], v[112:115], a[228:231], v[176:191]
  ds_read_b64_tr_b16 v[136:137], v8 offset:49152
  ds_read_b64_tr_b16 v[138:139], v8 offset:49664
s_waitcnt lgkmcnt(8)
s_nop 0
  v_mfma_f32_16x16x32_bf16 v[24:27], v[12:15], v[152:155], v[24:27]
  v_dot2c_f32_bf16 v80, s55, v92
  v_dot2c_f32_bf16 v82, v92, v92
  v_dot2c_f32_bf16 v84, s55, v96
  v_dot2c_f32_bf16 v86, v96, v96
  v_dot2c_f32_bf16 v81, s55, v93
  v_dot2c_f32_bf16 v83, v93, v93
  v_dot2c_f32_bf16 v85, s55, v97
  v_dot2c_f32_bf16 v87, v97, v97
  v_dot2c_f32_bf16 v80, s55, v94
  v_dot2c_f32_bf16 v82, v94, v94
  v_dot2c_f32_bf16 v84, s55, v98
  v_dot2c_f32_bf16 v86, v98, v98
  v_dot2c_f32_bf16 v81, s55, v95
  v_dot2c_f32_bf16 v83, v95, v95
  v_dot2c_f32_bf16 v85, s55, v99
  v_dot2c_f32_bf16 v87, v99, v99
  v_mfma_f32_32x32x16_bf16 v[192:207], v[116:119], a[100:103], v[192:207]
  s_add_u32 s43, s38, 1376256
  s_add_u32 m0, s42, 147456
s_nop 0
s_nop 0
  buffer_load_dwordx4 v1, s[16:19], s43 offen lds
  buffer_load_dwordx4 v2, s[16:19], s43 offen offset:1024 lds
  ds_read_b64_tr_b16 v[140:141], v8 offset:40960
  v_mfma_f32_32x32x16_bf16 v[208:223], v[116:119], a[228:231], v[208:223]
  ds_read_b64_tr_b16 v[142:143], v8 offset:41472
s_waitcnt lgkmcnt(8)
s_nop 0
  v_mfma_f32_16x16x32_bf16 v[24:27], v[12:15], v[156:159], v[24:27]
  ds_read_b128 v[100:103], v73 offset:32768
  ds_read_b128 v[104:107], v73 offset:36864
  v_mfma_f32_32x32x16_bf16 v[160:175], v[120:123], a[104:107], v[160:175]
  s_add_u32 s43, s38, 1605632
  s_add_u32 m0, s42, 139264
s_nop 0
s_nop 0
  buffer_load_dwordx4 v1, s[16:19], s43 offen lds
  buffer_load_dwordx4 v2, s[16:19], s43 offen offset:1024 lds
  ds_read_b128 a[116:119], v61 offset:49152
  ds_read_b128 a[244:247], v61 offset:53248
  ds_read_b64_tr_b16 v[144:145], v8 offset:51200
  ds_read_b64_tr_b16 v[146:147], v8 offset:51712
  v_mfma_f32_32x32x16_bf16 v[176:191], v[120:123], a[232:235], v[176:191]
  v_add_u32_e64 v56, s63, v8
  ds_read_b64_tr_b16 v[152:153], v56 offset:57344
  ds_read_b64_tr_b16 v[154:155], v56 offset:57856
  ds_read_b64_tr_b16 v[156:157], v56 offset:61440
  ds_read_b64_tr_b16 v[158:159], v56 offset:61952
  v_mfma_f32_32x32x16_bf16 v[192:207], v[124:127], a[104:107], v[192:207]
  s_add_u32 s43, s39, 0
s_nop 0
  s_add_u32 m0, s42, 131072
s_nop 0
s_nop 0
  buffer_load_dwordx4 v1, s[20:23], s43 offen lds
  buffer_load_dwordx4 v2, s[20:23], s43 offen offset:1024 lds
  ds_read_b64_tr_b16 v[148:149], v8 offset:43008
  v_mfma_f32_32x32x16_bf16 v[208:223], v[124:127], a[232:235], v[208:223]
  ds_read_b64_tr_b16 v[150:151], v8 offset:43520
  v_mfma_f32_32x32x16_bf16 v[160:175], v[128:131], a[108:111], v[160:175]
  ds_read_b128 a[120:123], v62 offset:49152
  ds_read_b128 a[248:251], v62 offset:53248
  v_mfma_f32_32x32x16_bf16 v[176:191], v[128:131], a[236:239], v[176:191]
  ds_read_b64_tr_b16 v[112:113], v8 offset:53248
  ds_read_b64_tr_b16 v[114:115], v8 offset:53760
s_waitcnt lgkmcnt(8)
s_nop 0
  v_mfma_f32_16x16x32_bf16 v[108:111], v[12:15], v[152:155], v[108:111]
  v_dot2c_f32_bf16 v80, s55, v100
  v_dot2c_f32_bf16 v82, v100, v100
  v_dot2c_f32_bf16 v84, s55, v104
  v_dot2c_f32_bf16 v86, v104, v104
  v_dot2c_f32_bf16 v81, s55, v101
  v_dot2c_f32_bf16 v83, v101, v101
  v_dot2c_f32_bf16 v85, s55, v105
  v_dot2c_f32_bf16 v87, v105, v105
  v_dot2c_f32_bf16 v80, s55, v102
  v_dot2c_f32_bf16 v82, v102, v102
  v_dot2c_f32_bf16 v84, s55, v106
  v_dot2c_f32_bf16 v86, v106, v106
  v_dot2c_f32_bf16 v81, s55, v103
  v_dot2c_f32_bf16 v83, v103, v103
  v_dot2c_f32_bf16 v85, s55, v107
  v_dot2c_f32_bf16 v87, v107, v107
  v_mfma_f32_32x32x16_bf16 v[192:207], v[132:135], a[108:111], v[192:207]
  ds_read_b64_tr_b16 v[116:117], v8 offset:45056
  v_mfma_f32_32x32x16_bf16 v[208:223], v[132:135], a[236:239], v[208:223]
  ds_read_b64_tr_b16 v[118:119], v8 offset:45568
s_waitcnt lgkmcnt(8)
s_nop 0
  v_mfma_f32_16x16x32_bf16 v[108:111], v[12:15], v[156:159], v[108:111]
  ds_read_b128 v[92:95], v72 offset:49152
  ds_read_b128 v[96:99], v72 offset:53248
  v_mfma_f32_32x32x16_bf16 v[160:175], v[136:139], a[112:115], v[160:175]
  ds_read_b128 a[124:127], v63 offset:49152
  ds_read_b128 a[252:255], v63 offset:53248
  ds_read_b64_tr_b16 v[120:121], v8 offset:55296
  ds_read_b64_tr_b16 v[122:123], v8 offset:55808
  v_mfma_f32_32x32x16_bf16 v[176:191], v[136:139], a[240:243], v[176:191]
  v_add_u32_e64 v56, s63, v8
  ds_read_b64_tr_b16 v[152:153], v56 offset:49152
  ds_read_b64_tr_b16 v[154:155], v56 offset:49664
  ds_read_b64_tr_b16 v[156:157], v56 offset:53248
  ds_read_b64_tr_b16 v[158:159], v56 offset:53760
  v_mfma_f32_32x32x16_bf16 v[192:207], v[140:143], a[112:115], v[192:207]
  ds_read_b64_tr_b16 v[124:125], v8 offset:47104
  v_mfma_f32_32x32x16_bf16 v[208:223], v[140:143], a[240:243], v[208:223]
  ds_read_b64_tr_b16 v[126:127], v8 offset:47616
s_waitcnt vmcnt(14)
  s_barrier
  v_mfma_f32_32x32x16_bf16 v[160:175], v[144:147], a[116:119], v[160:175]
  s_add_u32 s43, s39, 229376
  s_add_u32 m0, s42, 122880
s_nop 0
s_nop 0
  buffer_load_dwordx4 v1, s[20:23], s43 offen lds
  buffer_load_dwordx4 v2, s[20:23], s43 offen offset:1024 lds
  ds_read_b64_tr_b16 v[128:129], v8 offset:32768
  v_mfma_f32_32x32x16_bf16 v[176:191], v[144:147], a[244:247], v[176:191]
  ds_read_b64_tr_b16 v[130:131], v8 offset:33280
s_waitcnt lgkmcnt(6)
s_nop 0
  v_mfma_f32_16x16x32_bf16 v[24:27], v[12:15], v[152:155], v[24:27]
  v_dot2c_f32_bf16 v80, s55, v92
  v_dot2c_f32_bf16 v82, v92, v92
  v_dot2c_f32_bf16 v84, s55, v96
  v_dot2c_f32_bf16 v86, v96, v96
  v_dot2c_f32_bf16 v81, s55, v93
  v_dot2c_f32_bf16 v83, v93, v93
  v_dot2c_f32_bf16 v85, s55, v97
  v_dot2c_f32_bf16 v87, v97, v97
  v_dot2c_f32_bf16 v80, s55, v94
  v_dot2c_f32_bf16 v82, v94, v94
  v_dot2c_f32_bf16 v84, s55, v98
  v_dot2c_f32_bf16 v86, v98, v98
  v_dot2c_f32_bf16 v81, s55, v95
  v_dot2c_f32_bf16 v83, v95, v95
  v_dot2c_f32_bf16 v85, s55, v99
  v_dot2c_f32_bf16 v87, v99, v99
  v_mfma_f32_32x32x16_bf16 v[192:207], v[148:151], a[116:119], v[192:207]
  s_add_u32 s43, s39, 458752
  s_add_u32 m0, s42, 40960
s_nop 0
s_nop 0
  buffer_load_dwordx4 v1, s[20:23], s43 offen lds
  buffer_load_dwordx4 v2, s[20:23], s43 offen offset:1024 lds
  ds_read_b64_tr_b16 v[132:133], v8 offset:34816
  v_mfma_f32_32x32x16_bf16 v[208:223], v[148:151], a[244:247], v[208:223]
  ds_read_b64_tr_b16 v[134:135], v8 offset:35328
s_waitcnt lgkmcnt(6)
s_nop 0
  v_mfma_f32_16x16x32_bf16 v[24:27], v[12:15], v[156:159], v[24:27]
  ds_read_b128 v[100:103], v73 offset:49152
  ds_read_b128 v[104:107], v73 offset:53248
  v_mfma_f32_32x32x16_bf16 v[160:175], v[112:115], a[120:123], v[160:175]
  s_add_u32 s43, s39, 688128
  s_add_u32 m0, s42, 32768
s_nop 0
s_nop 0
  buffer_load_dwordx4 v1, s[20:23], s43 offen lds
  buffer_load_dwordx4 v2, s[20:23], s43 offen offset:1024 lds
  ds_read_b64_tr_b16 v[136:137], v8 offset:36864
  ds_read_b64_tr_b16 v[138:139], v8 offset:37376
  v_add_u32_e64 v56, s63, v8
  v_mfma_f32_32x32x16_bf16 v[176:191], v[112:115], a[248:251], v[176:191]
  ds_read_b64_tr_b16 v[152:153], v56 offset:40960
  ds_read_b64_tr_b16 v[154:155], v56 offset:41472
  ds_read_b64_tr_b16 v[156:157], v56 offset:45056
  ds_read_b64_tr_b16 v[158:159], v56 offset:45568
  v_mfma_f32_32x32x16_bf16 v[192:207], v[116:119], a[120:123], v[192:207]
  s_add_u32 s43, s39, 917504
  s_add_u32 m0, s42, 24576
s_nop 0
s_nop 0
  buffer_load_dwordx4 v1, s[20:23], s43 offen lds
  buffer_load_dwordx4 v2, s[20:23], s43 offen offset:1024 lds
  ds_read_b64_tr_b16 v[140:141], v8 offset:38912
  v_mfma_f32_32x32x16_bf16 v[208:223], v[116:119], a[248:251], v[208:223]
  ds_read_b64_tr_b16 v[142:143], v8 offset:39424
  v_mfma_f32_32x32x16_bf16 v[160:175], v[120:123], a[124:127], v[160:175]
  ds_read_b64_tr_b16 v[144:145], v8 offset:24576
  v_mfma_f32_32x32x16_bf16 v[176:191], v[120:123], a[252:255], v[176:191]
  ds_read_b64_tr_b16 v[146:147], v8 offset:25088
s_waitcnt lgkmcnt(6)
s_nop 0
  v_mfma_f32_16x16x32_bf16 v[108:111], v[12:15], v[152:155], v[108:111]
  v_dot2c_f32_bf16 v80, s55, v100
  v_dot2c_f32_bf16 v82, v100, v100
  v_dot2c_f32_bf16 v84, s55, v104
  v_dot2c_f32_bf16 v86, v104, v104
  v_dot2c_f32_bf16 v81, s55, v101
  v_dot2c_f32_bf16 v83, v101, v101
  v_dot2c_f32_bf16 v85, s55, v105
  v_dot2c_f32_bf16 v87, v105, v105
  v_dot2c_f32_bf16 v80, s55, v102
  v_dot2c_f32_bf16 v82, v102, v102
  v_dot2c_f32_bf16 v84, s55, v106
  v_dot2c_f32_bf16 v86, v106, v106
  v_dot2c_f32_bf16 v81, s55, v103
  v_dot2c_f32_bf16 v83, v103, v103
  v_dot2c_f32_bf16 v85, s55, v107
  v_dot2c_f32_bf16 v87, v107, v107
  v_mfma_f32_32x32x16_bf16 v[192:207], v[124:127], a[124:127], v[192:207]
  ds_read_b64_tr_b16 v[148:149], v8 offset:26624
  v_mfma_f32_32x32x16_bf16 v[208:223], v[124:127], a[252:255], v[208:223]
  ds_read_b64_tr_b16 v[150:151], v8 offset:27136
s_waitcnt lgkmcnt(6)
s_nop 0
  v_mfma_f32_16x16x32_bf16 v[108:111], v[12:15], v[156:159], v[108:111]
  ds_write_b32 v41, v24 offset:4096
s_nop 6
s_nop 0
  ds_write_b32 v41, v108 offset:5120
  s_lshl_b32 s62, s47, 4
  v_lshrrev_b32_e32 v49, 5, v10
  v_and_b32_e32 v49, 0x10, v49
  v_lshrrev_b32_e32 v49, 1, v49
  v_add3_u32 v49, v49, s62, v40
  v_add_f32_e32 v80, v80, v81
  v_add_f32_e32 v81, v82, v83
  ds_write_b64 v49, v[80:81] offset:0
  v_add_f32_e32 v84, v84, v85
  v_add_f32_e32 v85, v86, v87
  ds_write_b64 v49, v[84:85] offset:1024
  v_mfma_f32_32x32x16_bf16 v[224:239], v[128:131], a[0:3], 0
  ds_read_b64_tr_b16 v[112:113], v8 offset:28672
  ds_read_b64_tr_b16 v[114:115], v8 offset:29184
  v_add_u32_e64 v56, s63, v8
  v_mfma_f32_32x32x16_bf16 v[240:255], v[128:131], a[128:131], 0
  ds_read_b64_tr_b16 v[152:153], v56 offset:32768
  ds_read_b64_tr_b16 v[154:155], v56 offset:33280
  ds_read_b64_tr_b16 v[156:157], v56 offset:36864
  ds_read_b64_tr_b16 v[158:159], v56 offset:37376
  v_mfma_f32_32x32x16_bf16 v[224:239], v[132:135], a[4:7], v[224:239]
  ds_read_b64_tr_b16 v[116:117], v8 offset:30720
  v_mfma_f32_32x32x16_bf16 v[240:255], v[132:135], a[132:135], v[240:255]
  ds_read_b64_tr_b16 v[118:119], v8 offset:31232
s_waitcnt lgkmcnt(0)
s_waitcnt vmcnt(18)
  s_barrier
s_nop 0
  v_mfma_f32_32x32x16_bf16 v[224:239], v[136:139], a[8:11], v[224:239]
  s_add_u32 s43, s39, 1146880
  s_add_u32 m0, s42, 114688
s_nop 0
s_nop 0
  buffer_load_dwordx4 v1, s[20:23], s43 offen lds
  buffer_load_dwordx4 v2, s[20:23], s43 offen offset:1024 lds
  ds_read_b64_tr_b16 v[120:121], v8 offset:16384
  ds_read_b64_tr_b16 v[122:123], v8 offset:16896
  ds_read_b128 v[92:95], v40 offset:0
  v_mfma_f32_32x32x16_bf16 v[240:255], v[136:139], a[136:139], v[240:255]
  ds_read_b128 v[96:99], v40 offset:16
  ds_read_b128 v[100:103], v40 offset:1024
  ds_read_b128 v[104:107], v40 offset:1040
  v_mfma_f32_16x16x32_bf16 v[24:27], v[12:15], v[152:155], 0
  v_mfma_f32_32x32x16_bf16 v[224:239], v[140:143], a[12:15], v[224:239]
  s_add_u32 s43, s39, 1376256
  s_add_u32 m0, s42, 106496
s_nop 0
s_nop 0
  buffer_load_dwordx4 v1, s[20:23], s43 offen lds
  buffer_load_dwordx4 v2, s[20:23], s43 offen offset:1024 lds
  ds_read_b64_tr_b16 v[124:125], v8 offset:18432
  ds_read_b64_tr_b16 v[126:127], v8 offset:18944
s_waitcnt lgkmcnt(5)
  v_add_f32_e32 v92, v92, v94
s_waitcnt lgkmcnt(3)
  v_add_f32_e32 v100, v100, v102
  v_add_f32_e64 v93, v93, v95
  v_mfma_f32_32x32x16_bf16 v[240:255], v[140:143], a[140:143], v[240:255]
  v_add_f32_e32 v101, v101, v103
  v_add_f32_e32 v96, v96, v98
s_waitcnt lgkmcnt(2)
  v_add_f32_e32 v104, v104, v106
  v_add_f32_e32 v97, v97, v99
  v_add_f32_e32 v105, v105, v107
  v_mfma_f32_16x16x32_bf16 v[24:27], v[12:15], v[156:159], v[24:27]
  v_mfma_f32_32x32x16_bf16 v[224:239], v[144:147], a[16:19], v[224:239]
  s_add_u32 s43, s39, 1605632
  s_add_u32 m0, s42, 57344
s_nop 0
s_nop 0
  buffer_load_dwordx4 v1, s[20:23], s43 offen lds
  buffer_load_dwordx4 v2, s[20:23], s43 offen offset:1024 lds
  ds_read_b64_tr_b16 v[128:129], v8 offset:20480
  ds_read_b64_tr_b16 v[130:131], v8 offset:20992
  v_add_u32_e64 v56, s63, v8
  ds_read_b64_tr_b16 v[152:153], v56 offset:24576
  ds_read_b64_tr_b16 v[154:155], v56 offset:25088
  ds_read_b64_tr_b16 v[156:157], v56 offset:28672
  ds_read_b64_tr_b16 v[158:159], v56 offset:29184
  v_mfma_f32_32x32x16_bf16 v[240:255], v[144:147], a[144:147], v[240:255]
  v_add_f32_e32 v92, v92, v96
  v_add_f32_e32 v100, v100, v104
  v_add_f32_e32 v93, v93, v97
  v_add_f32_e32 v101, v101, v105
  v_mul_f32_e32 v92, s44, v92
  v_mul_f32_e32 v100, s44, v100
  v_mul_f32_e32 v93, s44, v93
  v_mul_f32_e32 v101, s44, v101
  v_mfma_f32_32x32x16_bf16 v[224:239], v[148:151], a[20:23], v[224:239]
  s_add_u32 s43, s40, 0
s_nop 0
  s_add_u32 m0, s42, 49152
s_nop 0
s_nop 0
  buffer_load_dwordx4 v3, s[12:15], s43 offen lds
  buffer_load_dwordx4 v4, s[12:15], s43 offen offset:1024 lds
  ds_read_b64_tr_b16 v[132:133], v8 offset:22528
  ds_read_b64_tr_b16 v[134:135], v8 offset:23040
  v_fma_f32 v93, -v92, v92, v93
  v_fma_f32 v101, -v100, v100, v101
  v_max_f32_e64 v93, 0, v93
  v_mfma_f32_32x32x16_bf16 v[240:255], v[148:151], a[148:151], v[240:255]
  v_max_f32_e64 v101, 0, v101
  v_cvt_pk_bf16_f32 v94, v92, v93
  v_cvt_pk_bf16_f32 v102, v100, v101
  v_and_b32_e32 v93, s46, v94
  v_and_b32_e32 v101, s46, v102
  v_mfma_f32_32x32x16_bf16 v[224:239], v[112:115], a[24:27], v[224:239]
  ds_read_b64_tr_b16 v[136:137], v8 offset:8192
  ds_read_b64_tr_b16 v[138:139], v8 offset:8704
  v_lshlrev_b32_e32 v92, 16, v94
  v_lshlrev_b32_e32 v100, 16, v102
  v_add_f32_e32 v93, 0x3727c5ac, v93
  v_mfma_f32_32x32x16_bf16 v[240:255], v[112:115], a[152:155], v[240:255]
  v_add_f32_e32 v101, 0x3727c5ac, v101
  v_mul_f32_e32 v92, v92, v45
  v_mul_f32_e32 v100, v100, v45
  v_cvt_pk_bf16_f32 v93, v93, v93
  v_cvt_pk_bf16_f32 v101, v101, v101
s_waitcnt lgkmcnt(6)
s_nop 0
  v_mfma_f32_16x16x32_bf16 v[24:27], v[12:15], v[152:155], v[24:27]
  v_mfma_f32_32x32x16_bf16 v[224:239], v[116:119], a[28:31], v[224:239]
  ds_read_b64_tr_b16 v[140:141], v8 offset:10240
  ds_read_b64_tr_b16 v[142:143], v8 offset:10752
  v_cvt_pk_bf16_f32 v28, v92, v92
  v_cvt_pk_bf16_f32 v32, v100, v100
  v_mfma_f32_32x32x16_bf16 v[240:255], v[116:119], a[156:159], v[240:255]
  v_and_b32_e32 v93, s46, v93
  v_and_b32_e32 v101, s46, v101
  v_sqrt_f32_e32 v93, v93
  v_sqrt_f32_e32 v101, v101
  v_mov_b32_e32 v29, 0
s_waitcnt lgkmcnt(6)
  v_mfma_f32_16x16x32_bf16 v[24:27], v[12:15], v[156:159], v[24:27]
  v_mfma_f32_32x32x16_bf16 v[224:239], v[120:123], a[32:35], v[224:239]
  ds_read_b64_tr_b16 v[144:145], v8 offset:12288
  ds_read_b64_tr_b16 v[146:147], v8 offset:12800
  v_add_u32_e64 v56, s63, v8
  ds_read_b64_tr_b16 v[152:153], v56 offset:16384
  ds_read_b64_tr_b16 v[154:155], v56 offset:16896
  ds_read_b64_tr_b16 v[156:157], v56 offset:20480
  ds_read_b64_tr_b16 v[158:159], v56 offset:20992
  v_mfma_f32_32x32x16_bf16 v[240:255], v[120:123], a[160:163], v[240:255]
  v_mov_b32_e32 v33, 0
  v_mov_b32_e32 v30, 0
  v_mov_b32_e64 v34, 0
  v_cvt_pk_bf16_f32 v93, v93, v93
  v_cvt_pk_bf16_f32 v101, v101, v101
  v_mov_b32_e32 v31, 0
  v_mov_b32_e32 v35, 0
  v_mfma_f32_32x32x16_bf16 v[224:239], v[124:127], a[36:39], v[224:239]
  ds_read_b64_tr_b16 v[148:149], v8 offset:14336
  ds_read_b64_tr_b16 v[150:151], v8 offset:14848
  v_and_b32_e32 v18, s46, v93
  v_and_b32_e32 v19, s46, v101
  v_mfma_f32_32x32x16_bf16 v[240:255], v[124:127], a[164:167], v[240:255]
  v_rcp_f32_e32 v22, v18
  v_rcp_f32_e32 v23, v19
  v_mov_b32_e32 v37, 0
  v_mov_b32_e32 v38, 0
  v_mov_b32_e32 v39, 0
s_waitcnt vmcnt(22)
  s_barrier
s_nop 0
  v_mfma_f32_32x32x16_bf16 v[224:239], v[128:131], a[40:43], v[224:239]
  s_add_u32 s43, s40, 196608
  s_add_u32 m0, s42, 98304
s_nop 0
s_nop 0
  buffer_load_dwordx4 v3, s[12:15], s43 offen lds
  buffer_load_dwordx4 v4, s[12:15], s43 offen offset:1024 lds
  ds_read_b64_tr_b16 v[112:113], v8 offset:0
  ds_read_b64_tr_b16 v[114:115], v8 offset:512
  v_mov_b32_e64 v39, 0
  v_mul_f32_e32 v16, 0xbfb8aa3b, v22
  v_mfma_f32_32x32x16_bf16 v[240:255], v[128:131], a[168:171], v[240:255]
  v_mul_f32_e32 v17, 0xbfb8aa3b, v23
  v_mul_f32_e32 v20, s56, v22
  v_mul_f32_e32 v21, s56, v23
  ds_read_b64 v[48:49], v42 offset:4096
s_waitcnt lgkmcnt(7)
s_nop 0
  v_mfma_f32_16x16x32_bf16 v[24:27], v[12:15], v[152:155], v[24:27]
  v_mfma_f32_32x32x16_bf16 v[224:239], v[132:135], a[44:47], v[224:239]
  s_add_u32 s43, s40, 393216
  s_add_u32 m0, s42, 90112
s_nop 0
s_nop 0
  buffer_load_dwordx4 v3, s[12:15], s43 offen lds
  buffer_load_dwordx4 v4, s[12:15], s43 offen offset:1024 lds
  ds_read_b64_tr_b16 v[116:117], v8 offset:2048
  ds_read_b64_tr_b16 v[118:119], v8 offset:2560
s_waitcnt lgkmcnt(2)
  v_add_f32_e32 v48, v48, v49
  v_cvt_pk_bf16_f32 v49, v48, v48
  v_mfma_f32_32x32x16_bf16 v[240:255], v[132:135], a[172:175], v[240:255]
  v_and_b32_e32 v49, s46, v49
  v_sub_f32_e32 v49, v48, v49
  v_cvt_pk_bf16_f32 v36, v48, v49
  s_cmp_ge_u32 s2, 144
  s_cbranch_scc1 K1A_w2a
  s_lshl_b32 s43, s2, 14
  s_lshl_b32 s62, s57, 12
s_nop 0
  s_add_u32 m0, s62, 8192
  s_cmp_ge_u32 s2, 112
  s_cbranch_scc1 K1A_w2o
s_nop 0
  buffer_load_dwordx4 v47, s[28:31], s43 offen offset:0 lds
  s_add_u32 s43, s43, 3072
  buffer_load_dwordx4 v47, s[28:31], s43 offen offset:1024 lds
  s_add_u32 s43, s43, 3072
  buffer_load_dwordx4 v47, s[28:31], s43 offen offset:2048 lds
  s_add_u32 s43, s43, 3072
  buffer_load_dwordx4 v47, s[28:31], s43 offen offset:3072 lds
  s_add_u32 s43, s43, 3072
  s_branch K1A_w2a
s_nop 0
K1A_w2o:
  s_sub_u32 s43, s43, 1835008
  buffer_load_dwordx4 v47, s[32:35], s43 offen offset:0 lds
  s_add_u32 s43, s43, 3072
  buffer_load_dwordx4 v47, s[32:35], s43 offen offset:1024 lds
  s_add_u32 s43, s43, 3072
  buffer_load_dwordx4 v47, s[32:35], s43 offen offset:2048 lds
  s_add_u32 s43, s43, 3072
  buffer_load_dwordx4 v47, s[32:35], s43 offen offset:3072 lds
  s_add_u32 s43, s43, 3072
K1A_w2a:
  v_mfma_f32_16x16x32_bf16 v[24:27], v[12:15], v[156:159], v[24:27]
  v_mfma_f32_32x32x16_bf16 v[224:239], v[136:139], a[48:51], v[224:239]
  ds_read_b64_tr_b16 v[120:121], v8 offset:4096
  ds_read_b64_tr_b16 v[122:123], v8 offset:4608
  v_add_u32_e64 v56, s63, v8
  ds_read_b64_tr_b16 v[152:153], v56 offset:8192
  v_mfma_f32_32x32x16_bf16 v[240:255], v[136:139], a[176:179], v[240:255]
  ds_read_b64_tr_b16 v[154:155], v56 offset:8704
  ds_read_b64_tr_b16 v[156:157], v56 offset:12288
  ds_read_b64_tr_b16 v[158:159], v56 offset:12800
  v_mfma_f32_32x32x16_bf16 v[160:175], v[36:39], v[28:31], v[160:175]
  v_mfma_f32_32x32x16_bf16 v[176:191], v[36:39], v[32:35], v[176:191]
  v_mfma_f32_32x32x16_bf16 v[224:239], v[140:143], a[52:55], v[224:239]
  ds_read_b64_tr_b16 v[124:125], v8 offset:6144
  ds_read_b64_tr_b16 v[126:127], v8 offset:6656
  ds_read_b64 v[48:49], v42 offset:5120
  v_mfma_f32_32x32x16_bf16 v[240:255], v[140:143], a[180:183], v[240:255]
s_nop 5
  v_mul_f32_e32 v160, v160, v16
  v_mul_f32_e32 v161, v161, v16
  v_mul_f32_e32 v162, v162, v16
  v_mul_f32_e64 v163, v163, v16
  v_mfma_f32_32x32x16_bf16 v[224:239], v[144:147], a[56:59], v[224:239]
  ds_read_b64_tr_b16 v[128:129], v9 offset:24576
  ds_read_b64_tr_b16 v[130:131], v9 offset:25088
s_waitcnt lgkmcnt(2)
  v_add_f32_e32 v48, v48, v49
  v_cvt_pk_bf16_f32 v49, v48, v48
  v_and_b32_e64 v49, s46, v49
  v_mfma_f32_32x32x16_bf16 v[240:255], v[144:147], a[184:187], v[240:255]
  v_sub_f32_e64 v49, v48, v49
  v_cvt_pk_bf16_f32 v36, v48, v49
  v_mul_f32_e32 v164, v164, v16
  v_mul_f32_e32 v165, v165, v16
  v_mul_f32_e32 v166, v166, v16
  v_mul_f32_e32 v167, v167, v16
  v_mfma_f32_16x16x32_bf16 v[24:27], v[12:15], v[152:155], v[24:27]
  v_mfma_f32_32x32x16_bf16 v[224:239], v[148:151], a[60:63], v[224:239]
  ds_read_b64_tr_b16 v[132:133], v9 offset:26624
  ds_read_b64_tr_b16 v[134:135], v9 offset:27136
  v_mfma_f32_32x32x16_bf16 v[192:207], v[36:39], v[28:31], v[192:207]
  v_mfma_f32_32x32x16_bf16 v[208:223], v[36:39], v[32:35], v[208:223]
  v_mfma_f32_32x32x16_bf16 v[240:255], v[148:151], a[188:191], v[240:255]
  v_exp_f32_e32 v160, v160
  v_exp_f32_e32 v161, v161
  v_exp_f32_e32 v162, v162
  v_exp_f32_e32 v163, v163
  v_mfma_f32_16x16x32_bf16 v[24:27], v[12:15], v[156:159], v[24:27]
  v_mfma_f32_32x32x16_bf16 v[224:239], v[112:115], a[64:67], v[224:239]
  ds_read_b64_tr_b16 v[136:137], v9 offset:28672
  ds_read_b64_tr_b16 v[138:139], v9 offset:29184
  v_add_u32_e64 v56, s63, v8
  ds_read_b64_tr_b16 v[152:153], v56 offset:0
  ds_read_b64_tr_b16 v[154:155], v56 offset:512
  v_mfma_f32_32x32x16_bf16 v[240:255], v[112:115], a[192:195], v[240:255]
  ds_read_b64_tr_b16 v[156:157], v56 offset:4096
  ds_read_b64_tr_b16 v[158:159], v56 offset:4608
  v_exp_f32_e32 v164, v164
  v_exp_f32_e32 v165, v165
  v_exp_f32_e32 v166, v166
  v_exp_f32_e32 v167, v167
  v_mfma_f32_32x32x16_bf16 v[224:239], v[116:119], a[68:71], v[224:239]
  ds_read_b64_tr_b16 v[140:141], v9 offset:30720
  ds_read_b64_tr_b16 v[142:143], v9 offset:31232
  v_fma_f32 v160, v160, v18, v18
  v_mfma_f32_32x32x16_bf16 v[240:255], v[116:119], a[196:199], v[240:255]
  v_fma_f32 v161, v161, v18, v18
  v_fma_f32 v162, v162, v18, v18
  v_fma_f32 v163, v163, v18, v18
s_waitcnt lgkmcnt(0)
s_waitcnt vmcnt(22)
  s_barrier
s_nop 0
  v_mfma_f32_32x32x16_bf16 v[224:239], v[120:123], a[72:75], v[224:239]
  s_add_u32 s43, s40, 589824
  s_add_u32 m0, s42, 81920
s_nop 0
s_nop 0
  buffer_load_dwordx4 v3, s[12:15], s43 offen lds
  buffer_load_dwordx4 v4, s[12:15], s43 offen offset:1024 lds
  ds_read_b64_tr_b16 v[144:145], v9 offset:16384
  ds_read_b64_tr_b16 v[146:147], v9 offset:16896
  v_fma_f32 v164, v164, v18, v18
  v_mfma_f32_32x32x16_bf16 v[240:255], v[120:123], a[200:203], v[240:255]
  v_fma_f32 v165, v165, v18, v18
  v_fma_f32 v166, v166, v18, v18
  v_fma_f32 v167, v167, v18, v18
  v_mfma_f32_16x16x32_bf16 v[24:27], v[12:15], v[152:155], v[24:27]
  v_mfma_f32_32x32x16_bf16 v[224:239], v[124:127], a[76:79], v[224:239]
  s_add_u32 s43, s40, 786432
  s_add_u32 m0, s42, 73728
s_nop 0
s_nop 0
  buffer_load_dwordx4 v3, s[12:15], s43 offen lds
  buffer_load_dwordx4 v4, s[12:15], s43 offen offset:1024 lds
  ds_read_b64_tr_b16 v[148:149], v9 offset:18432
  ds_read_b64_tr_b16 v[150:151], v9 offset:18944
  v_rcp_f32_e64 v160, v160
  v_mfma_f32_32x32x16_bf16 v[240:255], v[124:127], a[204:207], v[240:255]
  v_rcp_f32_e32 v161, v161
  v_rcp_f32_e32 v162, v162
  v_rcp_f32_e64 v163, v163
  v_mfma_f32_16x16x32_bf16 v[24:27], v[12:15], v[156:159], v[24:27]
  v_mfma_f32_32x32x16_bf16 v[224:239], v[128:131], a[80:83], v[224:239]
  ds_read_b64_tr_b16 v[112:113], v9 offset:20480
  ds_read_b64_tr_b16 v[114:115], v9 offset:20992
  v_add_u32_e64 v56, s63, v9
  ds_read_b64_tr_b16 v[152:153], v56 offset:24576
  ds_read_b64_tr_b16 v[154:155], v56 offset:25088
  v_mfma_f32_32x32x16_bf16 v[240:255], v[128:131], a[208:211], v[240:255]
  ds_read_b64_tr_b16 v[156:157], v56 offset:28672
  ds_read_b64_tr_b16 v[158:159], v56 offset:29184
  v_rcp_f32_e32 v164, v164
  v_rcp_f32_e32 v165, v165
  v_rcp_f32_e32 v166, v166
  v_rcp_f32_e32 v167, v167
  v_mfma_f32_32x32x16_bf16 v[224:239], v[132:135], a[84:87], v[224:239]
  ds_read_b64_tr_b16 v[116:117], v9 offset:22528
  ds_read_b64_tr_b16 v[118:119], v9 offset:23040
  v_mul_f32_e64 v192, v192, v160
  v_mfma_f32_32x32x16_bf16 v[240:255], v[132:135], a[212:215], v[240:255]
  v_mul_f32_e32 v193, v193, v161
  v_mul_f32_e32 v194, v194, v162
  v_mul_f32_e64 v195, v195, v163
  v_mfma_f32_32x32x16_bf16 v[224:239], v[136:139], a[88:91], v[224:239]
  ds_read_b64_tr_b16 v[120:121], v9 offset:8192
  ds_read_b64_tr_b16 v[122:123], v9 offset:8704
  v_mul_f32_e64 v196, v196, v164
  v_mfma_f32_32x32x16_bf16 v[240:255], v[136:139], a[216:219], v[240:255]
  v_mul_f32_e32 v197, v197, v165
  v_mul_f32_e32 v198, v198, v166
  v_mul_f32_e32 v199, v199, v167
s_waitcnt lgkmcnt(6)
  v_mfma_f32_16x16x32_bf16 v[24:27], v[12:15], v[152:155], v[24:27]
  v_mfma_f32_32x32x16_bf16 v[224:239], v[140:143], a[92:95], v[224:239]
  ds_read_b64_tr_b16 v[124:125], v9 offset:10240
  ds_read_b64_tr_b16 v[126:127], v9 offset:10752
  v_cvt_pk_bf16_f32 v160, v192, v193
  v_mfma_f32_32x32x16_bf16 v[240:255], v[140:143], a[220:223], v[240:255]
  v_cvt_pk_bf16_f32 v161, v194, v195
  v_cvt_pk_bf16_f32 v162, v196, v197
  v_cvt_pk_bf16_f32 v163, v198, v199
s_waitcnt lgkmcnt(6)
s_nop 0
  v_mfma_f32_16x16x32_bf16 v[24:27], v[12:15], v[156:159], v[24:27]
  v_mfma_f32_32x32x16_bf16 v[224:239], v[144:147], a[96:99], v[224:239]
  ds_read_b64_tr_b16 v[128:129], v9 offset:12288
  ds_read_b64_tr_b16 v[130:131], v9 offset:12800
  v_add_u32_e64 v56, s63, v9
  ds_read_b64_tr_b16 v[152:153], v56 offset:16384
  ds_read_b64_tr_b16 v[154:155], v56 offset:16896
  v_mfma_f32_32x32x16_bf16 v[240:255], v[144:147], a[224:227], v[240:255]
  ds_read_b64_tr_b16 v[156:157], v56 offset:20480
  ds_read_b64_tr_b16 v[158:159], v56 offset:20992
  buffer_store_dwordx4 v[160:163], v10, s[24:27], s48 offen offset:0 sc1
  v_mul_f32_e32 v168, v168, v16
  v_mul_f32_e32 v169, v169, v16
  v_mul_f32_e64 v170, v170, v16
  v_mfma_f32_32x32x16_bf16 v[224:239], v[148:151], a[100:103], v[224:239]
  ds_read_b64_tr_b16 v[132:133], v9 offset:14336
  ds_read_b64_tr_b16 v[134:135], v9 offset:14848
  v_mul_f32_e64 v171, v171, v16
  v_mfma_f32_32x32x16_bf16 v[240:255], v[148:151], a[228:231], v[240:255]
  v_mul_f32_e32 v172, v172, v16
  v_mul_f32_e32 v173, v173, v16
  v_mul_f32_e32 v174, v174, v16
s_waitcnt vmcnt(23)
  s_barrier
s_nop 0
  v_mfma_f32_32x32x16_bf16 v[224:239], v[112:115], a[104:107], v[224:239]
  s_add_u32 s43, s40, 983040
  s_add_u32 m0, s42, 155648
s_nop 0
s_nop 0
  buffer_load_dwordx4 v3, s[12:15], s43 offen lds
  buffer_load_dwordx4 v4, s[12:15], s43 offen offset:1024 lds
  ds_read_b64_tr_b16 v[136:137], v9 offset:0
  ds_read_b64_tr_b16 v[138:139], v9 offset:512
  v_mul_f32_e64 v175, v175, v16
  v_mfma_f32_32x32x16_bf16 v[240:255], v[112:115], a[232:235], v[240:255]
  v_exp_f32_e32 v168, v168
  v_exp_f32_e32 v169, v169
  v_exp_f32_e32 v170, v170
s_waitcnt lgkmcnt(6)
  v_mfma_f32_16x16x32_bf16 v[24:27], v[12:15], v[152:155], v[24:27]
  v_mfma_f32_32x32x16_bf16 v[224:239], v[116:119], a[108:111], v[224:239]
  s_add_u32 s43, s40, 1179648
  s_add_u32 m0, s42, 65536
s_nop 0
s_nop 0
  buffer_load_dwordx4 v3, s[12:15], s43 offen lds
  buffer_load_dwordx4 v4, s[12:15], s43 offen offset:1024 lds
  ds_read_b64_tr_b16 v[140:141], v9 offset:2048
  ds_read_b64_tr_b16 v[142:143], v9 offset:2560
  v_exp_f32_e64 v171, v171
  v_mfma_f32_32x32x16_bf16 v[240:255], v[116:119], a[236:239], v[240:255]
  v_exp_f32_e32 v172, v172
  v_exp_f32_e32 v173, v173
  v_exp_f32_e32 v174, v174
s_waitcnt lgkmcnt(6)
  v_mfma_f32_16x16x32_bf16 v[24:27], v[12:15], v[156:159], v[24:27]
  v_mfma_f32_32x32x16_bf16 v[224:239], v[120:123], a[112:115], v[224:239]
  ds_read_b64_tr_b16 v[144:145], v9 offset:4096
  ds_read_b64_tr_b16 v[146:147], v9 offset:4608
  v_add_u32_e64 v56, s63, v9
  ds_read_b64_tr_b16 v[152:153], v56 offset:8192
  ds_read_b64_tr_b16 v[154:155], v56 offset:8704
  v_mfma_f32_32x32x16_bf16 v[240:255], v[120:123], a[240:243], v[240:255]
  ds_read_b64_tr_b16 v[156:157], v56 offset:12288
  ds_read_b64_tr_b16 v[158:159], v56 offset:12800
  v_exp_f32_e64 v175, v175
  v_fma_f32 v168, v168, v18, v18
  v_fma_f32 v169, v169, v18, v18
  v_fma_f32 v170, v170, v18, v18
  v_mfma_f32_32x32x16_bf16 v[224:239], v[124:127], a[116:119], v[224:239]
  ds_read_b64_tr_b16 v[148:149], v9 offset:6144
  ds_read_b64_tr_b16 v[150:151], v9 offset:6656
  v_fma_f32 v171, v171, v18, v18
  v_mfma_f32_32x32x16_bf16 v[240:255], v[124:127], a[244:247], v[240:255]
  v_fma_f32 v172, v172, v18, v18
  v_fma_f32 v173, v173, v18, v18
  v_fma_f32 v174, v174, v18, v18
  v_mfma_f32_32x32x16_bf16 v[224:239], v[128:131], a[120:123], v[224:239]
  ds_read_b64_tr_b16 v[112:113], v8 offset:57344
  ds_read_b64_tr_b16 v[114:115], v8 offset:57856
  v_fma_f32 v175, v175, v18, v18
  v_mfma_f32_32x32x16_bf16 v[240:255], v[128:131], a[248:251], v[240:255]
  v_rcp_f32_e32 v168, v168
  v_rcp_f32_e32 v169, v169
  v_rcp_f32_e32 v170, v170
s_waitcnt lgkmcnt(6)
  v_mfma_f32_16x16x32_bf16 v[24:27], v[12:15], v[152:155], v[24:27]
  v_mfma_f32_32x32x16_bf16 v[224:239], v[132:135], a[124:127], v[224:239]
  ds_read_b64_tr_b16 v[116:117], v8 offset:59392
  ds_read_b64_tr_b16 v[118:119], v8 offset:59904
  v_rcp_f32_e64 v171, v171
  v_mfma_f32_32x32x16_bf16 v[240:255], v[132:135], a[252:255], v[240:255]
  v_rcp_f32_e32 v172, v172
  v_rcp_f32_e32 v173, v173
  v_rcp_f32_e32 v174, v174
s_waitcnt lgkmcnt(6)
  v_mfma_f32_16x16x32_bf16 v[24:27], v[12:15], v[156:159], v[24:27]
s_nop 7
s_nop 0
  ds_write_b32 v41, v24 offset:4096
  v_mfma_f32_32x32x16_bf16 v[60:75], v[136:139], a[0:3], 0
  ds_read_b64_tr_b16 v[120:121], v8 offset:61440
  ds_read_b64_tr_b16 v[122:123], v8 offset:61952
  v_add_u32_e64 v56, s63, v9
  ds_read_b64_tr_b16 v[152:153], v56 offset:0
  ds_read_b64_tr_b16 v[154:155], v56 offset:512
  v_mfma_f32_32x32x16_bf16 v[76:91], v[136:139], a[128:131], 0
  ds_read_b64_tr_b16 v[156:157], v56 offset:4096
  ds_read_b64_tr_b16 v[158:159], v56 offset:4608
  v_rcp_f32_e32 v175, v175
  v_mul_f32_e32 v200, v200, v168
  v_mul_f32_e32 v201, v201, v169
  v_mul_f32_e32 v202, v202, v170
  v_mfma_f32_32x32x16_bf16 v[60:75], v[140:143], a[4:7], v[60:75]
  ds_read_b64_tr_b16 v[124:125], v8 offset:63488
  ds_read_b64_tr_b16 v[126:127], v8 offset:64000
  v_mul_f32_e64 v203, v203, v171
  v_mfma_f32_32x32x16_bf16 v[76:91], v[140:143], a[132:135], v[76:91]
  v_mul_f32_e32 v204, v204, v172
  v_mul_f32_e32 v205, v205, v173
  v_mul_f32_e32 v206, v206, v174
s_waitcnt lgkmcnt(0)
s_waitcnt vmcnt(23)
  s_barrier
  v_mfma_f32_32x32x16_bf16 v[60:75], v[144:147], a[8:11], v[60:75]
  s_add_u32 s43, s40, 1376256
  s_add_u32 m0, s42, 147456
s_nop 0
s_nop 0
  buffer_load_dwordx4 v3, s[12:15], s43 offen lds
  buffer_load_dwordx4 v4, s[12:15], s43 offen offset:1024 lds
  ds_read_b64_tr_b16 v[128:129], v7 offset:40960
  ds_read_b64_tr_b16 v[130:131], v7 offset:41472
  v_mul_f32_e64 v207, v207, v175
  v_mfma_f32_32x32x16_bf16 v[76:91], v[144:147], a[136:139], v[76:91]
  v_cvt_pk_bf16_f32 v168, v200, v201
  v_cvt_pk_bf16_f32 v169, v202, v203
  v_cvt_pk_bf16_f32 v170, v204, v205
  ds_read_b64 v[48:49], v42 offset:4096
  v_mfma_f32_16x16x32_bf16 v[24:27], v[12:15], v[152:155], 0
  v_mfma_f32_32x32x16_bf16 v[60:75], v[148:151], a[12:15], v[60:75]
  ds_read_b64_tr_b16 v[132:133], v7 offset:43008
  ds_read_b64_tr_b16 v[134:135], v7 offset:43520
  v_cvt_pk_bf16_f32 v171, v206, v207
  buffer_store_dwordx4 v[168:171], v10, s[24:27], s48 offen offset:1024 sc1
  v_mfma_f32_32x32x16_bf16 v[76:91], v[148:151], a[140:143], v[76:91]
  v_mul_f32_e32 v176, v176, v17
  v_mul_f32_e32 v177, v177, v17
s_waitcnt lgkmcnt(2)
  v_add_f32_e32 v48, v48, v49
  v_cvt_pk_bf16_f32 v49, v48, v48
  v_and_b32_e64 v49, s46, v49
  v_mfma_f32_16x16x32_bf16 v[24:27], v[12:15], v[156:159], v[24:27]
  v_mfma_f32_32x32x16_bf16 v[60:75], v[112:115], a[16:19], v[60:75]
  ds_read_b64_tr_b16 v[136:137], v7 offset:45056
  ds_read_b64_tr_b16 v[138:139], v7 offset:45568
  v_add_u32_e64 v56, s63, v8
  ds_read_b64_tr_b16 v[152:153], v56 offset:57344
  ds_read_b64_tr_b16 v[154:155], v56 offset:57856
  ds_read_b64_tr_b16 v[156:157], v56 offset:61440
  v_mfma_f32_32x32x16_bf16 v[76:91], v[112:115], a[144:147], v[76:91]
  ds_read_b64_tr_b16 v[158:159], v56 offset:61952
  v_mul_f32_e32 v178, v178, v17
  v_mul_f32_e32 v179, v179, v17
  v_mul_f32_e32 v180, v180, v17
  v_mul_f32_e32 v181, v181, v17
  v_sub_f32_e64 v49, v48, v49
  v_cvt_pk_bf16_f32 v36, v48, v49
  v_mfma_f32_32x32x16_bf16 v[60:75], v[116:119], a[20:23], v[60:75]
  ds_read_b64_tr_b16 v[140:141], v7 offset:47104
  ds_read_b64_tr_b16 v[142:143], v7 offset:47616
  v_mul_f32_e64 v182, v182, v17
  v_mfma_f32_32x32x16_bf16 v[76:91], v[116:119], a[148:151], v[76:91]
  v_mul_f32_e32 v183, v183, v17
  v_exp_f32_e32 v176, v176
  v_exp_f32_e64 v177, v177
  v_mfma_f32_32x32x16_bf16 v[60:75], v[120:123], a[24:27], v[60:75]
  ds_read_b64_tr_b16 v[144:145], v7 offset:32768
  ds_read_b64_tr_b16 v[146:147], v7 offset:33280
  v_exp_f32_e32 v178, v178
  v_exp_f32_e32 v179, v179
  v_mfma_f32_32x32x16_bf16 v[76:91], v[120:123], a[152:155], v[76:91]
  v_exp_f32_e32 v180, v180
  v_exp_f32_e32 v181, v181
  v_mfma_f32_32x32x16_bf16 v[224:239], v[36:39], v[28:31], v[224:239]
  v_mfma_f32_32x32x16_bf16 v[240:255], v[36:39], v[32:35], v[240:255]
s_waitcnt lgkmcnt(6)
s_nop 0
  v_mfma_f32_16x16x32_bf16 v[24:27], v[12:15], v[152:155], v[24:27]
  v_mfma_f32_32x32x16_bf16 v[60:75], v[124:127], a[28:31], v[60:75]
  ds_read_b64_tr_b16 v[148:149], v7 offset:34816
  ds_read_b64_tr_b16 v[150:151], v7 offset:35328
  v_exp_f32_e64 v182, v182
  v_mfma_f32_32x32x16_bf16 v[76:91], v[124:127], a[156:159], v[76:91]
  v_exp_f32_e64 v183, v183
  v_fma_f32 v176, v176, v19, v19
  v_fma_f32 v177, v177, v19, v19
s_waitcnt lgkmcnt(6)
s_nop 0
  v_mfma_f32_16x16x32_bf16 v[24:27], v[12:15], v[156:159], v[24:27]
  v_mfma_f32_32x32x16_bf16 v[60:75], v[128:131], a[32:35], v[60:75]
  ds_read_b64_tr_b16 v[112:113], v7 offset:36864
  ds_read_b64_tr_b16 v[114:115], v7 offset:37376
  v_add_u32_e64 v56, s63, v7
  ds_read_b64_tr_b16 v[152:153], v56 offset:40960
  ds_read_b64_tr_b16 v[154:155], v56 offset:41472
  v_mfma_f32_32x32x16_bf16 v[76:91], v[128:131], a[160:163], v[76:91]
  ds_read_b64_tr_b16 v[156:157], v56 offset:45056
  ds_read_b64_tr_b16 v[158:159], v56 offset:45568
  v_fma_f32 v178, v178, v19, v19
  v_fma_f32 v179, v179, v19, v19
  v_fma_f32 v180, v180, v19, v19
  v_fma_f32 v181, v181, v19, v19
  v_mfma_f32_32x32x16_bf16 v[60:75], v[132:135], a[36:39], v[60:75]
  ds_read_b64_tr_b16 v[116:117], v7 offset:38912
  ds_read_b64_tr_b16 v[118:119], v7 offset:39424
  v_fma_f32 v182, v182, v19, v19
  v_mfma_f32_32x32x16_bf16 v[76:91], v[132:135], a[164:167], v[76:91]
  v_fma_f32 v183, v183, v19, v19
  v_rcp_f32_e32 v176, v176
  v_rcp_f32_e32 v177, v177
s_waitcnt vmcnt(22)
  s_barrier
  v_mfma_f32_32x32x16_bf16 v[60:75], v[136:139], a[40:43], v[60:75]
  ds_read_b64_tr_b16 v[120:121], v7 offset:24576
  ds_read_b64_tr_b16 v[122:123], v7 offset:25088
  v_rcp_f32_e64 v178, v178
  v_mfma_f32_32x32x16_bf16 v[76:91], v[136:139], a[168:171], v[76:91]
  v_rcp_f32_e32 v179, v179
  v_rcp_f32_e32 v180, v180
  v_rcp_f32_e32 v181, v181
s_waitcnt lgkmcnt(6)
  v_mfma_f32_16x16x32_bf16 v[24:27], v[12:15], v[152:155], v[24:27]
  v_mfma_f32_32x32x16_bf16 v[60:75], v[140:143], a[44:47], v[60:75]
  ds_read_b64_tr_b16 v[124:125], v7 offset:26624
  ds_read_b64_tr_b16 v[126:127], v7 offset:27136
  v_mfma_f32_32x32x16_bf16 v[76:91], v[140:143], a[172:175], v[76:91]
  v_rcp_f32_e32 v182, v182
  v_rcp_f32_e32 v183, v183
  v_mul_f32_e32 v208, v208, v176
s_waitcnt lgkmcnt(6)
  v_mfma_f32_16x16x32_bf16 v[24:27], v[12:15], v[156:159], v[24:27]
  v_mfma_f32_32x32x16_bf16 v[60:75], v[144:147], a[48:51], v[60:75]
  ds_read_b64_tr_b16 v[128:129], v7 offset:28672
  ds_read_b64_tr_b16 v[130:131], v7 offset:29184
  v_add_u32_e64 v56, s63, v7
  ds_read_b64_tr_b16 v[152:153], v56 offset:32768
  ds_read_b64_tr_b16 v[154:155], v56 offset:33280
  v_mfma_f32_32x32x16_bf16 v[76:91], v[144:147], a[176:179], v[76:91]
  ds_read_b64_tr_b16 v[156:157], v56 offset:36864
  ds_read_b64_tr_b16 v[158:159], v56 offset:37376
  v_mul_f32_e32 v209, v209, v177
  v_mul_f32_e32 v210, v210, v178
  v_mul_f32_e64 v211, v211, v179
  v_mfma_f32_32x32x16_bf16 v[60:75], v[148:151], a[52:55], v[60:75]
  ds_read_b64_tr_b16 v[132:133], v7 offset:30720
  ds_read_b64_tr_b16 v[134:135], v7 offset:31232
  v_mfma_f32_32x32x16_bf16 v[76:91], v[148:151], a[180:183], v[76:91]
  v_mul_f32_e32 v212, v212, v180
  v_mul_f32_e32 v213, v213, v181
  v_mul_f32_e64 v214, v214, v182
  v_mfma_f32_32x32x16_bf16 v[60:75], v[112:115], a[56:59], v[60:75]
  ds_read_b64_tr_b16 v[136:137], v8 offset:49152
  ds_read_b64_tr_b16 v[138:139], v8 offset:49664
  v_mfma_f32_32x32x16_bf16 v[76:91], v[112:115], a[184:187], v[76:91]
  v_mul_f32_e64 v215, v215, v183
  v_cvt_pk_bf16_f32 v176, v208, v209
  v_cvt_pk_bf16_f32 v177, v210, v211
s_waitcnt lgkmcnt(6)
s_nop 0
  v_mfma_f32_16x16x32_bf16 v[24:27], v[12:15], v[152:155], v[24:27]
  v_mfma_f32_32x32x16_bf16 v[60:75], v[116:119], a[60:63], v[60:75]
  ds_read_b64_tr_b16 v[140:141], v8 offset:51200
  ds_read_b64_tr_b16 v[142:143], v8 offset:51712
  v_mfma_f32_32x32x16_bf16 v[76:91], v[116:119], a[188:191], v[76:91]
  v_cvt_pk_bf16_f32 v178, v212, v213
  v_cvt_pk_bf16_f32 v179, v214, v215
  buffer_store_dwordx4 v[176:179], v10, s[24:27], s49 offen offset:0 sc1
s_waitcnt lgkmcnt(6)
s_nop 0
  v_mfma_f32_16x16x32_bf16 v[24:27], v[12:15], v[156:159], v[24:27]
  v_mfma_f32_32x32x16_bf16 v[60:75], v[120:123], a[64:67], v[60:75]
  ds_read_b64_tr_b16 v[144:145], v8 offset:53248
  ds_read_b64_tr_b16 v[146:147], v8 offset:53760
  v_add_u32_e64 v56, s63, v7
  ds_read_b64_tr_b16 v[152:153], v56 offset:24576
  ds_read_b64_tr_b16 v[154:155], v56 offset:25088
  v_mfma_f32_32x32x16_bf16 v[76:91], v[120:123], a[192:195], v[76:91]
  ds_read_b64_tr_b16 v[156:157], v56 offset:28672
  ds_read_b64_tr_b16 v[158:159], v56 offset:29184
  v_mul_f32_e32 v184, v184, v17
  v_mul_f32_e32 v185, v185, v17
  v_mul_f32_e64 v186, v186, v17
  v_mfma_f32_32x32x16_bf16 v[60:75], v[124:127], a[68:71], v[60:75]
  ds_read_b64_tr_b16 v[148:149], v8 offset:55296
  ds_read_b64_tr_b16 v[150:151], v8 offset:55808
  v_mfma_f32_32x32x16_bf16 v[76:91], v[124:127], a[196:199], v[76:91]
  v_mul_f32_e32 v187, v187, v17
  v_mul_f32_e32 v188, v188, v17
  v_mul_f32_e32 v189, v189, v17
s_waitcnt vmcnt(19)
  s_barrier
s_nop 0
  v_mfma_f32_32x32x16_bf16 v[60:75], v[128:131], a[72:75], v[60:75]
  ds_read_b64_tr_b16 v[112:113], v8 offset:40960
  ds_read_b64_tr_b16 v[114:115], v8 offset:41472
  v_mfma_f32_32x32x16_bf16 v[76:91], v[128:131], a[200:203], v[76:91]
  v_mul_f32_e32 v190, v190, v17
  v_mul_f32_e32 v191, v191, v17
  v_exp_f32_e32 v184, v184
s_waitcnt lgkmcnt(6)
  v_mfma_f32_16x16x32_bf16 v[24:27], v[12:15], v[152:155], v[24:27]
  v_mfma_f32_32x32x16_bf16 v[60:75], v[132:135], a[76:79], v[60:75]
  ds_read_b64_tr_b16 v[116:117], v8 offset:43008
  ds_read_b64_tr_b16 v[118:119], v8 offset:43520
  v_mfma_f32_32x32x16_bf16 v[76:91], v[132:135], a[204:207], v[76:91]
  v_exp_f32_e32 v185, v185
  v_exp_f32_e32 v186, v186
  v_exp_f32_e32 v187, v187
s_waitcnt lgkmcnt(6)
  v_mfma_f32_16x16x32_bf16 v[24:27], v[12:15], v[156:159], v[24:27]
  v_mfma_f32_32x32x16_bf16 v[60:75], v[136:139], a[80:83], v[60:75]
  ds_read_b64_tr_b16 v[120:121], v8 offset:45056
  ds_read_b64_tr_b16 v[122:123], v8 offset:45568
  v_add_u32_e64 v56, s63, v8
  ds_read_b64_tr_b16 v[152:153], v56 offset:49152
  ds_read_b64_tr_b16 v[154:155], v56 offset:49664
  v_mfma_f32_32x32x16_bf16 v[76:91], v[136:139], a[208:211], v[76:91]
  ds_read_b64_tr_b16 v[156:157], v56 offset:53248
  ds_read_b64_tr_b16 v[158:159], v56 offset:53760
  v_exp_f32_e32 v188, v188
  v_exp_f32_e32 v189, v189
  v_exp_f32_e64 v190, v190
  v_mfma_f32_32x32x16_bf16 v[60:75], v[140:143], a[84:87], v[60:75]
  ds_read_b64_tr_b16 v[124:125], v8 offset:47104
  ds_read_b64_tr_b16 v[126:127], v8 offset:47616
  v_mfma_f32_32x32x16_bf16 v[76:91], v[140:143], a[212:215], v[76:91]
  v_exp_f32_e64 v191, v191
  v_fma_f32 v184, v184, v19, v19
  v_fma_f32 v185, v185, v19, v19
  v_mfma_f32_32x32x16_bf16 v[60:75], v[144:147], a[88:91], v[60:75]
  ds_read_b64_tr_b16 v[128:129], v7 offset:57344
  ds_read_b64_tr_b16 v[130:131], v7 offset:57856
  v_mfma_f32_32x32x16_bf16 v[76:91], v[144:147], a[216:219], v[76:91]
  v_fma_f32 v186, v186, v19, v19
  v_fma_f32 v187, v187, v19, v19
  v_fma_f32 v188, v188, v19, v19
s_waitcnt lgkmcnt(6)
s_nop 0
  v_mfma_f32_16x16x32_bf16 v[24:27], v[12:15], v[152:155], v[24:27]
  v_mfma_f32_32x32x16_bf16 v[60:75], v[148:151], a[92:95], v[60:75]
  ds_read_b64_tr_b16 v[132:133], v7 offset:59392
  ds_read_b64_tr_b16 v[134:135], v7 offset:59904
  v_mfma_f32_32x32x16_bf16 v[76:91], v[148:151], a[220:223], v[76:91]
  v_fma_f32 v189, v189, v19, v19
  v_fma_f32 v190, v190, v19, v19
  v_fma_f32 v191, v191, v19, v19
s_waitcnt lgkmcnt(6)
s_nop 0
  v_mfma_f32_16x16x32_bf16 v[24:27], v[12:15], v[156:159], v[24:27]
  v_mfma_f32_32x32x16_bf16 v[60:75], v[112:115], a[96:99], v[60:75]
  ds_read_b64_tr_b16 v[136:137], v7 offset:61440
  ds_read_b64_tr_b16 v[138:139], v7 offset:61952
  v_add_u32_e64 v56, s63, v8
  ds_read_b64_tr_b16 v[152:153], v56 offset:40960
  ds_read_b64_tr_b16 v[154:155], v56 offset:41472
  v_mfma_f32_32x32x16_bf16 v[76:91], v[112:115], a[224:227], v[76:91]
  ds_read_b64_tr_b16 v[156:157], v56 offset:45056
  ds_read_b64_tr_b16 v[158:159], v56 offset:45568
  v_rcp_f32_e32 v184, v184
  v_rcp_f32_e32 v185, v185
  v_rcp_f32_e64 v186, v186
  v_mfma_f32_32x32x16_bf16 v[60:75], v[116:119], a[100:103], v[60:75]
  ds_read_b64_tr_b16 v[140:141], v7 offset:63488
  ds_read_b64_tr_b16 v[142:143], v7 offset:64000
  v_mfma_f32_32x32x16_bf16 v[76:91], v[116:119], a[228:231], v[76:91]
  v_rcp_f32_e32 v187, v187
  v_rcp_f32_e32 v188, v188
  v_rcp_f32_e32 v189, v189
s_waitcnt vmcnt(15)
  s_barrier
s_nop 0
  v_mfma_f32_32x32x16_bf16 v[60:75], v[120:123], a[104:107], v[60:75]
  ds_read_b64_tr_b16 v[144:145], v7 offset:49152
  ds_read_b64_tr_b16 v[146:147], v7 offset:49664
  v_mfma_f32_32x32x16_bf16 v[76:91], v[120:123], a[232:235], v[76:91]
  v_rcp_f32_e32 v190, v190
  v_rcp_f32_e32 v191, v191
  v_mul_f32_e32 v216, v216, v184
s_waitcnt lgkmcnt(6)
  v_mfma_f32_16x16x32_bf16 v[24:27], v[12:15], v[152:155], v[24:27]
  v_mfma_f32_32x32x16_bf16 v[60:75], v[124:127], a[108:111], v[60:75]
  ds_read_b64_tr_b16 v[148:149], v7 offset:51200
  ds_read_b64_tr_b16 v[150:151], v7 offset:51712
  v_mfma_f32_32x32x16_bf16 v[76:91], v[124:127], a[236:239], v[76:91]
  v_mul_f32_e32 v217, v217, v185
  v_mul_f32_e32 v218, v218, v186
  v_mul_f32_e32 v219, v219, v187
s_waitcnt lgkmcnt(6)
  v_mfma_f32_16x16x32_bf16 v[24:27], v[12:15], v[156:159], v[24:27]
  v_mfma_f32_32x32x16_bf16 v[60:75], v[128:131], a[112:115], v[60:75]
  ds_read_b64_tr_b16 v[112:113], v7 offset:53248
  ds_read_b64_tr_b16 v[114:115], v7 offset:53760
  v_add_u32_e64 v56, s63, v7
  ds_read_b64_tr_b16 v[152:153], v56 offset:57344
  ds_read_b64_tr_b16 v[154:155], v56 offset:57856
  v_mfma_f32_32x32x16_bf16 v[76:91], v[128:131], a[240:243], v[76:91]
  ds_read_b64_tr_b16 v[156:157], v56 offset:61440
  ds_read_b64_tr_b16 v[158:159], v56 offset:61952
  v_mul_f32_e32 v220, v220, v188
  v_mul_f32_e32 v221, v221, v189
  v_mul_f32_e64 v222, v222, v190
  v_mfma_f32_32x32x16_bf16 v[60:75], v[132:135], a[116:119], v[60:75]
  ds_read_b64_tr_b16 v[116:117], v7 offset:55296
  ds_read_b64_tr_b16 v[118:119], v7 offset:55808
  v_mfma_f32_32x32x16_bf16 v[76:91], v[132:135], a[244:247], v[76:91]
  v_mul_f32_e64 v223, v223, v191
  v_cvt_pk_bf16_f32 v184, v216, v217
  v_cvt_pk_bf16_f32 v185, v218, v219
  v_mfma_f32_32x32x16_bf16 v[60:75], v[136:139], a[120:123], v[60:75]
  ds_read_b64_tr_b16 v[120:121], v8 offset:32768
  ds_read_b64_tr_b16 v[122:123], v8 offset:33280
  v_mfma_f32_32x32x16_bf16 v[76:91], v[136:139], a[248:251], v[76:91]
  v_cvt_pk_bf16_f32 v186, v220, v221
  v_cvt_pk_bf16_f32 v187, v222, v223
  buffer_store_dwordx4 v[184:187], v10, s[24:27], s49 offen offset:1024 sc1
s_waitcnt lgkmcnt(6)
s_nop 0
  v_mfma_f32_16x16x32_bf16 v[24:27], v[12:15], v[152:155], v[24:27]
  v_mfma_f32_32x32x16_bf16 v[60:75], v[140:143], a[124:127], v[60:75]
  ds_read_b64_tr_b16 v[124:125], v8 offset:34816
  v_mfma_f32_32x32x16_bf16 v[76:91], v[140:143], a[252:255], v[76:91]
  ds_read_b64_tr_b16 v[126:127], v8 offset:35328
s_waitcnt lgkmcnt(6)
s_nop 0
  v_mfma_f32_16x16x32_bf16 v[24:27], v[12:15], v[156:159], v[24:27]
s_nop 7
s_nop 0
  ds_write_b32 v41, v24 offset:5120
  v_mfma_f32_32x32x16_bf16 v[160:175], v[144:147], a[0:3], 0
  ds_read_b64_tr_b16 v[128:129], v8 offset:36864
  ds_read_b64_tr_b16 v[130:131], v8 offset:37376
  v_add_u32_e64 v56, s63, v7
  ds_read_b64_tr_b16 v[152:153], v56 offset:49152
  v_mfma_f32_32x32x16_bf16 v[176:191], v[144:147], a[128:131], 0
  ds_read_b64_tr_b16 v[154:155], v56 offset:49664
  ds_read_b64_tr_b16 v[156:157], v56 offset:53248
  ds_read_b64_tr_b16 v[158:159], v56 offset:53760
  s_cmp_ge_u32 s2, 144
  s_cbranch_scc1 K1A_w2b
s_nop 0
  s_mul_i32 s43, s57, 576
  s_add_u32 s43, s43, s2
  s_lshl_b32 s43, s43, 10
  s_add_u32 s43, s43, 15728640
  s_waitcnt vmcnt(14)
s_nop 0
  ds_read_b64_tr_b16 v[92:93], v46 offset:0
  ds_read_b64_tr_b16 v[94:95], v46 offset:2048
  ds_read_b64_tr_b16 v[96:97], v46 offset:64
  ds_read_b64_tr_b16 v[98:99], v46 offset:2112
  ds_read_b64_tr_b16 v[100:101], v46 offset:128
  ds_read_b64_tr_b16 v[102:103], v46 offset:2176
  ds_read_b64_tr_b16 v[104:105], v46 offset:192
  ds_read_b64_tr_b16 v[106:107], v46 offset:2240
s_waitcnt lgkmcnt(0)
s_nop 0
  buffer_store_dwordx4 v[92:95], v10, s[24:27], s43 offen sc1
  s_add_u32 s43, s43, 147456
  buffer_store_dwordx4 v[96:99], v10, s[24:27], s43 offen sc1
  s_add_u32 s43, s43, 147456
  buffer_store_dwordx4 v[100:103], v10, s[24:27], s43 offen sc1
  s_add_u32 s43, s43, 147456
  buffer_store_dwordx4 v[104:107], v10, s[24:27], s43 offen sc1
s_nop 1
s_nop 0
K1A_w2b:
  v_mfma_f32_32x32x16_bf16 v[160:175], v[148:151], a[4:7], v[160:175]
  ds_read_b64_tr_b16 v[132:133], v8 offset:38912
  v_mfma_f32_32x32x16_bf16 v[176:191], v[148:151], a[132:135], v[176:191]
  ds_read_b64_tr_b16 v[134:135], v8 offset:39424
s_waitcnt lgkmcnt(0)
s_waitcnt vmcnt(12)
  s_barrier
s_nop 0
  v_mfma_f32_32x32x16_bf16 v[160:175], v[112:115], a[8:11], v[160:175]
  ds_read_b64_tr_b16 v[136:137], v8 offset:24576
  v_mfma_f32_32x32x16_bf16 v[176:191], v[112:115], a[136:139], v[176:191]
  ds_read_b64_tr_b16 v[138:139], v8 offset:25088
  ds_read_b64 v[48:49], v42 offset:5120
  v_mfma_f32_16x16x32_bf16 v[24:27], v[12:15], v[152:155], 0
  v_mfma_f32_32x32x16_bf16 v[160:175], v[116:119], a[12:15], v[160:175]
  ds_read_b64_tr_b16 v[140:141], v8 offset:26624
  ds_read_b64_tr_b16 v[142:143], v8 offset:27136
  v_mfma_f32_32x32x16_bf16 v[176:191], v[116:119], a[140:143], v[176:191]
s_waitcnt lgkmcnt(2)
  v_add_f32_e32 v48, v48, v49
  v_cvt_pk_bf16_f32 v49, v48, v48
  v_and_b32_e64 v49, s46, v49
  v_mfma_f32_16x16x32_bf16 v[24:27], v[12:15], v[156:159], v[24:27]
  v_mfma_f32_32x32x16_bf16 v[160:175], v[120:123], a[16:19], v[160:175]
  ds_read_b64_tr_b16 v[144:145], v8 offset:28672
  ds_read_b64_tr_b16 v[146:147], v8 offset:29184
  v_add_u32_e64 v56, s63, v8
  ds_read_b64_tr_b16 v[152:153], v56 offset:32768
  v_mfma_f32_32x32x16_bf16 v[176:191], v[120:123], a[144:147], v[176:191]
  ds_read_b64_tr_b16 v[154:155], v56 offset:33280
  ds_read_b64_tr_b16 v[156:157], v56 offset:36864
  ds_read_b64_tr_b16 v[158:159], v56 offset:37376
  v_sub_f32_e64 v49, v48, v49
  v_cvt_pk_bf16_f32 v36, v48, v49
  v_mfma_f32_32x32x16_bf16 v[160:175], v[124:127], a[20:23], v[160:175]
  ds_read_b64_tr_b16 v[148:149], v8 offset:30720
  v_mfma_f32_32x32x16_bf16 v[176:191], v[124:127], a[148:151], v[176:191]
  ds_read_b64_tr_b16 v[150:151], v8 offset:31232
  v_mfma_f32_32x32x16_bf16 v[160:175], v[128:131], a[24:27], v[160:175]
  ds_read_b64_tr_b16 v[112:113], v8 offset:16384
  ds_read_b64_tr_b16 v[114:115], v8 offset:16896
  v_mfma_f32_32x32x16_bf16 v[60:75], v[36:39], v[28:31], v[60:75]
  v_mfma_f32_32x32x16_bf16 v[76:91], v[36:39], v[32:35], v[76:91]
  v_mul_f32_e32 v224, v224, v16
  v_mul_f32_e32 v225, v225, v16
  v_mfma_f32_32x32x16_bf16 v[176:191], v[128:131], a[152:155], v[176:191]
  v_mul_f32_e32 v226, v226, v16
  v_mul_f32_e32 v227, v227, v16
  v_mul_f32_e32 v228, v228, v16
  v_mul_f32_e32 v229, v229, v16
  v_mul_f32_e32 v230, v230, v16
  v_mul_f32_e32 v231, v231, v16
s_waitcnt lgkmcnt(6)
s_nop 0
  v_mfma_f32_16x16x32_bf16 v[24:27], v[12:15], v[152:155], v[24:27]
  v_mfma_f32_32x32x16_bf16 v[160:175], v[132:135], a[28:31], v[160:175]
  ds_read_b64_tr_b16 v[116:117], v8 offset:18432
  ds_read_b64_tr_b16 v[118:119], v8 offset:18944
  v_exp_f32_e32 v224, v224
  v_exp_f32_e32 v225, v225
  v_exp_f32_e64 v226, v226
  v_mfma_f32_32x32x16_bf16 v[176:191], v[132:135], a[156:159], v[176:191]
  v_exp_f32_e32 v227, v227
  v_exp_f32_e32 v228, v228
  v_exp_f32_e32 v229, v229
  v_exp_f32_e32 v230, v230
  v_exp_f32_e32 v231, v231
s_waitcnt lgkmcnt(6)
  v_mfma_f32_16x16x32_bf16 v[24:27], v[12:15], v[156:159], v[24:27]
  v_mfma_f32_32x32x16_bf16 v[160:175], v[136:139], a[32:35], v[160:175]
  ds_read_b64_tr_b16 v[120:121], v8 offset:20480
  ds_read_b64_tr_b16 v[122:123], v8 offset:20992
  v_add_u32_e64 v56, s63, v8
  ds_read_b64_tr_b16 v[152:153], v56 offset:24576
  ds_read_b64_tr_b16 v[154:155], v56 offset:25088
  ds_read_b64_tr_b16 v[156:157], v56 offset:28672
  ds_read_b64_tr_b16 v[158:159], v56 offset:29184
  v_mfma_f32_32x32x16_bf16 v[176:191], v[136:139], a[160:163], v[176:191]
  v_fma_f32 v224, v224, v18, v18
  v_fma_f32 v225, v225, v18, v18
  v_fma_f32 v226, v226, v18, v18
  v_fma_f32 v227, v227, v18, v18
  v_fma_f32 v228, v228, v18, v18
  v_fma_f32 v229, v229, v18, v18
  v_fma_f32 v230, v230, v18, v18
  v_fma_f32 v231, v231, v18, v18
  v_mfma_f32_32x32x16_bf16 v[160:175], v[140:143], a[36:39], v[160:175]
  ds_read_b64_tr_b16 v[124:125], v8 offset:22528
  ds_read_b64_tr_b16 v[126:127], v8 offset:23040
  v_rcp_f32_e32 v224, v224
  v_rcp_f32_e32 v225, v225
  v_rcp_f32_e64 v226, v226
  v_mfma_f32_32x32x16_bf16 v[176:191], v[140:143], a[164:167], v[176:191]
  v_rcp_f32_e32 v227, v227
  v_rcp_f32_e32 v228, v228
  v_rcp_f32_e32 v229, v229
  v_rcp_f32_e32 v230, v230
  v_rcp_f32_e32 v231, v231
s_waitcnt vmcnt(7)
  s_barrier
s_nop 0
  v_mfma_f32_32x32x16_bf16 v[160:175], v[144:147], a[40:43], v[160:175]
  ds_read_b64_tr_b16 v[128:129], v8 offset:8192
  ds_read_b64_tr_b16 v[130:131], v8 offset:8704
  v_mul_f32_e32 v60, v60, v224
  v_mul_f32_e32 v61, v61, v225
  v_mul_f32_e64 v62, v62, v226
  v_mfma_f32_32x32x16_bf16 v[176:191], v[144:147], a[168:171], v[176:191]
  v_mul_f32_e32 v63, v63, v227
  v_mul_f32_e32 v64, v64, v228
  v_mul_f32_e32 v65, v65, v229
  v_mul_f32_e32 v66, v66, v230
  v_mul_f32_e32 v67, v67, v231
s_waitcnt lgkmcnt(6)
  v_mfma_f32_16x16x32_bf16 v[24:27], v[12:15], v[152:155], v[24:27]
  v_mfma_f32_32x32x16_bf16 v[160:175], v[148:151], a[44:47], v[160:175]
  ds_read_b64_tr_b16 v[132:133], v8 offset:10240
  ds_read_b64_tr_b16 v[134:135], v8 offset:10752
  v_cvt_pk_bf16_f32 v224, v60, v61
  v_cvt_pk_bf16_f32 v225, v62, v63
  v_mfma_f32_32x32x16_bf16 v[176:191], v[148:151], a[172:175], v[176:191]
  v_cvt_pk_bf16_f32 v226, v64, v65
  v_cvt_pk_bf16_f32 v227, v66, v67
  buffer_store_dwordx4 v[224:227], v10, s[24:27], s50 offen offset:0 sc1
  v_mul_f32_e32 v232, v232, v16
  v_mul_f32_e32 v233, v233, v16
s_waitcnt lgkmcnt(6)
s_nop 0
  v_mfma_f32_16x16x32_bf16 v[24:27], v[12:15], v[156:159], v[24:27]
  v_mfma_f32_32x32x16_bf16 v[160:175], v[112:115], a[48:51], v[160:175]
  ds_read_b64_tr_b16 v[136:137], v8 offset:12288
  ds_read_b64_tr_b16 v[138:139], v8 offset:12800
  v_add_u32_e64 v56, s63, v8
  ds_read_b64_tr_b16 v[152:153], v56 offset:16384
  ds_read_b64_tr_b16 v[154:155], v56 offset:16896
  ds_read_b64_tr_b16 v[156:157], v56 offset:20480
  ds_read_b64_tr_b16 v[158:159], v56 offset:20992
  v_mfma_f32_32x32x16_bf16 v[176:191], v[112:115], a[176:179], v[176:191]
  v_mul_f32_e32 v234, v234, v16
  v_mul_f32_e32 v235, v235, v16
  v_mul_f32_e32 v236, v236, v16
  v_mul_f32_e32 v237, v237, v16
  v_mul_f32_e32 v238, v238, v16
  v_mul_f32_e32 v239, v239, v16
  v_exp_f32_e64 v232, v232
  v_mfma_f32_32x32x16_bf16 v[160:175], v[116:119], a[52:55], v[160:175]
  ds_read_b64_tr_b16 v[140:141], v8 offset:14336
  ds_read_b64_tr_b16 v[142:143], v8 offset:14848
  v_exp_f32_e32 v233, v233
  v_exp_f32_e32 v234, v234
  v_mfma_f32_32x32x16_bf16 v[176:191], v[116:119], a[180:183], v[176:191]
  v_exp_f32_e32 v235, v235
  v_exp_f32_e32 v236, v236
  v_exp_f32_e32 v237, v237
  v_exp_f32_e32 v238, v238
  v_exp_f32_e64 v239, v239
  v_mfma_f32_32x32x16_bf16 v[160:175], v[120:123], a[56:59], v[160:175]
  ds_read_b64_tr_b16 v[144:145], v9 offset:24576
  ds_read_b64_tr_b16 v[146:147], v9 offset:25088
  v_fma_f32 v232, v232, v18, v18
  v_fma_f32 v233, v233, v18, v18
  v_mfma_f32_32x32x16_bf16 v[176:191], v[120:123], a[184:187], v[176:191]
  v_fma_f32 v234, v234, v18, v18
  v_fma_f32 v235, v235, v18, v18
  v_fma_f32 v236, v236, v18, v18
  v_fma_f32 v237, v237, v18, v18
  v_fma_f32 v238, v238, v18, v18
s_waitcnt lgkmcnt(6)
s_nop 0
  v_mfma_f32_16x16x32_bf16 v[24:27], v[12:15], v[152:155], v[24:27]
  v_mfma_f32_32x32x16_bf16 v[160:175], v[124:127], a[60:63], v[160:175]
  ds_read_b64_tr_b16 v[148:149], v9 offset:26624
  ds_read_b64_tr_b16 v[150:151], v9 offset:27136
  v_fma_f32 v239, v239, v18, v18
  v_rcp_f32_e64 v232, v232
  v_mfma_f32_32x32x16_bf16 v[176:191], v[124:127], a[188:191], v[176:191]
  v_rcp_f32_e32 v233, v233
  v_rcp_f32_e32 v234, v234
  v_rcp_f32_e32 v235, v235
  v_rcp_f32_e32 v236, v236
  v_rcp_f32_e32 v237, v237
s_waitcnt lgkmcnt(6)
  v_mfma_f32_16x16x32_bf16 v[24:27], v[12:15], v[156:159], v[24:27]
  v_mfma_f32_32x32x16_bf16 v[160:175], v[128:131], a[64:67], v[160:175]
  ds_read_b64_tr_b16 v[112:113], v9 offset:28672
  ds_read_b64_tr_b16 v[114:115], v9 offset:29184
  v_add_u32_e64 v56, s63, v8
  ds_read_b64_tr_b16 v[152:153], v56 offset:8192
  ds_read_b64_tr_b16 v[154:155], v56 offset:8704
  ds_read_b64_tr_b16 v[156:157], v56 offset:12288
  ds_read_b64_tr_b16 v[158:159], v56 offset:12800
  v_mfma_f32_32x32x16_bf16 v[176:191], v[128:131], a[192:195], v[176:191]
  v_rcp_f32_e32 v238, v238
  v_rcp_f32_e32 v239, v239
  v_mul_f32_e32 v68, v68, v232
  v_mul_f32_e32 v69, v69, v233
  v_mul_f32_e32 v70, v70, v234
  v_mul_f32_e32 v71, v71, v235
  v_mul_f32_e64 v72, v72, v236
  v_mfma_f32_32x32x16_bf16 v[160:175], v[132:135], a[68:71], v[160:175]
  ds_read_b64_tr_b16 v[116:117], v9 offset:30720
  ds_read_b64_tr_b16 v[118:119], v9 offset:31232
  v_mul_f32_e32 v73, v73, v237
  v_mul_f32_e32 v74, v74, v238
  v_mfma_f32_32x32x16_bf16 v[176:191], v[132:135], a[196:199], v[176:191]
  v_mul_f32_e64 v75, v75, v239
  v_cvt_pk_bf16_f32 v232, v68, v69
  v_cvt_pk_bf16_f32 v233, v70, v71
  v_cvt_pk_bf16_f32 v234, v72, v73
  v_cvt_pk_bf16_f32 v235, v74, v75
s_waitcnt vmcnt(4)
  s_barrier
  v_mfma_f32_32x32x16_bf16 v[160:175], v[136:139], a[72:75], v[160:175]
  ds_read_b64_tr_b16 v[120:121], v8 offset:0
  ds_read_b64_tr_b16 v[122:123], v8 offset:512
  buffer_store_dwordx4 v[232:235], v10, s[24:27], s50 offen offset:1024 sc1
  v_mul_f32_e64 v240, v240, v17
  v_mfma_f32_32x32x16_bf16 v[176:191], v[136:139], a[200:203], v[176:191]
  v_mul_f32_e32 v241, v241, v17
  v_mul_f32_e32 v242, v242, v17
  v_mul_f32_e32 v243, v243, v17
  v_mul_f32_e32 v244, v244, v17
  v_mul_f32_e32 v245, v245, v17
s_waitcnt lgkmcnt(6)
  v_mfma_f32_16x16x32_bf16 v[24:27], v[12:15], v[152:155], v[24:27]
  v_mfma_f32_32x32x16_bf16 v[160:175], v[140:143], a[76:79], v[160:175]
  ds_read_b64_tr_b16 v[124:125], v8 offset:2048
  ds_read_b64_tr_b16 v[126:127], v8 offset:2560
  v_mul_f32_e32 v246, v246, v17
  v_mul_f32_e32 v247, v247, v17
  v_mfma_f32_32x32x16_bf16 v[176:191], v[140:143], a[204:207], v[176:191]
  v_exp_f32_e32 v240, v240
  v_exp_f32_e32 v241, v241
  v_exp_f32_e32 v242, v242
  v_exp_f32_e32 v243, v243
  v_exp_f32_e32 v244, v244
s_waitcnt lgkmcnt(6)
  v_mfma_f32_16x16x32_bf16 v[24:27], v[12:15], v[156:159], v[24:27]
  v_mfma_f32_32x32x16_bf16 v[160:175], v[144:147], a[80:83], v[160:175]
  ds_read_b64_tr_b16 v[128:129], v8 offset:4096
  ds_read_b64_tr_b16 v[130:131], v8 offset:4608
  v_add_u32_e64 v56, s63, v9
  ds_read_b64_tr_b16 v[152:153], v56 offset:24576
  ds_read_b64_tr_b16 v[154:155], v56 offset:25088
  ds_read_b64_tr_b16 v[156:157], v56 offset:28672
  ds_read_b64_tr_b16 v[158:159], v56 offset:29184
  v_mfma_f32_32x32x16_bf16 v[176:191], v[144:147], a[208:211], v[176:191]
  v_exp_f32_e32 v245, v245
  v_exp_f32_e32 v246, v246
  v_exp_f32_e64 v247, v247
  v_fma_f32 v240, v240, v19, v19
  v_fma_f32 v241, v241, v19, v19
  v_fma_f32 v242, v242, v19, v19
  v_fma_f32 v243, v243, v19, v19
  v_mfma_f32_32x32x16_bf16 v[160:175], v[148:151], a[84:87], v[160:175]
  ds_read_b64_tr_b16 v[132:133], v8 offset:6144
  ds_read_b64_tr_b16 v[134:135], v8 offset:6656
  v_fma_f32 v244, v244, v19, v19
  v_fma_f32 v245, v245, v19, v19
  v_mfma_f32_32x32x16_bf16 v[176:191], v[148:151], a[212:215], v[176:191]
  v_fma_f32 v246, v246, v19, v19
  v_fma_f32 v247, v247, v19, v19
  v_rcp_f32_e32 v240, v240
  v_rcp_f32_e32 v241, v241
  v_rcp_f32_e64 v242, v242
  v_mfma_f32_32x32x16_bf16 v[160:175], v[112:115], a[88:91], v[160:175]
  ds_read_b64_tr_b16 v[136:137], v9 offset:16384
  ds_read_b64_tr_b16 v[138:139], v9 offset:16896
  v_rcp_f32_e32 v243, v243
  v_rcp_f32_e32 v244, v244
  v_mfma_f32_32x32x16_bf16 v[176:191], v[112:115], a[216:219], v[176:191]
  v_rcp_f32_e32 v245, v245
  v_rcp_f32_e32 v246, v246
  v_rcp_f32_e32 v247, v247
  v_mul_f32_e32 v76, v76, v240
  v_mul_f32_e32 v77, v77, v241
s_waitcnt lgkmcnt(6)
  v_mfma_f32_16x16x32_bf16 v[24:27], v[12:15], v[152:155], v[24:27]
  v_mfma_f32_32x32x16_bf16 v[160:175], v[116:119], a[92:95], v[160:175]
  ds_read_b64_tr_b16 v[140:141], v9 offset:18432
  ds_read_b64_tr_b16 v[142:143], v9 offset:18944
  v_mul_f32_e32 v78, v78, v242
  v_mul_f32_e32 v79, v79, v243
  v_mfma_f32_32x32x16_bf16 v[176:191], v[116:119], a[220:223], v[176:191]
  v_mul_f32_e32 v80, v80, v244
  v_mul_f32_e32 v81, v81, v245
  v_mul_f32_e32 v82, v82, v246
  v_mul_f32_e32 v83, v83, v247
  v_cvt_pk_bf16_f32 v240, v76, v77
s_waitcnt lgkmcnt(6)
s_nop 0
  v_mfma_f32_16x16x32_bf16 v[24:27], v[12:15], v[156:159], v[24:27]
  v_mfma_f32_32x32x16_bf16 v[160:175], v[120:123], a[96:99], v[160:175]
  ds_read_b64_tr_b16 v[144:145], v9 offset:20480
  ds_read_b64_tr_b16 v[146:147], v9 offset:20992
  v_add_u32_e64 v56, s63, v8
  ds_read_b64_tr_b16 v[152:153], v56 offset:0
  ds_read_b64_tr_b16 v[154:155], v56 offset:512
  ds_read_b64_tr_b16 v[156:157], v56 offset:4096
  ds_read_b64_tr_b16 v[158:159], v56 offset:4608
  v_mfma_f32_32x32x16_bf16 v[176:191], v[120:123], a[224:227], v[176:191]
  v_cvt_pk_bf16_f32 v241, v78, v79
  v_cvt_pk_bf16_f32 v242, v80, v81
  v_cvt_pk_bf16_f32 v243, v82, v83
  buffer_store_dwordx4 v[240:243], v10, s[24:27], s51 offen offset:0 sc1
  v_mul_f32_e32 v248, v248, v17
  v_mul_f32_e32 v249, v249, v17
  v_mul_f32_e64 v250, v250, v17
  v_mfma_f32_32x32x16_bf16 v[160:175], v[124:127], a[100:103], v[160:175]
  ds_read_b64_tr_b16 v[148:149], v9 offset:22528
  ds_read_b64_tr_b16 v[150:151], v9 offset:23040
  v_mul_f32_e32 v251, v251, v17
  v_mul_f32_e32 v252, v252, v17
  v_mfma_f32_32x32x16_bf16 v[176:191], v[124:127], a[228:231], v[176:191]
  v_mul_f32_e32 v253, v253, v17
  v_mul_f32_e32 v254, v254, v17
  v_mul_f32_e32 v255, v255, v17
  v_exp_f32_e32 v248, v248
  v_exp_f32_e64 v249, v249
  v_mfma_f32_32x32x16_bf16 v[160:175], v[128:131], a[104:107], v[160:175]
  v_exp_f32_e32 v250, v250
  v_exp_f32_e32 v251, v251
  v_exp_f32_e64 v252, v252
  v_mfma_f32_32x32x16_bf16 v[176:191], v[128:131], a[232:235], v[176:191]
  v_exp_f32_e32 v253, v253
  v_exp_f32_e32 v254, v254
  v_exp_f32_e64 v255, v255
  v_fma_f32 v248, v248, v19, v19
s_waitcnt lgkmcnt(4)
s_nop 0
  v_mfma_f32_16x16x32_bf16 v[24:27], v[12:15], v[152:155], v[24:27]
  v_mfma_f32_32x32x16_bf16 v[160:175], v[132:135], a[108:111], v[160:175]
  v_fma_f32 v249, v249, v19, v19
  v_fma_f32 v250, v250, v19, v19
  v_fma_f32 v251, v251, v19, v19
  v_mfma_f32_32x32x16_bf16 v[176:191], v[132:135], a[236:239], v[176:191]
  v_fma_f32 v252, v252, v19, v19
  v_fma_f32 v253, v253, v19, v19
  v_fma_f32 v254, v254, v19, v19
  v_fma_f32 v255, v255, v19, v19
s_waitcnt lgkmcnt(2)
s_nop 0
  v_mfma_f32_16x16x32_bf16 v[24:27], v[12:15], v[156:159], v[24:27]
  v_mfma_f32_32x32x16_bf16 v[160:175], v[136:139], a[112:115], v[160:175]
  v_add_u32_e64 v56, s63, v9
  ds_read_b64_tr_b16 v[152:153], v56 offset:16384
  ds_read_b64_tr_b16 v[154:155], v56 offset:16896
  ds_read_b64_tr_b16 v[156:157], v56 offset:20480
  ds_read_b64_tr_b16 v[158:159], v56 offset:20992
  v_rcp_f32_e64 v248, v248
  v_mfma_f32_32x32x16_bf16 v[176:191], v[136:139], a[240:243], v[176:191]
  v_rcp_f32_e32 v249, v249
  v_rcp_f32_e32 v250, v250
  v_rcp_f32_e32 v251, v251
  v_rcp_f32_e32 v252, v252
  v_rcp_f32_e32 v253, v253
  v_rcp_f32_e32 v254, v254
  v_mfma_f32_32x32x16_bf16 v[160:175], v[140:143], a[116:119], v[160:175]
  v_rcp_f32_e32 v255, v255
  v_mul_f32_e32 v84, v84, v248
  v_mul_f32_e64 v85, v85, v249
  v_mfma_f32_32x32x16_bf16 v[176:191], v[140:143], a[244:247], v[176:191]
  v_mul_f32_e32 v86, v86, v250
  v_mul_f32_e32 v87, v87, v251
  v_mul_f32_e32 v88, v88, v252
  v_mul_f32_e32 v89, v89, v253
  v_mfma_f32_32x32x16_bf16 v[160:175], v[144:147], a[120:123], v[160:175]
  v_mul_f32_e32 v90, v90, v254
  v_mul_f32_e32 v91, v91, v255
  v_cvt_pk_bf16_f32 v248, v84, v85
  v_mfma_f32_32x32x16_bf16 v[176:191], v[144:147], a[248:251], v[176:191]
  v_cvt_pk_bf16_f32 v249, v86, v87
  v_cvt_pk_bf16_f32 v250, v88, v89
  v_cvt_pk_bf16_f32 v251, v90, v91
  buffer_store_dwordx4 v[248:251], v10, s[24:27], s51 offen offset:1024 sc1
s_waitcnt lgkmcnt(2)
s_nop 0
  v_mfma_f32_16x16x32_bf16 v[24:27], v[12:15], v[152:155], v[24:27]
  v_mfma_f32_32x32x16_bf16 v[160:175], v[148:151], a[124:127], v[160:175]
  v_mfma_f32_32x32x16_bf16 v[176:191], v[148:151], a[252:255], v[176:191]
s_waitcnt lgkmcnt(0)
s_nop 0
  v_mfma_f32_16x16x32_bf16 v[24:27], v[12:15], v[156:159], v[24:27]
s_nop 7
s_nop 0
  ds_write_b32 v41, v24 offset:4096
s_waitcnt lgkmcnt(0)
  s_barrier
  ds_read_b64 v[48:49], v42 offset:4096
s_waitcnt lgkmcnt(0)
  v_add_f32_e32 v48, v48, v49
  v_cvt_pk_bf16_f32 v49, v48, v48
  v_and_b32_e32 v49, s46, v49
  v_sub_f32_e32 v49, v48, v49
  v_cvt_pk_bf16_f32 v36, v48, v49
s_nop 1
s_nop 0
  v_mfma_f32_32x32x16_bf16 v[160:175], v[36:39], v[28:31], v[160:175]
  v_mfma_f32_32x32x16_bf16 v[176:191], v[36:39], v[32:35], v[176:191]
s_nop 10
  v_mul_f32_e32 v160, v160, v20
  v_mul_f32_e32 v161, v161, v20
  v_mul_f32_e32 v162, v162, v20
  v_mul_f32_e32 v163, v163, v20
  v_mul_f32_e32 v164, v164, v20
  v_mul_f32_e32 v165, v165, v20
  v_mul_f32_e32 v166, v166, v20
  v_mul_f32_e32 v167, v167, v20
  v_mul_f32_e32 v168, v168, v20
  v_mul_f32_e32 v169, v169, v20
  v_mul_f32_e32 v170, v170, v20
  v_mul_f32_e32 v171, v171, v20
  v_mul_f32_e32 v172, v172, v20
  v_mul_f32_e32 v173, v173, v20
  v_mul_f32_e32 v174, v174, v20
  v_mul_f32_e64 v175, v175, v20
  v_cvt_pk_bf16_f32 v160, v160, v161
  v_cvt_pk_bf16_f32 v161, v162, v163
  v_cvt_pk_bf16_f32 v162, v164, v165
  v_cvt_pk_bf16_f32 v163, v166, v167
  buffer_store_dwordx4 v[160:163], v10, s[24:27], s52 offen offset:0 sc1
  v_cvt_pk_bf16_f32 v168, v168, v169
  v_cvt_pk_bf16_f32 v169, v170, v171
  v_cvt_pk_bf16_f32 v170, v172, v173
  v_cvt_pk_bf16_f32 v171, v174, v175
  buffer_store_dwordx4 v[168:171], v10, s[24:27], s53 offen offset:0 sc1
  v_mul_f32_e32 v176, v176, v21
  v_mul_f32_e32 v177, v177, v21
  v_mul_f32_e32 v178, v178, v21
  v_mul_f32_e32 v179, v179, v21
  v_mul_f32_e32 v180, v180, v21
  v_mul_f32_e32 v181, v181, v21
  v_mul_f32_e32 v182, v182, v21
  v_mul_f32_e32 v183, v183, v21
  v_mul_f32_e32 v184, v184, v21
  v_mul_f32_e32 v185, v185, v21
  v_mul_f32_e32 v186, v186, v21
  v_mul_f32_e32 v187, v187, v21
  v_mul_f32_e32 v188, v188, v21
  v_mul_f32_e32 v189, v189, v21
  v_mul_f32_e32 v190, v190, v21
  v_mul_f32_e32 v191, v191, v21
  v_cvt_pk_bf16_f32 v176, v176, v177
  v_cvt_pk_bf16_f32 v177, v178, v179
  v_cvt_pk_bf16_f32 v178, v180, v181
  v_cvt_pk_bf16_f32 v179, v182, v183
  buffer_store_dwordx4 v[176:179], v10, s[24:27], s52 offen offset:1024 sc1
  v_cvt_pk_bf16_f32 v184, v184, v185
  v_cvt_pk_bf16_f32 v185, v186, v187
  v_cvt_pk_bf16_f32 v186, v188, v189
  v_cvt_pk_bf16_f32 v187, v190, v191
  buffer_store_dwordx4 v[184:187], v10, s[24:27], s53 offen offset:1024 sc1
  s_endpgm
s_nop 0
K1_TYPEB:
  s_add_u32 s84, s59, 24
  s_add_u32 s85, s59, 12
  s_lshl_b32 s86, s59, 1
  s_add_u32 s86, s86, 16
  s_add_u32 s87, s86, 1
  s_lshl_b32 s36, s84, 7
  s_mov_b32 s37, s36
  s_lshl_b32 s38, s86, 7
  s_lshl_b32 s39, s87, 7
  s_lshl_b32 s40, s85, 7
  s_lshl_b32 s43, s84, 1
  s_add_u32 s43, s43, s47
  s_lshl_b32 s43, s43, 1
s_nop 0
  s_mul_i32 s62, s61, 144
  s_add_u32 s43, s43, s62
  s_lshl_b32 s43, s43, 10
  s_add_u32 s48, s43, 6291456
  s_add_u32 s49, s48, 147456
  s_lshl_b32 s43, s86, 1
  s_add_u32 s43, s43, s47
  s_lshl_b32 s43, s43, 17
  s_lshl_b32 s62, s61, 10
  s_add_u32 s50, s43, s62
  s_lshl_b32 s43, s87, 1
  s_add_u32 s43, s43, s47
  s_lshl_b32 s43, s43, 17
  s_lshl_b32 s62, s61, 10
  s_add_u32 s51, s43, s62
  s_lshl_b32 s43, s85, 1
  s_add_u32 s43, s43, s47
  s_lshl_b32 s43, s43, 17
  s_lshl_b32 s62, s61, 10
  s_add_u32 s52, s43, s62
s_nop 0
  s_add_u32 s53, s52, 65536
  s_mov_b32 s56, 1.0
  s_add_u32 s43, s36, 0
  s_add_u32 m0, s42, 155648
s_nop 0
s_nop 0
  buffer_load_dwordx4 v1, s[16:19], s43 offen lds
  buffer_load_dwordx4 v2, s[16:19], s43 offen offset:1024 lds
  s_add_u32 s43, s41, 0
  s_add_u32 m0, s42, 0
s_nop 0
s_nop 0
  buffer_load_dwordx4 v5, s[8:11], s43 offen lds
  buffer_load_dwordx4 v6, s[8:11], s43 offen offset:1024 lds
  s_add_u32 s43, s41, 65536
  s_add_u32 m0, s42, 8192
s_nop 0
s_nop 0
  buffer_load_dwordx4 v5, s[8:11], s43 offen lds
  buffer_load_dwordx4 v6, s[8:11], s43 offen offset:1024 lds
  s_add_u32 s43, s37, 0
s_nop 0
  s_add_u32 m0, s42, 147456
s_nop 0
s_nop 0
  buffer_load_dwordx4 v1, s[20:23], s43 offen lds
  buffer_load_dwordx4 v2, s[20:23], s43 offen offset:1024 lds
  s_add_u32 s43, s36, 229376
  s_add_u32 m0, s42, 139264
s_nop 0
s_nop 0
  buffer_load_dwordx4 v1, s[16:19], s43 offen lds
  buffer_load_dwordx4 v2, s[16:19], s43 offen offset:1024 lds
  s_add_u32 s43, s41, 128
  s_add_u32 m0, s42, 16384
s_nop 0
s_nop 0
  buffer_load_dwordx4 v5, s[8:11], s43 offen lds
  buffer_load_dwordx4 v6, s[8:11], s43 offen offset:1024 lds
  s_add_u32 s43, s41, 65664
  s_add_u32 m0, s42, 24576
s_nop 0
s_nop 0
  buffer_load_dwordx4 v5, s[8:11], s43 offen lds
  buffer_load_dwordx4 v6, s[8:11], s43 offen offset:1024 lds
  s_add_u32 s43, s37, 229376
  s_add_u32 m0, s42, 131072
s_nop 0
s_nop 0
  buffer_load_dwordx4 v1, s[20:23], s43 offen lds
  buffer_load_dwordx4 v2, s[20:23], s43 offen offset:1024 lds
  s_add_u32 s43, s36, 458752
  s_add_u32 m0, s42, 122880
s_nop 0
s_nop 0
  buffer_load_dwordx4 v1, s[16:19], s43 offen lds
  buffer_load_dwordx4 v2, s[16:19], s43 offen offset:1024 lds
  v_lshrrev_b32_e32 v240, 4, v10
  v_lshrrev_b32_e32 v241, 3, v240
  v_and_b32_e32 v242, 7, v240
  v_lshlrev_b32_e32 v241, 10, v241
  v_lshl_add_u32 v241, v242, 7, v241
  s_lshl_b32 s43, s60, 15
  s_lshl_b32 s62, s57, 13
  s_add_u32 s43, s43, s62
  s_add_u32 s43, s43, s41
  buffer_load_dword v244, v241, s[8:11], s43 offen
  s_and_b32 s62, s58, 7
  s_lshl_b32 s62, s62, 6
  v_add_u32_e32 v242, s62, v240
  s_cmp_lg_u32 s57, 0
  s_cbranch_scc1 K1B_tch1
s_nop 0
  s_mov_b32 s43, 3584
  v_mul_lo_u32 v243, v242, s43
  buffer_load_dword v245, v243, s[20:23], s37 offen
K1B_tch1:
  s_cmp_lg_u32 s57, 1
  s_cbranch_scc1 K1B_tch2
  s_mov_b32 s43, 3072
  v_mul_lo_u32 v243, v242, s43
  buffer_load_dword v245, v243, s[12:15], s38 offen
K1B_tch2:
  s_cmp_lg_u32 s57, 2
  s_cbranch_scc1 K1B_tch3
  s_mov_b32 s43, 3072
  v_mul_lo_u32 v243, v242, s43
  buffer_load_dword v245, v243, s[12:15], s39 offen
K1B_tch3:
  s_cmp_lg_u32 s57, 3
  s_cbranch_scc1 K1B_tch4
  s_mov_b32 s43, 3072
  v_mul_lo_u32 v243, v242, s43
  buffer_load_dword v245, v243, s[12:15], s40 offen
K1B_tch4:
  v_mov_b32_e32 v80, 0
  v_mov_b32_e32 v81, 0
  v_mov_b32_e32 v82, 0
  v_mov_b32_e32 v83, 0
  v_mov_b32_e32 v84, 0
  v_mov_b32_e32 v85, 0
  v_mov_b32_e32 v86, 0
  v_mov_b32_e32 v87, 0
s_waitcnt vmcnt(11)
  s_barrier
  ds_read_b128 a[0:3], v60 offset:0
  ds_read_b128 a[128:131], v60 offset:4096
  ds_read_b64_tr_b16 v[112:113], v9 offset:24576
  ds_read_b64_tr_b16 v[114:115], v9 offset:25088
  ds_read_b64_tr_b16 v[116:117], v9 offset:16384
  ds_read_b64_tr_b16 v[118:119], v9 offset:16896
  ds_read_b128 a[4:7], v61 offset:0
  ds_read_b128 a[132:135], v61 offset:4096
  ds_read_b64_tr_b16 v[120:121], v9 offset:26624
  ds_read_b64_tr_b16 v[122:123], v9 offset:27136
  ds_read_b64_tr_b16 v[124:125], v9 offset:18432
  ds_read_b64_tr_b16 v[126:127], v9 offset:18944
  ds_read_b128 a[8:11], v62 offset:0
  ds_read_b128 a[136:139], v62 offset:4096
  ds_read_b64_tr_b16 v[128:129], v9 offset:28672
  ds_read_b64_tr_b16 v[130:131], v9 offset:29184
  ds_read_b64_tr_b16 v[132:133], v9 offset:20480
  ds_read_b64_tr_b16 v[134:135], v9 offset:20992
  ds_read_b128 v[92:95], v72 offset:0
  ds_read_b128 v[96:99], v72 offset:4096
s_waitcnt lgkmcnt(15)
s_nop 0
  v_mfma_f32_32x32x16_bf16 v[160:175], v[112:115], a[0:3], 0
  s_add_u32 s43, s41, 256
  s_add_u32 m0, s42, 32768
s_nop 0
s_nop 0
  buffer_load_dwordx4 v5, s[8:11], s43 offen lds
  buffer_load_dwordx4 v6, s[8:11], s43 offen offset:1024 lds
  ds_read_b128 a[12:15], v63 offset:0
  ds_read_b128 a[140:143], v63 offset:4096
  ds_read_b64_tr_b16 v[136:137], v9 offset:30720
  ds_read_b64_tr_b16 v[138:139], v9 offset:31232
  v_mfma_f32_32x32x16_bf16 v[176:191], v[112:115], a[128:131], 0
  v_add_u32_e64 v56, s63, v9
  ds_read_b64_tr_b16 v[152:153], v56 offset:24576
  ds_read_b64_tr_b16 v[154:155], v56 offset:25088
  ds_read_b64_tr_b16 v[156:157], v56 offset:28672
  ds_read_b64_tr_b16 v[158:159], v56 offset:29184
s_waitcnt lgkmcnt(15)
s_nop 0
  v_mfma_f32_32x32x16_bf16 v[192:207], v[116:119], a[0:3], 0
  s_add_u32 s43, s41, 65792
  s_add_u32 m0, s42, 40960
s_nop 0
s_nop 0
  buffer_load_dwordx4 v5, s[8:11], s43 offen lds
  buffer_load_dwordx4 v6, s[8:11], s43 offen offset:1024 lds
  ds_read_b64_tr_b16 v[140:141], v9 offset:22528
  v_mfma_f32_32x32x16_bf16 v[208:223], v[116:119], a[128:131], 0
  ds_read_b64_tr_b16 v[142:143], v9 offset:23040
s_waitcnt vmcnt(7)
  s_barrier
  v_mfma_f32_32x32x16_bf16 v[160:175], v[120:123], a[4:7], v[160:175]
  s_add_u32 s43, s37, 458752
  s_add_u32 m0, s42, 114688
s_nop 0
s_nop 0
  buffer_load_dwordx4 v1, s[20:23], s43 offen lds
  buffer_load_dwordx4 v2, s[20:23], s43 offen offset:1024 lds
  ds_read_b128 a[16:19], v60 offset:16384
  ds_read_b128 a[144:147], v60 offset:20480
  v_mfma_f32_32x32x16_bf16 v[176:191], v[120:123], a[132:135], v[176:191]
  ds_read_b64_tr_b16 v[144:145], v9 offset:8192
  ds_read_b64_tr_b16 v[146:147], v9 offset:8704
s_waitcnt lgkmcnt(8)
s_nop 0
  v_mfma_f32_16x16x32_bf16 v[24:27], v[12:15], v[152:155], 0
  v_dot2c_f32_bf16 v80, s55, v92
  v_dot2c_f32_bf16 v82, v92, v92
  v_dot2c_f32_bf16 v84, s55, v96
  v_dot2c_f32_bf16 v86, v96, v96
  v_dot2c_f32_bf16 v81, s55, v93
  v_dot2c_f32_bf16 v83, v93, v93
  v_dot2c_f32_bf16 v85, s55, v97
  v_dot2c_f32_bf16 v87, v97, v97
  v_dot2c_f32_bf16 v80, s55, v94
  v_dot2c_f32_bf16 v82, v94, v94
  v_dot2c_f32_bf16 v84, s55, v98
  v_dot2c_f32_bf16 v86, v98, v98
  v_dot2c_f32_bf16 v81, s55, v95
  v_dot2c_f32_bf16 v83, v95, v95
  v_dot2c_f32_bf16 v85, s55, v99
  v_dot2c_f32_bf16 v87, v99, v99
  v_mfma_f32_32x32x16_bf16 v[192:207], v[124:127], a[4:7], v[192:207]
  s_add_u32 s43, s36, 688128
  s_add_u32 m0, s42, 106496
s_nop 0
s_nop 0
  buffer_load_dwordx4 v1, s[16:19], s43 offen lds
  buffer_load_dwordx4 v2, s[16:19], s43 offen offset:1024 lds
  ds_read_b64_tr_b16 v[148:149], v9 offset:0
  v_mfma_f32_32x32x16_bf16 v[208:223], v[124:127], a[132:135], v[208:223]
  ds_read_b64_tr_b16 v[150:151], v9 offset:512
s_waitcnt lgkmcnt(8)
s_nop 0
  v_mfma_f32_16x16x32_bf16 v[24:27], v[12:15], v[156:159], v[24:27]
  ds_read_b128 v[100:103], v73 offset:0
  ds_read_b128 v[104:107], v73 offset:4096
  v_mfma_f32_32x32x16_bf16 v[160:175], v[128:131], a[8:11], v[160:175]
  s_add_u32 s43, s41, 384
  s_add_u32 m0, s42, 49152
s_nop 0
s_nop 0
  buffer_load_dwordx4 v5, s[8:11], s43 offen lds
  buffer_load_dwordx4 v6, s[8:11], s43 offen offset:1024 lds
  ds_read_b128 a[20:23], v61 offset:16384
  ds_read_b128 a[148:151], v61 offset:20480
  ds_read_b64_tr_b16 v[112:113], v9 offset:10240
  ds_read_b64_tr_b16 v[114:115], v9 offset:10752
  v_mfma_f32_32x32x16_bf16 v[176:191], v[128:131], a[136:139], v[176:191]
  v_add_u32_e64 v56, s63, v9
  ds_read_b64_tr_b16 v[152:153], v56 offset:16384
  ds_read_b64_tr_b16 v[154:155], v56 offset:16896
  ds_read_b64_tr_b16 v[156:157], v56 offset:20480
  ds_read_b64_tr_b16 v[158:159], v56 offset:20992
  v_mfma_f32_32x32x16_bf16 v[192:207], v[132:135], a[8:11], v[192:207]
  s_add_u32 s43, s41, 65920
  s_add_u32 m0, s42, 57344
s_nop 0
s_nop 0
  buffer_load_dwordx4 v5, s[8:11], s43 offen lds
  buffer_load_dwordx4 v6, s[8:11], s43 offen offset:1024 lds
  ds_read_b64_tr_b16 v[116:117], v9 offset:2048
  v_mfma_f32_32x32x16_bf16 v[208:223], v[132:135], a[136:139], v[208:223]
  ds_read_b64_tr_b16 v[118:119], v9 offset:2560
  v_mfma_f32_32x32x16_bf16 v[160:175], v[136:139], a[12:15], v[160:175]
  s_add_u32 s43, s37, 688128
  s_add_u32 m0, s42, 98304
s_nop 0
s_nop 0
  buffer_load_dwordx4 v1, s[20:23], s43 offen lds
  buffer_load_dwordx4 v2, s[20:23], s43 offen offset:1024 lds
  ds_read_b128 a[24:27], v62 offset:16384
  ds_read_b128 a[152:155], v62 offset:20480
  v_mfma_f32_32x32x16_bf16 v[176:191], v[136:139], a[140:143], v[176:191]
  ds_read_b64_tr_b16 v[120:121], v9 offset:12288
  ds_read_b64_tr_b16 v[122:123], v9 offset:12800
s_waitcnt lgkmcnt(8)
s_nop 0
  v_mfma_f32_16x16x32_bf16 v[108:111], v[12:15], v[152:155], 0
  v_dot2c_f32_bf16 v80, s55, v100
  v_dot2c_f32_bf16 v82, v100, v100
  v_dot2c_f32_bf16 v84, s55, v104
  v_dot2c_f32_bf16 v86, v104, v104
  v_dot2c_f32_bf16 v81, s55, v101
  v_dot2c_f32_bf16 v83, v101, v101
  v_dot2c_f32_bf16 v85, s55, v105
  v_dot2c_f32_bf16 v87, v105, v105
  v_dot2c_f32_bf16 v80, s55, v102
  v_dot2c_f32_bf16 v82, v102, v102
  v_dot2c_f32_bf16 v84, s55, v106
  v_dot2c_f32_bf16 v86, v106, v106
  v_dot2c_f32_bf16 v81, s55, v103
  v_dot2c_f32_bf16 v83, v103, v103
  v_dot2c_f32_bf16 v85, s55, v107
  v_dot2c_f32_bf16 v87, v107, v107
  v_mfma_f32_32x32x16_bf16 v[192:207], v[140:143], a[12:15], v[192:207]
  s_add_u32 s43, s36, 917504
  s_add_u32 m0, s42, 90112
s_nop 0
s_nop 0
  buffer_load_dwordx4 v1, s[16:19], s43 offen lds
  buffer_load_dwordx4 v2, s[16:19], s43 offen offset:1024 lds
  ds_read_b64_tr_b16 v[124:125], v9 offset:4096
  v_mfma_f32_32x32x16_bf16 v[208:223], v[140:143], a[140:143], v[208:223]
  ds_read_b64_tr_b16 v[126:127], v9 offset:4608
s_waitcnt lgkmcnt(8)
s_nop 0
  v_mfma_f32_16x16x32_bf16 v[108:111], v[12:15], v[156:159], v[108:111]
  ds_read_b128 v[92:95], v72 offset:16384
  ds_read_b128 v[96:99], v72 offset:20480
  v_mfma_f32_32x32x16_bf16 v[160:175], v[144:147], a[16:19], v[160:175]
  s_add_u32 s43, s41, 512
  s_add_u32 m0, s42, 65536
s_nop 0
s_nop 0
  buffer_load_dwordx4 v5, s[8:11], s43 offen lds
  buffer_load_dwordx4 v6, s[8:11], s43 offen offset:1024 lds
  ds_read_b128 a[28:31], v63 offset:16384
  ds_read_b128 a[156:159], v63 offset:20480
  ds_read_b64_tr_b16 v[128:129], v9 offset:14336
  ds_read_b64_tr_b16 v[130:131], v9 offset:14848
  v_mfma_f32_32x32x16_bf16 v[176:191], v[144:147], a[144:147], v[176:191]
  v_add_u32_e64 v56, s63, v9
  ds_read_b64_tr_b16 v[152:153], v56 offset:8192
  ds_read_b64_tr_b16 v[154:155], v56 offset:8704
  ds_read_b64_tr_b16 v[156:157], v56 offset:12288
  ds_read_b64_tr_b16 v[158:159], v56 offset:12800
  v_mfma_f32_32x32x16_bf16 v[192:207], v[148:151], a[16:19], v[192:207]
  s_add_u32 s43, s41, 66048
  s_add_u32 m0, s42, 73728
s_nop 0
s_nop 0
  buffer_load_dwordx4 v5, s[8:11], s43 offen lds
  buffer_load_dwordx4 v6, s[8:11], s43 offen offset:1024 lds
  ds_read_b64_tr_b16 v[132:133], v9 offset:6144
  v_mfma_f32_32x32x16_bf16 v[208:223], v[148:151], a[144:147], v[208:223]
  ds_read_b64_tr_b16 v[134:135], v9 offset:6656
s_waitcnt vmcnt(14)
  s_barrier
  v_mfma_f32_32x32x16_bf16 v[160:175], v[112:115], a[20:23], v[160:175]
  s_add_u32 s43, s37, 917504
  s_add_u32 m0, s42, 81920
s_nop 0
s_nop 0
  buffer_load_dwordx4 v1, s[20:23], s43 offen lds
  buffer_load_dwordx4 v2, s[20:23], s43 offen offset:1024 lds
  ds_read_b128 a[32:35], v60 offset:32768
  ds_read_b128 a[160:163], v60 offset:36864
  v_mfma_f32_32x32x16_bf16 v[176:191], v[112:115], a[148:151], v[176:191]
  ds_read_b64_tr_b16 v[136:137], v8 offset:57344
  ds_read_b64_tr_b16 v[138:139], v8 offset:57856
s_waitcnt lgkmcnt(8)
s_nop 0
  v_mfma_f32_16x16x32_bf16 v[24:27], v[12:15], v[152:155], v[24:27]
  v_dot2c_f32_bf16 v80, s55, v92
  v_dot2c_f32_bf16 v82, v92, v92
  v_dot2c_f32_bf16 v84, s55, v96
  v_dot2c_f32_bf16 v86, v96, v96
  v_dot2c_f32_bf16 v81, s55, v93
  v_dot2c_f32_bf16 v83, v93, v93
  v_dot2c_f32_bf16 v85, s55, v97
  v_dot2c_f32_bf16 v87, v97, v97
  v_dot2c_f32_bf16 v80, s55, v94
  v_dot2c_f32_bf16 v82, v94, v94
  v_dot2c_f32_bf16 v84, s55, v98
  v_dot2c_f32_bf16 v86, v98, v98
  v_dot2c_f32_bf16 v81, s55, v95
  v_dot2c_f32_bf16 v83, v95, v95
  v_dot2c_f32_bf16 v85, s55, v99
  v_dot2c_f32_bf16 v87, v99, v99
  v_mfma_f32_32x32x16_bf16 v[192:207], v[116:119], a[20:23], v[192:207]
  s_add_u32 s43, s36, 1146880
  s_add_u32 m0, s42, 155648
s_nop 0
s_nop 0
  buffer_load_dwordx4 v1, s[16:19], s43 offen lds
  buffer_load_dwordx4 v2, s[16:19], s43 offen offset:1024 lds
  ds_read_b64_tr_b16 v[140:141], v8 offset:49152
  v_mfma_f32_32x32x16_bf16 v[208:223], v[116:119], a[148:151], v[208:223]
  ds_read_b64_tr_b16 v[142:143], v8 offset:49664
s_waitcnt lgkmcnt(8)
s_nop 0
  v_mfma_f32_16x16x32_bf16 v[24:27], v[12:15], v[156:159], v[24:27]
  ds_read_b128 v[100:103], v73 offset:16384
  ds_read_b128 v[104:107], v73 offset:20480
  v_mfma_f32_32x32x16_bf16 v[160:175], v[120:123], a[24:27], v[160:175]
  ds_read_b128 a[36:39], v61 offset:32768
  ds_read_b128 a[164:167], v61 offset:36864
  ds_read_b64_tr_b16 v[144:145], v8 offset:59392
  ds_read_b64_tr_b16 v[146:147], v8 offset:59904
  v_mfma_f32_32x32x16_bf16 v[176:191], v[120:123], a[152:155], v[176:191]
  v_add_u32_e64 v56, s63, v9
  ds_read_b64_tr_b16 v[152:153], v56 offset:0
  ds_read_b64_tr_b16 v[154:155], v56 offset:512
  ds_read_b64_tr_b16 v[156:157], v56 offset:4096
  ds_read_b64_tr_b16 v[158:159], v56 offset:4608
  v_mfma_f32_32x32x16_bf16 v[192:207], v[124:127], a[24:27], v[192:207]
  ds_read_b64_tr_b16 v[148:149], v8 offset:51200
  v_mfma_f32_32x32x16_bf16 v[208:223], v[124:127], a[152:155], v[208:223]
  ds_read_b64_tr_b16 v[150:151], v8 offset:51712
  v_mfma_f32_32x32x16_bf16 v[160:175], v[128:131], a[28:31], v[160:175]
  ds_read_b128 a[40:43], v62 offset:32768
  ds_read_b128 a[168:171], v62 offset:36864
  v_mfma_f32_32x32x16_bf16 v[176:191], v[128:131], a[156:159], v[176:191]
  ds_read_b64_tr_b16 v[112:113], v8 offset:61440
  ds_read_b64_tr_b16 v[114:115], v8 offset:61952
s_waitcnt lgkmcnt(8)
s_nop 0
  v_mfma_f32_16x16x32_bf16 v[108:111], v[12:15], v[152:155], v[108:111]
  v_dot2c_f32_bf16 v80, s55, v100
  v_dot2c_f32_bf16 v82, v100, v100
  v_dot2c_f32_bf16 v84, s55, v104
  v_dot2c_f32_bf16 v86, v104, v104
  v_dot2c_f32_bf16 v81, s55, v101
  v_dot2c_f32_bf16 v83, v101, v101
  v_dot2c_f32_bf16 v85, s55, v105
  v_dot2c_f32_bf16 v87, v105, v105
  v_dot2c_f32_bf16 v80, s55, v102
  v_dot2c_f32_bf16 v82, v102, v102
  v_dot2c_f32_bf16 v84, s55, v106
  v_dot2c_f32_bf16 v86, v106, v106
  v_dot2c_f32_bf16 v81, s55, v103
  v_dot2c_f32_bf16 v83, v103, v103
  v_dot2c_f32_bf16 v85, s55, v107
  v_dot2c_f32_bf16 v87, v107, v107
  v_mfma_f32_32x32x16_bf16 v[192:207], v[132:135], a[28:31], v[192:207]
  ds_read_b64_tr_b16 v[116:117], v8 offset:53248
  v_mfma_f32_32x32x16_bf16 v[208:223], v[132:135], a[156:159], v[208:223]
  ds_read_b64_tr_b16 v[118:119], v8 offset:53760
s_waitcnt lgkmcnt(8)
s_nop 0
  v_mfma_f32_16x16x32_bf16 v[108:111], v[12:15], v[156:159], v[108:111]
  ds_read_b128 v[92:95], v72 offset:32768
  ds_read_b128 v[96:99], v72 offset:36864
  v_mfma_f32_32x32x16_bf16 v[160:175], v[136:139], a[32:35], v[160:175]
  ds_read_b128 a[44:47], v63 offset:32768
  ds_read_b128 a[172:175], v63 offset:36864
  ds_read_b64_tr_b16 v[120:121], v8 offset:63488
  ds_read_b64_tr_b16 v[122:123], v8 offset:64000
  v_mfma_f32_32x32x16_bf16 v[176:191], v[136:139], a[160:163], v[176:191]
  v_add_u32_e64 v56, s63, v8
  ds_read_b64_tr_b16 v[152:153], v56 offset:57344
  ds_read_b64_tr_b16 v[154:155], v56 offset:57856
  ds_read_b64_tr_b16 v[156:157], v56 offset:61440
  ds_read_b64_tr_b16 v[158:159], v56 offset:61952
  v_mfma_f32_32x32x16_bf16 v[192:207], v[140:143], a[32:35], v[192:207]
  ds_read_b64_tr_b16 v[124:125], v8 offset:55296
  v_mfma_f32_32x32x16_bf16 v[208:223], v[140:143], a[160:163], v[208:223]
  ds_read_b64_tr_b16 v[126:127], v8 offset:55808
s_waitcnt vmcnt(10)
  s_barrier
  v_mfma_f32_32x32x16_bf16 v[160:175], v[144:147], a[36:39], v[160:175]
  s_add_u32 s43, s41, 640
  s_add_u32 m0, s42, 131072
s_nop 0
s_nop 0
  buffer_load_dwordx4 v5, s[8:11], s43 offen lds
  buffer_load_dwordx4 v6, s[8:11], s43 offen offset:1024 lds
  ds_read_b128 a[48:51], v60 offset:49152
  ds_read_b128 a[176:179], v60 offset:53248
  v_mfma_f32_32x32x16_bf16 v[176:191], v[144:147], a[164:167], v[176:191]
  ds_read_b64_tr_b16 v[128:129], v8 offset:40960
  ds_read_b64_tr_b16 v[130:131], v8 offset:41472
s_waitcnt lgkmcnt(8)
s_nop 0
  v_mfma_f32_16x16x32_bf16 v[24:27], v[12:15], v[152:155], v[24:27]
  v_dot2c_f32_bf16 v80, s55, v92
  v_dot2c_f32_bf16 v82, v92, v92
  v_dot2c_f32_bf16 v84, s55, v96
  v_dot2c_f32_bf16 v86, v96, v96
  v_dot2c_f32_bf16 v81, s55, v93
  v_dot2c_f32_bf16 v83, v93, v93
  v_dot2c_f32_bf16 v85, s55, v97
  v_dot2c_f32_bf16 v87, v97, v97
  v_dot2c_f32_bf16 v80, s55, v94
  v_dot2c_f32_bf16 v82, v94, v94
  v_dot2c_f32_bf16 v84, s55, v98
  v_dot2c_f32_bf16 v86, v98, v98
  v_dot2c_f32_bf16 v81, s55, v95
  v_dot2c_f32_bf16 v83, v95, v95
  v_dot2c_f32_bf16 v85, s55, v99
  v_dot2c_f32_bf16 v87, v99, v99
  v_mfma_f32_32x32x16_bf16 v[192:207], v[148:151], a[36:39], v[192:207]
  s_add_u32 s43, s41, 66176
  s_add_u32 m0, s42, 139264
s_nop 0
s_nop 0
  buffer_load_dwordx4 v5, s[8:11], s43 offen lds
  buffer_load_dwordx4 v6, s[8:11], s43 offen offset:1024 lds
  ds_read_b64_tr_b16 v[132:133], v8 offset:32768
  v_mfma_f32_32x32x16_bf16 v[208:223], v[148:151], a[164:167], v[208:223]
  ds_read_b64_tr_b16 v[134:135], v8 offset:33280
s_waitcnt lgkmcnt(8)
s_nop 0
  v_mfma_f32_16x16x32_bf16 v[24:27], v[12:15], v[156:159], v[24:27]
  ds_read_b128 v[100:103], v73 offset:32768
  ds_read_b128 v[104:107], v73 offset:36864
  v_mfma_f32_32x32x16_bf16 v[160:175], v[112:115], a[40:43], v[160:175]
  s_add_u32 s43, s37, 1146880
  s_add_u32 m0, s42, 147456
s_nop 0
s_nop 0
  buffer_load_dwordx4 v1, s[20:23], s43 offen lds
  buffer_load_dwordx4 v2, s[20:23], s43 offen offset:1024 lds
  ds_read_b128 a[52:55], v61 offset:49152
  ds_read_b128 a[180:183], v61 offset:53248
  ds_read_b64_tr_b16 v[136:137], v8 offset:43008
  ds_read_b64_tr_b16 v[138:139], v8 offset:43520
  v_mfma_f32_32x32x16_bf16 v[176:191], v[112:115], a[168:171], v[176:191]
  v_add_u32_e64 v56, s63, v8
  ds_read_b64_tr_b16 v[152:153], v56 offset:49152
  ds_read_b64_tr_b16 v[154:155], v56 offset:49664
  ds_read_b64_tr_b16 v[156:157], v56 offset:53248
  ds_read_b64_tr_b16 v[158:159], v56 offset:53760
  v_mfma_f32_32x32x16_bf16 v[192:207], v[116:119], a[40:43], v[192:207]
  s_add_u32 s43, s36, 1376256
  s_add_u32 m0, s42, 24576
s_nop 0
s_nop 0
  buffer_load_dwordx4 v1, s[16:19], s43 offen lds
  buffer_load_dwordx4 v2, s[16:19], s43 offen offset:1024 lds
  ds_read_b64_tr_b16 v[140:141], v8 offset:34816
  v_mfma_f32_32x32x16_bf16 v[208:223], v[116:119], a[168:171], v[208:223]
  ds_read_b64_tr_b16 v[142:143], v8 offset:35328
  v_mfma_f32_32x32x16_bf16 v[160:175], v[120:123], a[44:47], v[160:175]
  ds_read_b128 a[56:59], v62 offset:49152
  ds_read_b128 a[184:187], v62 offset:53248
  v_mfma_f32_32x32x16_bf16 v[176:191], v[120:123], a[172:175], v[176:191]
  ds_read_b64_tr_b16 v[144:145], v8 offset:45056
  ds_read_b64_tr_b16 v[146:147], v8 offset:45568
s_waitcnt lgkmcnt(8)
s_nop 0
  v_mfma_f32_16x16x32_bf16 v[108:111], v[12:15], v[152:155], v[108:111]
  v_dot2c_f32_bf16 v80, s55, v100
  v_dot2c_f32_bf16 v82, v100, v100
  v_dot2c_f32_bf16 v84, s55, v104
  v_dot2c_f32_bf16 v86, v104, v104
  v_dot2c_f32_bf16 v81, s55, v101
  v_dot2c_f32_bf16 v83, v101, v101
  v_dot2c_f32_bf16 v85, s55, v105
  v_dot2c_f32_bf16 v87, v105, v105
  v_dot2c_f32_bf16 v80, s55, v102
  v_dot2c_f32_bf16 v82, v102, v102
  v_dot2c_f32_bf16 v84, s55, v106
  v_dot2c_f32_bf16 v86, v106, v106
  v_dot2c_f32_bf16 v81, s55, v103
  v_dot2c_f32_bf16 v83, v103, v103
  v_dot2c_f32_bf16 v85, s55, v107
  v_dot2c_f32_bf16 v87, v107, v107
  v_mfma_f32_32x32x16_bf16 v[192:207], v[124:127], a[44:47], v[192:207]
  ds_read_b64_tr_b16 v[148:149], v8 offset:36864
  v_mfma_f32_32x32x16_bf16 v[208:223], v[124:127], a[172:175], v[208:223]
  ds_read_b64_tr_b16 v[150:151], v8 offset:37376
s_waitcnt lgkmcnt(8)
s_nop 0
  v_mfma_f32_16x16x32_bf16 v[108:111], v[12:15], v[156:159], v[108:111]
  ds_read_b128 v[92:95], v72 offset:49152
  ds_read_b128 v[96:99], v72 offset:53248
  v_mfma_f32_32x32x16_bf16 v[160:175], v[128:131], a[48:51], v[160:175]
  ds_read_b128 a[60:63], v63 offset:49152
  ds_read_b128 a[188:191], v63 offset:53248
  ds_read_b64_tr_b16 v[112:113], v8 offset:47104
  ds_read_b64_tr_b16 v[114:115], v8 offset:47616
  v_mfma_f32_32x32x16_bf16 v[176:191], v[128:131], a[176:179], v[176:191]
  v_add_u32_e64 v56, s63, v8
  ds_read_b64_tr_b16 v[152:153], v56 offset:40960
  ds_read_b64_tr_b16 v[154:155], v56 offset:41472
  ds_read_b64_tr_b16 v[156:157], v56 offset:45056
  ds_read_b64_tr_b16 v[158:159], v56 offset:45568
  v_mfma_f32_32x32x16_bf16 v[192:207], v[132:135], a[48:51], v[192:207]
  ds_read_b64_tr_b16 v[116:117], v8 offset:38912
  v_mfma_f32_32x32x16_bf16 v[208:223], v[132:135], a[176:179], v[208:223]
  ds_read_b64_tr_b16 v[118:119], v8 offset:39424
s_waitcnt vmcnt(10)
  s_barrier
  v_mfma_f32_32x32x16_bf16 v[160:175], v[136:139], a[52:55], v[160:175]
  s_add_u32 s43, s41, 768
  s_add_u32 m0, s42, 32768
s_nop 0
s_nop 0
  buffer_load_dwordx4 v5, s[8:11], s43 offen lds
  buffer_load_dwordx4 v6, s[8:11], s43 offen offset:1024 lds
  ds_read_b128 a[64:67], v64 offset:0
  ds_read_b128 a[192:195], v64 offset:4096
  v_mfma_f32_32x32x16_bf16 v[176:191], v[136:139], a[180:183], v[176:191]
  ds_read_b64_tr_b16 v[120:121], v8 offset:24576
  ds_read_b64_tr_b16 v[122:123], v8 offset:25088
s_waitcnt lgkmcnt(8)
s_nop 0
  v_mfma_f32_16x16x32_bf16 v[24:27], v[12:15], v[152:155], v[24:27]
  v_dot2c_f32_bf16 v80, s55, v92
  v_dot2c_f32_bf16 v82, v92, v92
  v_dot2c_f32_bf16 v84, s55, v96
  v_dot2c_f32_bf16 v86, v96, v96
  v_dot2c_f32_bf16 v81, s55, v93
  v_dot2c_f32_bf16 v83, v93, v93
  v_dot2c_f32_bf16 v85, s55, v97
  v_dot2c_f32_bf16 v87, v97, v97
  v_dot2c_f32_bf16 v80, s55, v94
  v_dot2c_f32_bf16 v82, v94, v94
  v_dot2c_f32_bf16 v84, s55, v98
  v_dot2c_f32_bf16 v86, v98, v98
  v_dot2c_f32_bf16 v81, s55, v95
  v_dot2c_f32_bf16 v83, v95, v95
  v_dot2c_f32_bf16 v85, s55, v99
  v_dot2c_f32_bf16 v87, v99, v99
  v_mfma_f32_32x32x16_bf16 v[192:207], v[140:143], a[52:55], v[192:207]
  s_add_u32 s43, s41, 66304
  s_add_u32 m0, s42, 40960
s_nop 0
s_nop 0
  buffer_load_dwordx4 v5, s[8:11], s43 offen lds
  buffer_load_dwordx4 v6, s[8:11], s43 offen offset:1024 lds
  ds_read_b64_tr_b16 v[124:125], v8 offset:16384
  v_mfma_f32_32x32x16_bf16 v[208:223], v[140:143], a[180:183], v[208:223]
  ds_read_b64_tr_b16 v[126:127], v8 offset:16896
s_waitcnt lgkmcnt(8)
s_nop 0
  v_mfma_f32_16x16x32_bf16 v[24:27], v[12:15], v[156:159], v[24:27]
  ds_read_b128 v[100:103], v73 offset:49152
  ds_read_b128 v[104:107], v73 offset:53248
  v_mfma_f32_32x32x16_bf16 v[160:175], v[144:147], a[56:59], v[160:175]
  s_add_u32 s43, s37, 1376256
  s_add_u32 m0, s42, 122880
s_nop 0
s_nop 0
  buffer_load_dwordx4 v1, s[20:23], s43 offen lds
  buffer_load_dwordx4 v2, s[20:23], s43 offen offset:1024 lds
  ds_read_b128 a[68:71], v65 offset:0
  ds_read_b128 a[196:199], v65 offset:4096
  ds_read_b64_tr_b16 v[128:129], v8 offset:26624
  ds_read_b64_tr_b16 v[130:131], v8 offset:27136
  v_mfma_f32_32x32x16_bf16 v[176:191], v[144:147], a[184:187], v[176:191]
  v_add_u32_e64 v56, s63, v8
  ds_read_b64_tr_b16 v[152:153], v56 offset:32768
  ds_read_b64_tr_b16 v[154:155], v56 offset:33280
  ds_read_b64_tr_b16 v[156:157], v56 offset:36864
  ds_read_b64_tr_b16 v[158:159], v56 offset:37376
  v_mfma_f32_32x32x16_bf16 v[192:207], v[148:151], a[56:59], v[192:207]
  s_add_u32 s43, s36, 1605632
  s_add_u32 m0, s42, 114688
s_nop 0
s_nop 0
  buffer_load_dwordx4 v1, s[16:19], s43 offen lds
  buffer_load_dwordx4 v2, s[16:19], s43 offen offset:1024 lds
  ds_read_b64_tr_b16 v[132:133], v8 offset:18432
  v_mfma_f32_32x32x16_bf16 v[208:223], v[148:151], a[184:187], v[208:223]
  ds_read_b64_tr_b16 v[134:135], v8 offset:18944
  v_mfma_f32_32x32x16_bf16 v[160:175], v[112:115], a[60:63], v[160:175]
  ds_read_b128 a[72:75], v66 offset:0
  ds_read_b128 a[200:203], v66 offset:4096
  v_mfma_f32_32x32x16_bf16 v[176:191], v[112:115], a[188:191], v[176:191]
  ds_read_b64_tr_b16 v[136:137], v8 offset:28672
  ds_read_b64_tr_b16 v[138:139], v8 offset:29184
s_waitcnt lgkmcnt(8)
s_nop 0
  v_mfma_f32_16x16x32_bf16 v[108:111], v[12:15], v[152:155], v[108:111]
  v_dot2c_f32_bf16 v80, s55, v100
  v_dot2c_f32_bf16 v82, v100, v100
  v_dot2c_f32_bf16 v84, s55, v104
  v_dot2c_f32_bf16 v86, v104, v104
  v_dot2c_f32_bf16 v81, s55, v101
  v_dot2c_f32_bf16 v83, v101, v101
  v_dot2c_f32_bf16 v85, s55, v105
  v_dot2c_f32_bf16 v87, v105, v105
  v_dot2c_f32_bf16 v80, s55, v102
  v_dot2c_f32_bf16 v82, v102, v102
  v_dot2c_f32_bf16 v84, s55, v106
  v_dot2c_f32_bf16 v86, v106, v106
  v_dot2c_f32_bf16 v81, s55, v103
  v_dot2c_f32_bf16 v83, v103, v103
  v_dot2c_f32_bf16 v85, s55, v107
  v_dot2c_f32_bf16 v87, v107, v107
  v_mfma_f32_32x32x16_bf16 v[192:207], v[116:119], a[60:63], v[192:207]
  ds_read_b64_tr_b16 v[140:141], v8 offset:20480
  v_mfma_f32_32x32x16_bf16 v[208:223], v[116:119], a[188:191], v[208:223]
  ds_read_b64_tr_b16 v[142:143], v8 offset:20992
s_waitcnt lgkmcnt(8)
s_nop 0
  v_mfma_f32_16x16x32_bf16 v[108:111], v[12:15], v[156:159], v[108:111]
  ds_read_b128 v[92:95], v74 offset:0
  ds_read_b128 v[96:99], v74 offset:4096
  v_mfma_f32_32x32x16_bf16 v[160:175], v[120:123], a[64:67], v[160:175]
  ds_read_b128 a[76:79], v67 offset:0
  ds_read_b128 a[204:207], v67 offset:4096
  ds_read_b64_tr_b16 v[144:145], v8 offset:30720
  ds_read_b64_tr_b16 v[146:147], v8 offset:31232
  v_mfma_f32_32x32x16_bf16 v[176:191], v[120:123], a[192:195], v[176:191]
  v_add_u32_e64 v56, s63, v8
  ds_read_b64_tr_b16 v[152:153], v56 offset:24576
  ds_read_b64_tr_b16 v[154:155], v56 offset:25088
  ds_read_b64_tr_b16 v[156:157], v56 offset:28672
  ds_read_b64_tr_b16 v[158:159], v56 offset:29184
  v_mfma_f32_32x32x16_bf16 v[192:207], v[124:127], a[64:67], v[192:207]
  ds_read_b64_tr_b16 v[148:149], v8 offset:22528
  v_mfma_f32_32x32x16_bf16 v[208:223], v[124:127], a[192:195], v[208:223]
  ds_read_b64_tr_b16 v[150:151], v8 offset:23040
s_waitcnt vmcnt(10)
  s_barrier
  v_mfma_f32_32x32x16_bf16 v[160:175], v[128:131], a[68:71], v[160:175]
  s_add_u32 s43, s41, 896
  s_add_u32 m0, s42, 49152
s_nop 0
s_nop 0
  buffer_load_dwordx4 v5, s[8:11], s43 offen lds
  buffer_load_dwordx4 v6, s[8:11], s43 offen offset:1024 lds
  ds_read_b128 a[80:83], v68 offset:0
  ds_read_b128 a[208:211], v68 offset:4096
  v_mfma_f32_32x32x16_bf16 v[176:191], v[128:131], a[196:199], v[176:191]
  ds_read_b64_tr_b16 v[112:113], v9 offset:24576
  ds_read_b64_tr_b16 v[114:115], v9 offset:25088
s_waitcnt lgkmcnt(8)
s_nop 0
  v_mfma_f32_16x16x32_bf16 v[24:27], v[12:15], v[152:155], v[24:27]
  v_dot2c_f32_bf16 v80, s55, v92
  v_dot2c_f32_bf16 v82, v92, v92
  v_dot2c_f32_bf16 v84, s55, v96
  v_dot2c_f32_bf16 v86, v96, v96
  v_dot2c_f32_bf16 v81, s55, v93
  v_dot2c_f32_bf16 v83, v93, v93
  v_dot2c_f32_bf16 v85, s55, v97
  v_dot2c_f32_bf16 v87, v97, v97
  v_dot2c_f32_bf16 v80, s55, v94
  v_dot2c_f32_bf16 v82, v94, v94
  v_dot2c_f32_bf16 v84, s55, v98
  v_dot2c_f32_bf16 v86, v98, v98
  v_dot2c_f32_bf16 v81, s55, v95
  v_dot2c_f32_bf16 v83, v95, v95
  v_dot2c_f32_bf16 v85, s55, v99
  v_dot2c_f32_bf16 v87, v99, v99
  v_mfma_f32_32x32x16_bf16 v[192:207], v[132:135], a[68:71], v[192:207]
  s_add_u32 s43, s41, 66432
  s_add_u32 m0, s42, 57344
s_nop 0
s_nop 0
  buffer_load_dwordx4 v5, s[8:11], s43 offen lds
  buffer_load_dwordx4 v6, s[8:11], s43 offen offset:1024 lds
  ds_read_b64_tr_b16 v[116:117], v9 offset:16384
  v_mfma_f32_32x32x16_bf16 v[208:223], v[132:135], a[196:199], v[208:223]
  ds_read_b64_tr_b16 v[118:119], v9 offset:16896
s_waitcnt lgkmcnt(8)
s_nop 0
  v_mfma_f32_16x16x32_bf16 v[24:27], v[12:15], v[156:159], v[24:27]
  ds_read_b128 v[100:103], v75 offset:0
  ds_read_b128 v[104:107], v75 offset:4096
  v_mfma_f32_32x32x16_bf16 v[160:175], v[136:139], a[72:75], v[160:175]
  s_add_u32 s43, s37, 1605632
  s_add_u32 m0, s42, 106496
s_nop 0
s_nop 0
  buffer_load_dwordx4 v1, s[20:23], s43 offen lds
  buffer_load_dwordx4 v2, s[20:23], s43 offen offset:1024 lds
  ds_read_b128 a[84:87], v69 offset:0
  ds_read_b128 a[212:215], v69 offset:4096
  ds_read_b64_tr_b16 v[120:121], v9 offset:26624
  ds_read_b64_tr_b16 v[122:123], v9 offset:27136
  v_mfma_f32_32x32x16_bf16 v[176:191], v[136:139], a[200:203], v[176:191]
  v_add_u32_e64 v56, s63, v8
  ds_read_b64_tr_b16 v[152:153], v56 offset:16384
  ds_read_b64_tr_b16 v[154:155], v56 offset:16896
  ds_read_b64_tr_b16 v[156:157], v56 offset:20480
  ds_read_b64_tr_b16 v[158:159], v56 offset:20992
  v_mfma_f32_32x32x16_bf16 v[192:207], v[140:143], a[72:75], v[192:207]
  s_add_u32 s43, s38, 0
s_nop 0
  s_add_u32 m0, s42, 98304
s_nop 0
s_nop 0
  buffer_load_dwordx4 v3, s[12:15], s43 offen lds
  buffer_load_dwordx4 v4, s[12:15], s43 offen offset:1024 lds
  ds_read_b64_tr_b16 v[124:125], v9 offset:18432
  v_mfma_f32_32x32x16_bf16 v[208:223], v[140:143], a[200:203], v[208:223]
  ds_read_b64_tr_b16 v[126:127], v9 offset:18944
  v_mfma_f32_32x32x16_bf16 v[160:175], v[144:147], a[76:79], v[160:175]
  ds_read_b128 a[88:91], v70 offset:0
  ds_read_b128 a[216:219], v70 offset:4096
  v_mfma_f32_32x32x16_bf16 v[176:191], v[144:147], a[204:207], v[176:191]
  ds_read_b64_tr_b16 v[128:129], v9 offset:28672
  ds_read_b64_tr_b16 v[130:131], v9 offset:29184
s_waitcnt lgkmcnt(8)
s_nop 0
  v_mfma_f32_16x16x32_bf16 v[108:111], v[12:15], v[152:155], v[108:111]
  v_dot2c_f32_bf16 v80, s55, v100
  v_dot2c_f32_bf16 v82, v100, v100
  v_dot2c_f32_bf16 v84, s55, v104
  v_dot2c_f32_bf16 v86, v104, v104
  v_dot2c_f32_bf16 v81, s55, v101
  v_dot2c_f32_bf16 v83, v101, v101
  v_dot2c_f32_bf16 v85, s55, v105
  v_dot2c_f32_bf16 v87, v105, v105
  v_dot2c_f32_bf16 v80, s55, v102
  v_dot2c_f32_bf16 v82, v102, v102
  v_dot2c_f32_bf16 v84, s55, v106
  v_dot2c_f32_bf16 v86, v106, v106
  v_dot2c_f32_bf16 v81, s55, v103
  v_dot2c_f32_bf16 v83, v103, v103
  v_dot2c_f32_bf16 v85, s55, v107
  v_dot2c_f32_bf16 v87, v107, v107
  v_mfma_f32_32x32x16_bf16 v[192:207], v[148:151], a[76:79], v[192:207]
  ds_read_b64_tr_b16 v[132:133], v9 offset:20480
  v_mfma_f32_32x32x16_bf16 v[208:223], v[148:151], a[204:207], v[208:223]
  ds_read_b64_tr_b16 v[134:135], v9 offset:20992
s_waitcnt lgkmcnt(8)
s_nop 0
  v_mfma_f32_16x16x32_bf16 v[108:111], v[12:15], v[156:159], v[108:111]
  ds_read_b128 v[92:95], v76 offset:0
  ds_read_b128 v[96:99], v76 offset:4096
  v_mfma_f32_32x32x16_bf16 v[160:175], v[112:115], a[80:83], v[160:175]
  ds_read_b128 a[92:95], v71 offset:0
  ds_read_b128 a[220:223], v71 offset:4096
  ds_read_b64_tr_b16 v[136:137], v9 offset:30720
  ds_read_b64_tr_b16 v[138:139], v9 offset:31232
  v_mfma_f32_32x32x16_bf16 v[176:191], v[112:115], a[208:211], v[176:191]
  v_add_u32_e64 v56, s63, v9
  ds_read_b64_tr_b16 v[152:153], v56 offset:24576
  ds_read_b64_tr_b16 v[154:155], v56 offset:25088
  ds_read_b64_tr_b16 v[156:157], v56 offset:28672
  ds_read_b64_tr_b16 v[158:159], v56 offset:29184
  v_mfma_f32_32x32x16_bf16 v[192:207], v[116:119], a[80:83], v[192:207]
  ds_read_b64_tr_b16 v[140:141], v9 offset:22528
  v_mfma_f32_32x32x16_bf16 v[208:223], v[116:119], a[208:211], v[208:223]
  ds_read_b64_tr_b16 v[142:143], v9 offset:23040
s_waitcnt vmcnt(10)
  s_barrier
  v_mfma_f32_32x32x16_bf16 v[160:175], v[120:123], a[84:87], v[160:175]
  s_add_u32 s43, s38, 196608
  s_add_u32 m0, s42, 90112
s_nop 0
s_nop 0
  buffer_load_dwordx4 v3, s[12:15], s43 offen lds
  buffer_load_dwordx4 v4, s[12:15], s43 offen offset:1024 lds
  ds_read_b128 a[96:99], v60 offset:32768
  ds_read_b128 a[224:227], v60 offset:36864
  v_mfma_f32_32x32x16_bf16 v[176:191], v[120:123], a[212:215], v[176:191]
  ds_read_b64_tr_b16 v[144:145], v7 offset:24576
  ds_read_b64_tr_b16 v[146:147], v7 offset:25088
s_waitcnt lgkmcnt(8)
s_nop 0
  v_mfma_f32_16x16x32_bf16 v[24:27], v[12:15], v[152:155], v[24:27]
  v_dot2c_f32_bf16 v80, s55, v92
  v_dot2c_f32_bf16 v82, v92, v92
  v_dot2c_f32_bf16 v84, s55, v96
  v_dot2c_f32_bf16 v86, v96, v96
  v_dot2c_f32_bf16 v81, s55, v93
  v_dot2c_f32_bf16 v83, v93, v93
  v_dot2c_f32_bf16 v85, s55, v97
  v_dot2c_f32_bf16 v87, v97, v97
  v_dot2c_f32_bf16 v80, s55, v94
  v_dot2c_f32_bf16 v82, v94, v94
  v_dot2c_f32_bf16 v84, s55, v98
  v_dot2c_f32_bf16 v86, v98, v98
  v_dot2c_f32_bf16 v81, s55, v95
  v_dot2c_f32_bf16 v83, v95, v95
  v_dot2c_f32_bf16 v85, s55, v99
  v_dot2c_f32_bf16 v87, v99, v99
  v_mfma_f32_32x32x16_bf16 v[192:207], v[124:127], a[84:87], v[192:207]
  s_add_u32 s43, s38, 393216
  s_add_u32 m0, s42, 81920
s_nop 0
s_nop 0
  buffer_load_dwordx4 v3, s[12:15], s43 offen lds
  buffer_load_dwordx4 v4, s[12:15], s43 offen offset:1024 lds
  ds_read_b64_tr_b16 v[148:149], v8 offset:57344
  v_mfma_f32_32x32x16_bf16 v[208:223], v[124:127], a[212:215], v[208:223]
  ds_read_b64_tr_b16 v[150:151], v8 offset:57856
s_waitcnt lgkmcnt(8)
s_nop 0
  v_mfma_f32_16x16x32_bf16 v[24:27], v[12:15], v[156:159], v[24:27]
  ds_read_b128 v[100:103], v77 offset:0
  ds_read_b128 v[104:107], v77 offset:4096
  v_mfma_f32_32x32x16_bf16 v[160:175], v[128:131], a[88:91], v[160:175]
  s_add_u32 s43, s38, 589824
  s_add_u32 m0, s42, 73728
s_nop 0
s_nop 0
  buffer_load_dwordx4 v3, s[12:15], s43 offen lds
  buffer_load_dwordx4 v4, s[12:15], s43 offen offset:1024 lds
  ds_read_b128 a[100:103], v61 offset:32768
  ds_read_b128 a[228:231], v61 offset:36864
  ds_read_b64_tr_b16 v[112:113], v7 offset:26624
  ds_read_b64_tr_b16 v[114:115], v7 offset:27136
  v_mfma_f32_32x32x16_bf16 v[176:191], v[128:131], a[216:219], v[176:191]
  v_add_u32_e64 v56, s63, v9
  ds_read_b64_tr_b16 v[152:153], v56 offset:16384
  ds_read_b64_tr_b16 v[154:155], v56 offset:16896
  ds_read_b64_tr_b16 v[156:157], v56 offset:20480
  ds_read_b64_tr_b16 v[158:159], v56 offset:20992
  v_mfma_f32_32x32x16_bf16 v[192:207], v[132:135], a[88:91], v[192:207]
  s_add_u32 s43, s38, 786432
  s_add_u32 m0, s42, 65536
s_nop 0
s_nop 0
  buffer_load_dwordx4 v3, s[12:15], s43 offen lds
  buffer_load_dwordx4 v4, s[12:15], s43 offen offset:1024 lds
  ds_read_b64_tr_b16 v[116:117], v8 offset:59392
  v_mfma_f32_32x32x16_bf16 v[208:223], v[132:135], a[216:219], v[208:223]
  ds_read_b64_tr_b16 v[118:119], v8 offset:59904
  v_mfma_f32_32x32x16_bf16 v[160:175], v[136:139], a[92:95], v[160:175]
  ds_read_b128 a[104:107], v62 offset:32768
  ds_read_b128 a[232:235], v62 offset:36864
  v_mfma_f32_32x32x16_bf16 v[176:191], v[136:139], a[220:223], v[176:191]
  ds_read_b64_tr_b16 v[120:121], v7 offset:28672
  ds_read_b64_tr_b16 v[122:123], v7 offset:29184
s_waitcnt lgkmcnt(8)
s_nop 0
  v_mfma_f32_16x16x32_bf16 v[108:111], v[12:15], v[152:155], v[108:111]
  v_dot2c_f32_bf16 v80, s55, v100
  v_dot2c_f32_bf16 v82, v100, v100
  v_dot2c_f32_bf16 v84, s55, v104
  v_dot2c_f32_bf16 v86, v104, v104
  v_dot2c_f32_bf16 v81, s55, v101
  v_dot2c_f32_bf16 v83, v101, v101
  v_dot2c_f32_bf16 v85, s55, v105
  v_dot2c_f32_bf16 v87, v105, v105
  v_dot2c_f32_bf16 v80, s55, v102
  v_dot2c_f32_bf16 v82, v102, v102
  v_dot2c_f32_bf16 v84, s55, v106
  v_dot2c_f32_bf16 v86, v106, v106
  v_dot2c_f32_bf16 v81, s55, v103
  v_dot2c_f32_bf16 v83, v103, v103
  v_dot2c_f32_bf16 v85, s55, v107
  v_dot2c_f32_bf16 v87, v107, v107
  v_mfma_f32_32x32x16_bf16 v[192:207], v[140:143], a[92:95], v[192:207]
  ds_read_b64_tr_b16 v[124:125], v8 offset:61440
  v_mfma_f32_32x32x16_bf16 v[208:223], v[140:143], a[220:223], v[208:223]
  ds_read_b64_tr_b16 v[126:127], v8 offset:61952
s_waitcnt lgkmcnt(8)
s_nop 0
  v_mfma_f32_16x16x32_bf16 v[108:111], v[12:15], v[156:159], v[108:111]
  ds_read_b128 v[92:95], v72 offset:32768
  ds_read_b128 v[96:99], v72 offset:36864
  v_mfma_f32_32x32x16_bf16 v[160:175], v[144:147], a[96:99], v[160:175]
  ds_read_b128 a[108:111], v63 offset:32768
  ds_read_b128 a[236:239], v63 offset:36864
  ds_read_b64_tr_b16 v[128:129], v7 offset:30720
  ds_read_b64_tr_b16 v[130:131], v7 offset:31232
  v_mfma_f32_32x32x16_bf16 v[176:191], v[144:147], a[224:227], v[176:191]
  v_add_u32_e64 v56, s63, v7
  ds_read_b64_tr_b16 v[152:153], v56 offset:24576
  ds_read_b64_tr_b16 v[154:155], v56 offset:25088
  ds_read_b64_tr_b16 v[156:157], v56 offset:28672
  ds_read_b64_tr_b16 v[158:159], v56 offset:29184
  v_mfma_f32_32x32x16_bf16 v[192:207], v[148:151], a[96:99], v[192:207]
  ds_read_b64_tr_b16 v[132:133], v8 offset:63488
  v_mfma_f32_32x32x16_bf16 v[208:223], v[148:151], a[224:227], v[208:223]
  ds_read_b64_tr_b16 v[134:135], v8 offset:64000
s_waitcnt vmcnt(10)
  s_barrier
  v_mfma_f32_32x32x16_bf16 v[160:175], v[112:115], a[100:103], v[160:175]
  s_add_u32 s43, s38, 983040
  s_add_u32 m0, s42, 155648
s_nop 0
s_nop 0
  buffer_load_dwordx4 v3, s[12:15], s43 offen lds
  buffer_load_dwordx4 v4, s[12:15], s43 offen offset:1024 lds
  ds_read_b128 a[112:115], v60 offset:49152
  ds_read_b128 a[240:243], v60 offset:53248
  v_mfma_f32_32x32x16_bf16 v[176:191], v[112:115], a[228:231], v[176:191]
  ds_read_b64_tr_b16 v[136:137], v8 offset:49152
  ds_read_b64_tr_b16 v[138:139], v8 offset:49664
s_waitcnt lgkmcnt(8)
s_nop 0
  v_mfma_f32_16x16x32_bf16 v[24:27], v[12:15], v[152:155], v[24:27]
  v_dot2c_f32_bf16 v80, s55, v92
  v_dot2c_f32_bf16 v82, v92, v92
  v_dot2c_f32_bf16 v84, s55, v96
  v_dot2c_f32_bf16 v86, v96, v96
  v_dot2c_f32_bf16 v81, s55, v93
  v_dot2c_f32_bf16 v83, v93, v93
  v_dot2c_f32_bf16 v85, s55, v97
  v_dot2c_f32_bf16 v87, v97, v97
  v_dot2c_f32_bf16 v80, s55, v94
  v_dot2c_f32_bf16 v82, v94, v94
  v_dot2c_f32_bf16 v84, s55, v98
  v_dot2c_f32_bf16 v86, v98, v98
  v_dot2c_f32_bf16 v81, s55, v95
  v_dot2c_f32_bf16 v83, v95, v95
  v_dot2c_f32_bf16 v85, s55, v99
  v_dot2c_f32_bf16 v87, v99, v99
  v_mfma_f32_32x32x16_bf16 v[192:207], v[116:119], a[100:103], v[192:207]
  s_add_u32 s43, s38, 1179648
  s_add_u32 m0, s42, 147456
s_nop 0
s_nop 0
  buffer_load_dwordx4 v3, s[12:15], s43 offen lds
  buffer_load_dwordx4 v4, s[12:15], s43 offen offset:1024 lds
  ds_read_b64_tr_b16 v[140:141], v8 offset:40960
  v_mfma_f32_32x32x16_bf16 v[208:223], v[116:119], a[228:231], v[208:223]
  ds_read_b64_tr_b16 v[142:143], v8 offset:41472
s_waitcnt lgkmcnt(8)
s_nop 0
  v_mfma_f32_16x16x32_bf16 v[24:27], v[12:15], v[156:159], v[24:27]
  ds_read_b128 v[100:103], v73 offset:32768
  ds_read_b128 v[104:107], v73 offset:36864
  v_mfma_f32_32x32x16_bf16 v[160:175], v[120:123], a[104:107], v[160:175]
  s_add_u32 s43, s38, 1376256
  s_add_u32 m0, s42, 139264
s_nop 0
s_nop 0
  buffer_load_dwordx4 v3, s[12:15], s43 offen lds
  buffer_load_dwordx4 v4, s[12:15], s43 offen offset:1024 lds
  ds_read_b128 a[116:119], v61 offset:49152
  ds_read_b128 a[244:247], v61 offset:53248
  ds_read_b64_tr_b16 v[144:145], v8 offset:51200
  ds_read_b64_tr_b16 v[146:147], v8 offset:51712
  v_mfma_f32_32x32x16_bf16 v[176:191], v[120:123], a[232:235], v[176:191]
  v_add_u32_e64 v56, s63, v8
  ds_read_b64_tr_b16 v[152:153], v56 offset:57344
  ds_read_b64_tr_b16 v[154:155], v56 offset:57856
  ds_read_b64_tr_b16 v[156:157], v56 offset:61440
  ds_read_b64_tr_b16 v[158:159], v56 offset:61952
  v_mfma_f32_32x32x16_bf16 v[192:207], v[124:127], a[104:107], v[192:207]
  s_add_u32 s43, s39, 0
s_nop 0
  s_add_u32 m0, s42, 131072
s_nop 0
s_nop 0
  buffer_load_dwordx4 v3, s[12:15], s43 offen lds
  buffer_load_dwordx4 v4, s[12:15], s43 offen offset:1024 lds
  ds_read_b64_tr_b16 v[148:149], v8 offset:43008
  v_mfma_f32_32x32x16_bf16 v[208:223], v[124:127], a[232:235], v[208:223]
  ds_read_b64_tr_b16 v[150:151], v8 offset:43520
  v_mfma_f32_32x32x16_bf16 v[160:175], v[128:131], a[108:111], v[160:175]
  ds_read_b128 a[120:123], v62 offset:49152
  ds_read_b128 a[248:251], v62 offset:53248
  v_mfma_f32_32x32x16_bf16 v[176:191], v[128:131], a[236:239], v[176:191]
  ds_read_b64_tr_b16 v[112:113], v8 offset:53248
  ds_read_b64_tr_b16 v[114:115], v8 offset:53760
s_waitcnt lgkmcnt(8)
s_nop 0
  v_mfma_f32_16x16x32_bf16 v[108:111], v[12:15], v[152:155], v[108:111]
  v_dot2c_f32_bf16 v80, s55, v100
  v_dot2c_f32_bf16 v82, v100, v100
  v_dot2c_f32_bf16 v84, s55, v104
  v_dot2c_f32_bf16 v86, v104, v104
  v_dot2c_f32_bf16 v81, s55, v101
  v_dot2c_f32_bf16 v83, v101, v101
  v_dot2c_f32_bf16 v85, s55, v105
  v_dot2c_f32_bf16 v87, v105, v105
  v_dot2c_f32_bf16 v80, s55, v102
  v_dot2c_f32_bf16 v82, v102, v102
  v_dot2c_f32_bf16 v84, s55, v106
  v_dot2c_f32_bf16 v86, v106, v106
  v_dot2c_f32_bf16 v81, s55, v103
  v_dot2c_f32_bf16 v83, v103, v103
  v_dot2c_f32_bf16 v85, s55, v107
  v_dot2c_f32_bf16 v87, v107, v107
  v_mfma_f32_32x32x16_bf16 v[192:207], v[132:135], a[108:111], v[192:207]
  ds_read_b64_tr_b16 v[116:117], v8 offset:45056
  v_mfma_f32_32x32x16_bf16 v[208:223], v[132:135], a[236:239], v[208:223]
  ds_read_b64_tr_b16 v[118:119], v8 offset:45568
s_waitcnt lgkmcnt(8)
s_nop 0
  v_mfma_f32_16x16x32_bf16 v[108:111], v[12:15], v[156:159], v[108:111]
  ds_read_b128 v[92:95], v72 offset:49152
  ds_read_b128 v[96:99], v72 offset:53248
  v_mfma_f32_32x32x16_bf16 v[160:175], v[136:139], a[112:115], v[160:175]
  ds_read_b128 a[124:127], v63 offset:49152
  ds_read_b128 a[252:255], v63 offset:53248
  ds_read_b64_tr_b16 v[120:121], v8 offset:55296
  ds_read_b64_tr_b16 v[122:123], v8 offset:55808
  v_mfma_f32_32x32x16_bf16 v[176:191], v[136:139], a[240:243], v[176:191]
  v_add_u32_e64 v56, s63, v8
  ds_read_b64_tr_b16 v[152:153], v56 offset:49152
  ds_read_b64_tr_b16 v[154:155], v56 offset:49664
  ds_read_b64_tr_b16 v[156:157], v56 offset:53248
  ds_read_b64_tr_b16 v[158:159], v56 offset:53760
  v_mfma_f32_32x32x16_bf16 v[192:207], v[140:143], a[112:115], v[192:207]
  ds_read_b64_tr_b16 v[124:125], v8 offset:47104
  v_mfma_f32_32x32x16_bf16 v[208:223], v[140:143], a[240:243], v[208:223]
  ds_read_b64_tr_b16 v[126:127], v8 offset:47616
s_waitcnt vmcnt(14)
  s_barrier
  v_mfma_f32_32x32x16_bf16 v[160:175], v[144:147], a[116:119], v[160:175]
  s_add_u32 s43, s39, 196608
  s_add_u32 m0, s42, 122880
s_nop 0
s_nop 0
  buffer_load_dwordx4 v3, s[12:15], s43 offen lds
  buffer_load_dwordx4 v4, s[12:15], s43 offen offset:1024 lds
  ds_read_b64_tr_b16 v[128:129], v8 offset:32768
  v_mfma_f32_32x32x16_bf16 v[176:191], v[144:147], a[244:247], v[176:191]
  ds_read_b64_tr_b16 v[130:131], v8 offset:33280
s_waitcnt lgkmcnt(6)
s_nop 0
  v_mfma_f32_16x16x32_bf16 v[24:27], v[12:15], v[152:155], v[24:27]
  v_dot2c_f32_bf16 v80, s55, v92
  v_dot2c_f32_bf16 v82, v92, v92
  v_dot2c_f32_bf16 v84, s55, v96
  v_dot2c_f32_bf16 v86, v96, v96
  v_dot2c_f32_bf16 v81, s55, v93
  v_dot2c_f32_bf16 v83, v93, v93
  v_dot2c_f32_bf16 v85, s55, v97
  v_dot2c_f32_bf16 v87, v97, v97
  v_dot2c_f32_bf16 v80, s55, v94
  v_dot2c_f32_bf16 v82, v94, v94
  v_dot2c_f32_bf16 v84, s55, v98
  v_dot2c_f32_bf16 v86, v98, v98
  v_dot2c_f32_bf16 v81, s55, v95
  v_dot2c_f32_bf16 v83, v95, v95
  v_dot2c_f32_bf16 v85, s55, v99
  v_dot2c_f32_bf16 v87, v99, v99
  v_mfma_f32_32x32x16_bf16 v[192:207], v[148:151], a[116:119], v[192:207]
  s_add_u32 s43, s39, 393216
  s_add_u32 m0, s42, 40960
s_nop 0
s_nop 0
  buffer_load_dwordx4 v3, s[12:15], s43 offen lds
  buffer_load_dwordx4 v4, s[12:15], s43 offen offset:1024 lds
  ds_read_b64_tr_b16 v[132:133], v8 offset:34816
  v_mfma_f32_32x32x16_bf16 v[208:223], v[148:151], a[244:247], v[208:223]
  ds_read_b64_tr_b16 v[134:135], v8 offset:35328
s_waitcnt lgkmcnt(6)
s_nop 0
  v_mfma_f32_16x16x32_bf16 v[24:27], v[12:15], v[156:159], v[24:27]
  ds_read_b128 v[100:103], v73 offset:49152
  ds_read_b128 v[104:107], v73 offset:53248
  v_mfma_f32_32x32x16_bf16 v[160:175], v[112:115], a[120:123], v[160:175]
  s_add_u32 s43, s39, 589824
  s_add_u32 m0, s42, 32768
s_nop 0
s_nop 0
  buffer_load_dwordx4 v3, s[12:15], s43 offen lds
  buffer_load_dwordx4 v4, s[12:15], s43 offen offset:1024 lds
  ds_read_b64_tr_b16 v[136:137], v8 offset:36864
  ds_read_b64_tr_b16 v[138:139], v8 offset:37376
  v_add_u32_e64 v56, s63, v8
  v_mfma_f32_32x32x16_bf16 v[176:191], v[112:115], a[248:251], v[176:191]
  ds_read_b64_tr_b16 v[152:153], v56 offset:40960
  ds_read_b64_tr_b16 v[154:155], v56 offset:41472
  ds_read_b64_tr_b16 v[156:157], v56 offset:45056
  ds_read_b64_tr_b16 v[158:159], v56 offset:45568
  v_mfma_f32_32x32x16_bf16 v[192:207], v[116:119], a[120:123], v[192:207]
  s_add_u32 s43, s39, 786432
  s_add_u32 m0, s42, 24576
s_nop 0
s_nop 0
  buffer_load_dwordx4 v3, s[12:15], s43 offen lds
  buffer_load_dwordx4 v4, s[12:15], s43 offen offset:1024 lds
  ds_read_b64_tr_b16 v[140:141], v8 offset:38912
  v_mfma_f32_32x32x16_bf16 v[208:223], v[116:119], a[248:251], v[208:223]
  ds_read_b64_tr_b16 v[142:143], v8 offset:39424
  v_mfma_f32_32x32x16_bf16 v[160:175], v[120:123], a[124:127], v[160:175]
  ds_read_b64_tr_b16 v[144:145], v8 offset:24576
  v_mfma_f32_32x32x16_bf16 v[176:191], v[120:123], a[252:255], v[176:191]
  ds_read_b64_tr_b16 v[146:147], v8 offset:25088
s_waitcnt lgkmcnt(6)
s_nop 0
  v_mfma_f32_16x16x32_bf16 v[108:111], v[12:15], v[152:155], v[108:111]
  v_dot2c_f32_bf16 v80, s55, v100
  v_dot2c_f32_bf16 v82, v100, v100
  v_dot2c_f32_bf16 v84, s55, v104
  v_dot2c_f32_bf16 v86, v104, v104
  v_dot2c_f32_bf16 v81, s55, v101
  v_dot2c_f32_bf16 v83, v101, v101
  v_dot2c_f32_bf16 v85, s55, v105
  v_dot2c_f32_bf16 v87, v105, v105
  v_dot2c_f32_bf16 v80, s55, v102
  v_dot2c_f32_bf16 v82, v102, v102
  v_dot2c_f32_bf16 v84, s55, v106
  v_dot2c_f32_bf16 v86, v106, v106
  v_dot2c_f32_bf16 v81, s55, v103
  v_dot2c_f32_bf16 v83, v103, v103
  v_dot2c_f32_bf16 v85, s55, v107
  v_dot2c_f32_bf16 v87, v107, v107
  v_mfma_f32_32x32x16_bf16 v[192:207], v[124:127], a[124:127], v[192:207]
  ds_read_b64_tr_b16 v[148:149], v8 offset:26624
  v_mfma_f32_32x32x16_bf16 v[208:223], v[124:127], a[252:255], v[208:223]
  ds_read_b64_tr_b16 v[150:151], v8 offset:27136
s_waitcnt lgkmcnt(6)
s_nop 0
  v_mfma_f32_16x16x32_bf16 v[108:111], v[12:15], v[156:159], v[108:111]
  ds_write_b32 v41, v24 offset:4096
s_nop 6
s_nop 0
  ds_write_b32 v41, v108 offset:5120
  s_lshl_b32 s62, s47, 4
  v_lshrrev_b32_e32 v49, 5, v10
  v_and_b32_e32 v49, 0x10, v49
  v_lshrrev_b32_e32 v49, 1, v49
  v_add3_u32 v49, v49, s62, v40
  v_add_f32_e32 v80, v80, v81
  v_add_f32_e32 v81, v82, v83
  ds_write_b64 v49, v[80:81] offset:0
  v_add_f32_e32 v84, v84, v85
  v_add_f32_e32 v85, v86, v87
  ds_write_b64 v49, v[84:85] offset:1024
  v_mfma_f32_32x32x16_bf16 v[224:239], a[0:3], v[128:131], 0
  ds_read_b64_tr_b16 v[112:113], v8 offset:28672
  ds_read_b64_tr_b16 v[114:115], v8 offset:29184
  v_add_u32_e64 v56, s63, v8
  v_mfma_f32_32x32x16_bf16 v[240:255], a[128:131], v[128:131], 0
  ds_read_b64_tr_b16 v[152:153], v56 offset:32768
  ds_read_b64_tr_b16 v[154:155], v56 offset:33280
  ds_read_b64_tr_b16 v[156:157], v56 offset:36864
  ds_read_b64_tr_b16 v[158:159], v56 offset:37376
  v_mfma_f32_32x32x16_bf16 v[224:239], a[4:7], v[132:135], v[224:239]
  ds_read_b64_tr_b16 v[116:117], v8 offset:30720
  v_mfma_f32_32x32x16_bf16 v[240:255], a[132:135], v[132:135], v[240:255]
  ds_read_b64_tr_b16 v[118:119], v8 offset:31232
s_waitcnt lgkmcnt(0)
s_waitcnt vmcnt(18)
  s_barrier
s_nop 0
  v_mfma_f32_32x32x16_bf16 v[224:239], a[8:11], v[136:139], v[224:239]
  s_add_u32 s43, s39, 983040
  s_add_u32 m0, s42, 114688
s_nop 0
s_nop 0
  buffer_load_dwordx4 v3, s[12:15], s43 offen lds
  buffer_load_dwordx4 v4, s[12:15], s43 offen offset:1024 lds
  ds_read_b64_tr_b16 v[120:121], v8 offset:16384
  ds_read_b64_tr_b16 v[122:123], v8 offset:16896
  ds_read_b128 v[92:95], v40 offset:0
  v_mfma_f32_32x32x16_bf16 v[240:255], a[136:139], v[136:139], v[240:255]
  ds_read_b128 v[96:99], v40 offset:16
  ds_read_b128 v[100:103], v40 offset:1024
  ds_read_b128 v[104:107], v40 offset:1040
  v_mfma_f32_16x16x32_bf16 v[24:27], v[12:15], v[152:155], 0
  v_mfma_f32_32x32x16_bf16 v[224:239], a[12:15], v[140:143], v[224:239]
  s_add_u32 s43, s39, 1179648
  s_add_u32 m0, s42, 106496
s_nop 0
s_nop 0
  buffer_load_dwordx4 v3, s[12:15], s43 offen lds
  buffer_load_dwordx4 v4, s[12:15], s43 offen offset:1024 lds
  ds_read_b64_tr_b16 v[124:125], v8 offset:18432
  ds_read_b64_tr_b16 v[126:127], v8 offset:18944
s_waitcnt lgkmcnt(5)
  v_add_f32_e32 v92, v92, v94
s_waitcnt lgkmcnt(3)
  v_add_f32_e32 v100, v100, v102
  v_add_f32_e64 v93, v93, v95
  v_mfma_f32_32x32x16_bf16 v[240:255], a[140:143], v[140:143], v[240:255]
  v_add_f32_e32 v101, v101, v103
  v_add_f32_e32 v96, v96, v98
s_waitcnt lgkmcnt(2)
  v_add_f32_e32 v104, v104, v106
  v_add_f32_e32 v97, v97, v99
  v_add_f32_e32 v105, v105, v107
  v_mfma_f32_16x16x32_bf16 v[24:27], v[12:15], v[156:159], v[24:27]
  v_mfma_f32_32x32x16_bf16 v[224:239], a[16:19], v[144:147], v[224:239]
  s_add_u32 s43, s39, 1376256
  s_add_u32 m0, s42, 57344
s_nop 0
s_nop 0
  buffer_load_dwordx4 v3, s[12:15], s43 offen lds
  buffer_load_dwordx4 v4, s[12:15], s43 offen offset:1024 lds
  ds_read_b64_tr_b16 v[128:129], v8 offset:20480
  ds_read_b64_tr_b16 v[130:131], v8 offset:20992
  v_add_u32_e64 v56, s63, v8
  ds_read_b64_tr_b16 v[152:153], v56 offset:24576
  ds_read_b64_tr_b16 v[154:155], v56 offset:25088
  ds_read_b64_tr_b16 v[156:157], v56 offset:28672
  ds_read_b64_tr_b16 v[158:159], v56 offset:29184
  v_mfma_f32_32x32x16_bf16 v[240:255], a[144:147], v[144:147], v[240:255]
  v_add_f32_e32 v92, v92, v96
  v_add_f32_e32 v100, v100, v104
  v_add_f32_e32 v93, v93, v97
  v_add_f32_e32 v101, v101, v105
  v_mul_f32_e32 v92, s44, v92
  v_mul_f32_e32 v100, s44, v100
  v_mul_f32_e32 v93, s44, v93
  v_mul_f32_e32 v101, s44, v101
  v_mfma_f32_32x32x16_bf16 v[224:239], a[20:23], v[148:151], v[224:239]
  s_add_u32 s43, s40, 0
s_nop 0
  s_add_u32 m0, s42, 49152
s_nop 0
s_nop 0
  buffer_load_dwordx4 v3, s[12:15], s43 offen lds
  buffer_load_dwordx4 v4, s[12:15], s43 offen offset:1024 lds
  ds_read_b64_tr_b16 v[132:133], v8 offset:22528
  ds_read_b64_tr_b16 v[134:135], v8 offset:23040
  v_fma_f32 v93, -v92, v92, v93
  v_fma_f32 v101, -v100, v100, v101
  v_max_f32_e64 v93, 0, v93
  v_mfma_f32_32x32x16_bf16 v[240:255], a[148:151], v[148:151], v[240:255]
  v_max_f32_e64 v101, 0, v101
  v_cvt_pk_bf16_f32 v94, v92, v93
  v_cvt_pk_bf16_f32 v102, v100, v101
  v_and_b32_e32 v93, s46, v94
  v_and_b32_e32 v101, s46, v102
  v_mfma_f32_32x32x16_bf16 v[224:239], a[24:27], v[112:115], v[224:239]
  ds_read_b64_tr_b16 v[136:137], v8 offset:8192
  ds_read_b64_tr_b16 v[138:139], v8 offset:8704
  v_lshlrev_b32_e32 v92, 16, v94
  v_lshlrev_b32_e32 v100, 16, v102
  v_add_f32_e32 v93, 0x3727c5ac, v93
  v_mfma_f32_32x32x16_bf16 v[240:255], a[152:155], v[112:115], v[240:255]
  v_add_f32_e32 v101, 0x3727c5ac, v101
  v_mul_f32_e32 v92, v92, v45
  v_mul_f32_e32 v100, v100, v45
  v_cvt_pk_bf16_f32 v93, v93, v93
  v_cvt_pk_bf16_f32 v101, v101, v101
s_waitcnt lgkmcnt(6)
s_nop 0
  v_mfma_f32_16x16x32_bf16 v[24:27], v[12:15], v[152:155], v[24:27]
  v_mfma_f32_32x32x16_bf16 v[224:239], a[28:31], v[116:119], v[224:239]
  ds_read_b64_tr_b16 v[140:141], v8 offset:10240
  ds_read_b64_tr_b16 v[142:143], v8 offset:10752
  v_cvt_pk_bf16_f32 v28, v92, v92
  v_cvt_pk_bf16_f32 v32, v100, v100
  v_and_b32_e64 v93, s46, v93
  v_mfma_f32_32x32x16_bf16 v[240:255], a[156:159], v[116:119], v[240:255]
  v_and_b32_e32 v101, s46, v101
  v_sqrt_f32_e32 v93, v93
  v_sqrt_f32_e32 v101, v101
  v_mov_b32_e32 v29, 0
  v_mov_b32_e32 v33, 0
s_waitcnt lgkmcnt(6)
  v_mfma_f32_16x16x32_bf16 v[24:27], v[12:15], v[156:159], v[24:27]
  v_mfma_f32_32x32x16_bf16 v[224:239], a[32:35], v[120:123], v[224:239]
  ds_read_b64_tr_b16 v[144:145], v8 offset:12288
  ds_read_b64_tr_b16 v[146:147], v8 offset:12800
  v_add_u32_e64 v56, s63, v8
  ds_read_b64_tr_b16 v[152:153], v56 offset:16384
  ds_read_b64_tr_b16 v[154:155], v56 offset:16896
  ds_read_b64_tr_b16 v[156:157], v56 offset:20480
  ds_read_b64_tr_b16 v[158:159], v56 offset:20992
  v_mfma_f32_32x32x16_bf16 v[240:255], a[160:163], v[120:123], v[240:255]
  v_mov_b32_e32 v30, 0
  v_mov_b32_e32 v34, 0
  v_cvt_pk_bf16_f32 v93, v93, v93
  v_cvt_pk_bf16_f32 v101, v101, v101
  v_mov_b32_e32 v31, 0
  v_mov_b32_e32 v35, 0
  v_and_b32_e32 v18, s46, v93
  v_and_b32_e32 v19, s46, v101
  v_mfma_f32_32x32x16_bf16 v[224:239], a[36:39], v[124:127], v[224:239]
  ds_read_b64_tr_b16 v[148:149], v8 offset:14336
  ds_read_b64_tr_b16 v[150:151], v8 offset:14848
  v_rcp_f32_e32 v22, v18
  v_rcp_f32_e32 v23, v19
  v_mfma_f32_32x32x16_bf16 v[240:255], a[164:167], v[124:127], v[240:255]
  v_mov_b32_e32 v37, 0
  v_mov_b32_e32 v38, 0
  v_mov_b32_e32 v39, 0
  v_mov_b32_e32 v39, 0
  v_mul_f32_e32 v16, 0xbfb8aa3b, v22
s_waitcnt vmcnt(22)
  s_barrier
  v_mfma_f32_32x32x16_bf16 v[224:239], a[40:43], v[128:131], v[224:239]
  s_add_u32 s43, s40, 196608
  s_add_u32 m0, s42, 98304
s_nop 0
s_nop 0
  buffer_load_dwordx4 v3, s[12:15], s43 offen lds
  buffer_load_dwordx4 v4, s[12:15], s43 offen offset:1024 lds
  ds_read_b64_tr_b16 v[112:113], v8 offset:0
  ds_read_b64_tr_b16 v[114:115], v8 offset:512
  v_mul_f32_e32 v17, 0xbfb8aa3b, v23
  v_mul_f32_e64 v20, s56, v22
  v_mfma_f32_32x32x16_bf16 v[240:255], a[168:171], v[128:131], v[240:255]
  v_mul_f32_e64 v21, s56, v23
  ds_write_b32 v43, v22 offset:0
  ds_write_b32 v43, v23 offset:128
  ds_read_b64 v[48:49], v42 offset:4096
s_waitcnt lgkmcnt(9)
s_nop 0
  v_mfma_f32_16x16x32_bf16 v[24:27], v[12:15], v[152:155], v[24:27]
  v_mfma_f32_32x32x16_bf16 v[224:239], a[44:47], v[132:135], v[224:239]
  s_add_u32 s43, s40, 393216
  s_add_u32 m0, s42, 90112
s_nop 0
s_nop 0
  buffer_load_dwordx4 v3, s[12:15], s43 offen lds
  buffer_load_dwordx4 v4, s[12:15], s43 offen offset:1024 lds
  ds_read_b64_tr_b16 v[116:117], v8 offset:2048
  ds_read_b64_tr_b16 v[118:119], v8 offset:2560
s_waitcnt lgkmcnt(2)
  v_add_f32_e32 v48, v48, v49
  v_cvt_pk_bf16_f32 v49, v48, v48
  v_mfma_f32_32x32x16_bf16 v[240:255], a[172:175], v[132:135], v[240:255]
  v_and_b32_e32 v49, s46, v49
  v_sub_f32_e32 v49, v48, v49
  v_cvt_pk_bf16_f32 v36, v48, v49
  s_cmp_ge_u32 s2, 144
  s_cbranch_scc1 K1B_w2a
  s_lshl_b32 s43, s2, 14
  s_lshl_b32 s62, s57, 12
s_nop 0
  s_add_u32 m0, s62, 8192
  s_cmp_ge_u32 s2, 112
  s_cbranch_scc1 K1B_w2o
s_nop 0
  buffer_load_dwordx4 v47, s[28:31], s43 offen offset:0 lds
  s_add_u32 s43, s43, 3072
  buffer_load_dwordx4 v47, s[28:31], s43 offen offset:1024 lds
  s_add_u32 s43, s43, 3072
  buffer_load_dwordx4 v47, s[28:31], s43 offen offset:2048 lds
  s_add_u32 s43, s43, 3072
  buffer_load_dwordx4 v47, s[28:31], s43 offen offset:3072 lds
  s_add_u32 s43, s43, 3072
  s_branch K1B_w2a
s_nop 0
K1B_w2o:
  s_sub_u32 s43, s43, 1835008
  buffer_load_dwordx4 v47, s[32:35], s43 offen offset:0 lds
  s_add_u32 s43, s43, 3072
  buffer_load_dwordx4 v47, s[32:35], s43 offen offset:1024 lds
  s_add_u32 s43, s43, 3072
  buffer_load_dwordx4 v47, s[32:35], s43 offen offset:2048 lds
  s_add_u32 s43, s43, 3072
  buffer_load_dwordx4 v47, s[32:35], s43 offen offset:3072 lds
  s_add_u32 s43, s43, 3072
K1B_w2a:
  v_mfma_f32_16x16x32_bf16 v[24:27], v[12:15], v[156:159], v[24:27]
  v_mfma_f32_32x32x16_bf16 v[224:239], a[48:51], v[136:139], v[224:239]
  ds_read_b64_tr_b16 v[120:121], v8 offset:4096
  ds_read_b64_tr_b16 v[122:123], v8 offset:4608
  v_add_u32_e64 v56, s63, v8
  ds_read_b64_tr_b16 v[152:153], v56 offset:8192
  v_mfma_f32_32x32x16_bf16 v[240:255], a[176:179], v[136:139], v[240:255]
  ds_read_b64_tr_b16 v[154:155], v56 offset:8704
  ds_read_b64_tr_b16 v[156:157], v56 offset:12288
  ds_read_b64_tr_b16 v[158:159], v56 offset:12800
  v_mfma_f32_32x32x16_bf16 v[160:175], v[36:39], v[28:31], v[160:175]
  v_mfma_f32_32x32x16_bf16 v[176:191], v[36:39], v[32:35], v[176:191]
  v_mfma_f32_32x32x16_bf16 v[224:239], a[52:55], v[140:143], v[224:239]
  ds_read_b64_tr_b16 v[124:125], v8 offset:6144
  ds_read_b64_tr_b16 v[126:127], v8 offset:6656
  ds_read_b64 v[48:49], v42 offset:5120
  v_mfma_f32_32x32x16_bf16 v[240:255], a[180:183], v[140:143], v[240:255]
s_nop 5
  v_mul_f32_e32 v160, v160, v16
  v_mul_f32_e32 v161, v161, v16
  v_mul_f32_e32 v162, v162, v16
  v_mul_f32_e64 v163, v163, v16
  v_mfma_f32_32x32x16_bf16 v[224:239], a[56:59], v[144:147], v[224:239]
  ds_read_b64_tr_b16 v[128:129], v9 offset:24576
  ds_read_b64_tr_b16 v[130:131], v9 offset:25088
s_waitcnt lgkmcnt(2)
  v_add_f32_e32 v48, v48, v49
  v_cvt_pk_bf16_f32 v49, v48, v48
  v_and_b32_e64 v49, s46, v49
  v_mfma_f32_32x32x16_bf16 v[240:255], a[184:187], v[144:147], v[240:255]
  v_sub_f32_e64 v49, v48, v49
  v_cvt_pk_bf16_f32 v36, v48, v49
  v_mul_f32_e32 v164, v164, v16
  v_mul_f32_e32 v165, v165, v16
  v_mul_f32_e32 v166, v166, v16
  v_mul_f32_e32 v167, v167, v16
  v_mfma_f32_16x16x32_bf16 v[24:27], v[12:15], v[152:155], v[24:27]
  v_mfma_f32_32x32x16_bf16 v[224:239], a[60:63], v[148:151], v[224:239]
  ds_read_b64_tr_b16 v[132:133], v9 offset:26624
  ds_read_b64_tr_b16 v[134:135], v9 offset:27136
  v_mfma_f32_32x32x16_bf16 v[192:207], v[36:39], v[28:31], v[192:207]
  v_mfma_f32_32x32x16_bf16 v[208:223], v[36:39], v[32:35], v[208:223]
  v_mfma_f32_32x32x16_bf16 v[240:255], a[188:191], v[148:151], v[240:255]
  v_exp_f32_e32 v160, v160
  v_exp_f32_e32 v161, v161
  v_exp_f32_e32 v162, v162
  v_exp_f32_e32 v163, v163
  v_mfma_f32_16x16x32_bf16 v[24:27], v[12:15], v[156:159], v[24:27]
  v_mfma_f32_32x32x16_bf16 v[224:239], a[64:67], v[112:115], v[224:239]
  ds_read_b64_tr_b16 v[136:137], v9 offset:28672
  ds_read_b64_tr_b16 v[138:139], v9 offset:29184
  v_add_u32_e64 v56, s63, v8
  ds_read_b64_tr_b16 v[152:153], v56 offset:0
  ds_read_b64_tr_b16 v[154:155], v56 offset:512
  v_mfma_f32_32x32x16_bf16 v[240:255], a[192:195], v[112:115], v[240:255]
  ds_read_b64_tr_b16 v[156:157], v56 offset:4096
  ds_read_b64_tr_b16 v[158:159], v56 offset:4608
  v_exp_f32_e32 v164, v164
  v_exp_f32_e32 v165, v165
  v_exp_f32_e32 v166, v166
  v_exp_f32_e32 v167, v167
  v_mfma_f32_32x32x16_bf16 v[224:239], a[68:71], v[116:119], v[224:239]
  ds_read_b64_tr_b16 v[140:141], v9 offset:30720
  ds_read_b64_tr_b16 v[142:143], v9 offset:31232
  v_fma_f32 v160, v160, v18, v18
  v_mfma_f32_32x32x16_bf16 v[240:255], a[196:199], v[116:119], v[240:255]
  v_fma_f32 v161, v161, v18, v18
  v_fma_f32 v162, v162, v18, v18
  v_fma_f32 v163, v163, v18, v18
s_waitcnt lgkmcnt(0)
s_waitcnt vmcnt(22)
  s_barrier
s_nop 0
  v_mfma_f32_32x32x16_bf16 v[224:239], a[72:75], v[120:123], v[224:239]
  s_add_u32 s43, s40, 589824
  s_add_u32 m0, s42, 81920
s_nop 0
s_nop 0
  buffer_load_dwordx4 v3, s[12:15], s43 offen lds
  buffer_load_dwordx4 v4, s[12:15], s43 offen offset:1024 lds
  ds_read_b64_tr_b16 v[144:145], v9 offset:16384
  ds_read_b64_tr_b16 v[146:147], v9 offset:16896
  v_fma_f32 v164, v164, v18, v18
  v_mfma_f32_32x32x16_bf16 v[240:255], a[200:203], v[120:123], v[240:255]
  v_fma_f32 v165, v165, v18, v18
  v_fma_f32 v166, v166, v18, v18
  v_fma_f32 v167, v167, v18, v18
  v_mfma_f32_16x16x32_bf16 v[24:27], v[12:15], v[152:155], v[24:27]
  v_mfma_f32_32x32x16_bf16 v[224:239], a[76:79], v[124:127], v[224:239]
  s_add_u32 s43, s40, 786432
  s_add_u32 m0, s42, 73728
s_nop 0
s_nop 0
  buffer_load_dwordx4 v3, s[12:15], s43 offen lds
  buffer_load_dwordx4 v4, s[12:15], s43 offen offset:1024 lds
  ds_read_b64_tr_b16 v[148:149], v9 offset:18432
  ds_read_b64_tr_b16 v[150:151], v9 offset:18944
  v_rcp_f32_e64 v160, v160
  v_mfma_f32_32x32x16_bf16 v[240:255], a[204:207], v[124:127], v[240:255]
  v_rcp_f32_e32 v161, v161
  v_rcp_f32_e32 v162, v162
  v_rcp_f32_e64 v163, v163
  v_mfma_f32_16x16x32_bf16 v[24:27], v[12:15], v[156:159], v[24:27]
  v_mfma_f32_32x32x16_bf16 v[224:239], a[80:83], v[128:131], v[224:239]
  ds_read_b64_tr_b16 v[112:113], v9 offset:20480
  ds_read_b64_tr_b16 v[114:115], v9 offset:20992
  v_add_u32_e64 v56, s63, v9
  ds_read_b64_tr_b16 v[152:153], v56 offset:24576
  ds_read_b64_tr_b16 v[154:155], v56 offset:25088
  v_mfma_f32_32x32x16_bf16 v[240:255], a[208:211], v[128:131], v[240:255]
  ds_read_b64_tr_b16 v[156:157], v56 offset:28672
  ds_read_b64_tr_b16 v[158:159], v56 offset:29184
  v_rcp_f32_e32 v164, v164
  v_rcp_f32_e32 v165, v165
  v_rcp_f32_e32 v166, v166
  v_rcp_f32_e32 v167, v167
  v_mfma_f32_32x32x16_bf16 v[224:239], a[84:87], v[132:135], v[224:239]
  ds_read_b64_tr_b16 v[116:117], v9 offset:22528
  ds_read_b64_tr_b16 v[118:119], v9 offset:23040
  v_mul_f32_e64 v192, v192, v160
  v_mfma_f32_32x32x16_bf16 v[240:255], a[212:215], v[132:135], v[240:255]
  v_mul_f32_e32 v193, v193, v161
  v_mul_f32_e32 v194, v194, v162
  v_mul_f32_e64 v195, v195, v163
  v_mfma_f32_32x32x16_bf16 v[224:239], a[88:91], v[136:139], v[224:239]
  ds_read_b64_tr_b16 v[120:121], v9 offset:8192
  ds_read_b64_tr_b16 v[122:123], v9 offset:8704
  v_mul_f32_e64 v196, v196, v164
  v_mfma_f32_32x32x16_bf16 v[240:255], a[216:219], v[136:139], v[240:255]
  v_mul_f32_e32 v197, v197, v165
  v_mul_f32_e32 v198, v198, v166
  v_mul_f32_e32 v199, v199, v167
s_waitcnt lgkmcnt(6)
  v_mfma_f32_16x16x32_bf16 v[24:27], v[12:15], v[152:155], v[24:27]
  v_mfma_f32_32x32x16_bf16 v[224:239], a[92:95], v[140:143], v[224:239]
  ds_read_b64_tr_b16 v[124:125], v9 offset:10240
  ds_read_b64_tr_b16 v[126:127], v9 offset:10752
  v_cvt_pk_bf16_f32 v160, v192, v193
  v_mfma_f32_32x32x16_bf16 v[240:255], a[220:223], v[140:143], v[240:255]
  v_cvt_pk_bf16_f32 v161, v194, v195
  v_cvt_pk_bf16_f32 v162, v196, v197
  v_cvt_pk_bf16_f32 v163, v198, v199
s_waitcnt lgkmcnt(6)
s_nop 0
  v_mfma_f32_16x16x32_bf16 v[24:27], v[12:15], v[156:159], v[24:27]
  v_mfma_f32_32x32x16_bf16 v[224:239], a[96:99], v[144:147], v[224:239]
  ds_read_b64_tr_b16 v[128:129], v9 offset:12288
  ds_read_b64_tr_b16 v[130:131], v9 offset:12800
  v_add_u32_e64 v56, s63, v9
  ds_read_b64_tr_b16 v[152:153], v56 offset:16384
  ds_read_b64_tr_b16 v[154:155], v56 offset:16896
  v_mfma_f32_32x32x16_bf16 v[240:255], a[224:227], v[144:147], v[240:255]
  ds_read_b64_tr_b16 v[156:157], v56 offset:20480
  ds_read_b64_tr_b16 v[158:159], v56 offset:20992
  buffer_store_dwordx4 v[160:163], v10, s[24:27], s48 offen offset:0 sc1
  v_mul_f32_e32 v168, v168, v16
  v_mul_f32_e32 v169, v169, v16
  v_mul_f32_e64 v170, v170, v16
  v_mfma_f32_32x32x16_bf16 v[224:239], a[100:103], v[148:151], v[224:239]
  ds_read_b64_tr_b16 v[132:133], v9 offset:14336
  ds_read_b64_tr_b16 v[134:135], v9 offset:14848
  v_mul_f32_e64 v171, v171, v16
  v_mfma_f32_32x32x16_bf16 v[240:255], a[228:231], v[148:151], v[240:255]
  v_mul_f32_e32 v172, v172, v16
  v_mul_f32_e32 v173, v173, v16
  v_mul_f32_e32 v174, v174, v16
s_waitcnt vmcnt(23)
  s_barrier
s_nop 0
  v_mfma_f32_32x32x16_bf16 v[224:239], a[104:107], v[112:115], v[224:239]
  s_add_u32 s43, s40, 983040
  s_add_u32 m0, s42, 155648
s_nop 0
s_nop 0
  buffer_load_dwordx4 v3, s[12:15], s43 offen lds
  buffer_load_dwordx4 v4, s[12:15], s43 offen offset:1024 lds
  ds_read_b64_tr_b16 v[136:137], v9 offset:0
  ds_read_b64_tr_b16 v[138:139], v9 offset:512
  v_mul_f32_e64 v175, v175, v16
  v_mfma_f32_32x32x16_bf16 v[240:255], a[232:235], v[112:115], v[240:255]
  v_exp_f32_e32 v168, v168
  v_exp_f32_e32 v169, v169
  v_exp_f32_e32 v170, v170
s_waitcnt lgkmcnt(6)
  v_mfma_f32_16x16x32_bf16 v[24:27], v[12:15], v[152:155], v[24:27]
  v_mfma_f32_32x32x16_bf16 v[224:239], a[108:111], v[116:119], v[224:239]
  s_add_u32 s43, s40, 1179648
  s_add_u32 m0, s42, 65536
s_nop 0
s_nop 0
  buffer_load_dwordx4 v3, s[12:15], s43 offen lds
  buffer_load_dwordx4 v4, s[12:15], s43 offen offset:1024 lds
  ds_read_b64_tr_b16 v[140:141], v9 offset:2048
  ds_read_b64_tr_b16 v[142:143], v9 offset:2560
  v_exp_f32_e64 v171, v171
  v_mfma_f32_32x32x16_bf16 v[240:255], a[236:239], v[116:119], v[240:255]
  v_exp_f32_e32 v172, v172
  v_exp_f32_e32 v173, v173
  v_exp_f32_e32 v174, v174
s_waitcnt lgkmcnt(6)
  v_mfma_f32_16x16x32_bf16 v[24:27], v[12:15], v[156:159], v[24:27]
  v_mfma_f32_32x32x16_bf16 v[224:239], a[112:115], v[120:123], v[224:239]
  ds_read_b64_tr_b16 v[144:145], v9 offset:4096
  ds_read_b64_tr_b16 v[146:147], v9 offset:4608
  v_add_u32_e64 v56, s63, v9
  ds_read_b64_tr_b16 v[152:153], v56 offset:8192
  ds_read_b64_tr_b16 v[154:155], v56 offset:8704
  v_mfma_f32_32x32x16_bf16 v[240:255], a[240:243], v[120:123], v[240:255]
  ds_read_b64_tr_b16 v[156:157], v56 offset:12288
  ds_read_b64_tr_b16 v[158:159], v56 offset:12800
  v_exp_f32_e64 v175, v175
  v_fma_f32 v168, v168, v18, v18
  v_fma_f32 v169, v169, v18, v18
  v_fma_f32 v170, v170, v18, v18
  v_mfma_f32_32x32x16_bf16 v[224:239], a[116:119], v[124:127], v[224:239]
  ds_read_b64_tr_b16 v[148:149], v9 offset:6144
  ds_read_b64_tr_b16 v[150:151], v9 offset:6656
  v_fma_f32 v171, v171, v18, v18
  v_mfma_f32_32x32x16_bf16 v[240:255], a[244:247], v[124:127], v[240:255]
  v_fma_f32 v172, v172, v18, v18
  v_fma_f32 v173, v173, v18, v18
  v_fma_f32 v174, v174, v18, v18
  v_mfma_f32_32x32x16_bf16 v[224:239], a[120:123], v[128:131], v[224:239]
  ds_read_b64_tr_b16 v[112:113], v8 offset:57344
  ds_read_b64_tr_b16 v[114:115], v8 offset:57856
  v_fma_f32 v175, v175, v18, v18
  v_mfma_f32_32x32x16_bf16 v[240:255], a[248:251], v[128:131], v[240:255]
  v_rcp_f32_e32 v168, v168
  v_rcp_f32_e32 v169, v169
  v_rcp_f32_e32 v170, v170
s_waitcnt lgkmcnt(6)
  v_mfma_f32_16x16x32_bf16 v[24:27], v[12:15], v[152:155], v[24:27]
  v_mfma_f32_32x32x16_bf16 v[224:239], a[124:127], v[132:135], v[224:239]
  ds_read_b64_tr_b16 v[116:117], v8 offset:59392
  ds_read_b64_tr_b16 v[118:119], v8 offset:59904
  v_rcp_f32_e64 v171, v171
  v_mfma_f32_32x32x16_bf16 v[240:255], a[252:255], v[132:135], v[240:255]
  v_rcp_f32_e32 v172, v172
  v_rcp_f32_e32 v173, v173
  v_rcp_f32_e32 v174, v174
s_waitcnt lgkmcnt(6)
  v_mfma_f32_16x16x32_bf16 v[24:27], v[12:15], v[156:159], v[24:27]
s_nop 7
s_nop 0
  ds_write_b32 v41, v24 offset:4096
  v_mfma_f32_32x32x16_bf16 v[60:75], a[0:3], v[136:139], 0
  ds_read_b64_tr_b16 v[120:121], v8 offset:61440
  ds_read_b64_tr_b16 v[122:123], v8 offset:61952
  v_add_u32_e64 v56, s63, v9
  ds_read_b64_tr_b16 v[152:153], v56 offset:0
  ds_read_b64_tr_b16 v[154:155], v56 offset:512
  v_mfma_f32_32x32x16_bf16 v[76:91], a[128:131], v[136:139], 0
  ds_read_b64_tr_b16 v[156:157], v56 offset:4096
  ds_read_b64_tr_b16 v[158:159], v56 offset:4608
  v_rcp_f32_e32 v175, v175
  v_mul_f32_e32 v200, v200, v168
  v_mul_f32_e32 v201, v201, v169
  v_mul_f32_e32 v202, v202, v170
  v_mfma_f32_32x32x16_bf16 v[60:75], a[4:7], v[140:143], v[60:75]
  ds_read_b64_tr_b16 v[124:125], v8 offset:63488
  ds_read_b64_tr_b16 v[126:127], v8 offset:64000
  v_mul_f32_e64 v203, v203, v171
  v_mfma_f32_32x32x16_bf16 v[76:91], a[132:135], v[140:143], v[76:91]
  v_mul_f32_e32 v204, v204, v172
  v_mul_f32_e32 v205, v205, v173
  v_mul_f32_e32 v206, v206, v174
s_waitcnt lgkmcnt(0)
s_waitcnt vmcnt(23)
  s_barrier
  v_mfma_f32_32x32x16_bf16 v[60:75], a[8:11], v[144:147], v[60:75]
  s_add_u32 s43, s40, 1376256
  s_add_u32 m0, s42, 147456
s_nop 0
s_nop 0
  buffer_load_dwordx4 v3, s[12:15], s43 offen lds
  buffer_load_dwordx4 v4, s[12:15], s43 offen offset:1024 lds
  ds_read_b64_tr_b16 v[128:129], v7 offset:40960
  ds_read_b64_tr_b16 v[130:131], v7 offset:41472
  v_mul_f32_e64 v207, v207, v175
  v_mfma_f32_32x32x16_bf16 v[76:91], a[136:139], v[144:147], v[76:91]
  v_cvt_pk_bf16_f32 v168, v200, v201
  v_cvt_pk_bf16_f32 v169, v202, v203
  v_cvt_pk_bf16_f32 v170, v204, v205
  ds_read_b64 v[48:49], v42 offset:4096
  v_mfma_f32_16x16x32_bf16 v[24:27], v[12:15], v[152:155], 0
  v_mfma_f32_32x32x16_bf16 v[60:75], a[12:15], v[148:151], v[60:75]
  ds_read_b64_tr_b16 v[132:133], v7 offset:43008
  ds_read_b64_tr_b16 v[134:135], v7 offset:43520
  v_cvt_pk_bf16_f32 v171, v206, v207
  buffer_store_dwordx4 v[168:171], v10, s[24:27], s48 offen offset:1024 sc1
  v_mfma_f32_32x32x16_bf16 v[76:91], a[140:143], v[148:151], v[76:91]
  v_mul_f32_e32 v176, v176, v17
  v_mul_f32_e32 v177, v177, v17
s_waitcnt lgkmcnt(2)
  v_add_f32_e32 v48, v48, v49
  v_cvt_pk_bf16_f32 v49, v48, v48
  v_and_b32_e64 v49, s46, v49
  v_mfma_f32_16x16x32_bf16 v[24:27], v[12:15], v[156:159], v[24:27]
  v_mfma_f32_32x32x16_bf16 v[60:75], a[16:19], v[112:115], v[60:75]
  ds_read_b64_tr_b16 v[136:137], v7 offset:45056
  ds_read_b64_tr_b16 v[138:139], v7 offset:45568
  v_add_u32_e64 v56, s63, v8
  ds_read_b64_tr_b16 v[152:153], v56 offset:57344
  ds_read_b64_tr_b16 v[154:155], v56 offset:57856
  ds_read_b64_tr_b16 v[156:157], v56 offset:61440
  v_mfma_f32_32x32x16_bf16 v[76:91], a[144:147], v[112:115], v[76:91]
  ds_read_b64_tr_b16 v[158:159], v56 offset:61952
  v_mul_f32_e32 v178, v178, v17
  v_mul_f32_e32 v179, v179, v17
  v_mul_f32_e32 v180, v180, v17
  v_mul_f32_e32 v181, v181, v17
  v_sub_f32_e64 v49, v48, v49
  v_cvt_pk_bf16_f32 v36, v48, v49
  v_mfma_f32_32x32x16_bf16 v[60:75], a[20:23], v[116:119], v[60:75]
  ds_read_b64_tr_b16 v[140:141], v7 offset:47104
  ds_read_b64_tr_b16 v[142:143], v7 offset:47616
  v_mul_f32_e64 v182, v182, v17
  v_mfma_f32_32x32x16_bf16 v[76:91], a[148:151], v[116:119], v[76:91]
  v_mul_f32_e32 v183, v183, v17
  v_exp_f32_e32 v176, v176
  v_exp_f32_e64 v177, v177
  v_mfma_f32_32x32x16_bf16 v[60:75], a[24:27], v[120:123], v[60:75]
  ds_read_b64_tr_b16 v[144:145], v7 offset:32768
  ds_read_b64_tr_b16 v[146:147], v7 offset:33280
  v_exp_f32_e32 v178, v178
  v_exp_f32_e32 v179, v179
  v_exp_f32_e64 v180, v180
  v_mfma_f32_32x32x16_bf16 v[76:91], a[152:155], v[120:123], v[76:91]
  v_exp_f32_e64 v181, v181
  v_mfma_f32_32x32x16_bf16 v[224:239], v[28:31], v[36:39], v[224:239]
  v_mfma_f32_32x32x16_bf16 v[240:255], v[32:35], v[36:39], v[240:255]
  ds_read_b128 v[92:95], v44 offset:0
  ds_read_b128 v[96:99], v44 offset:32
  ds_read_b128 v[100:103], v44 offset:64
s_waitcnt lgkmcnt(9)
s_nop 0
  v_mfma_f32_16x16x32_bf16 v[24:27], v[12:15], v[152:155], v[24:27]
  v_mfma_f32_32x32x16_bf16 v[60:75], a[28:31], v[124:127], v[60:75]
  ds_read_b64_tr_b16 v[148:149], v7 offset:34816
  ds_read_b64_tr_b16 v[150:151], v7 offset:35328
  v_exp_f32_e64 v182, v182
  v_mfma_f32_32x32x16_bf16 v[76:91], a[156:159], v[124:127], v[76:91]
  v_exp_f32_e64 v183, v183
  v_fma_f32 v176, v176, v19, v19
  v_fma_f32 v177, v177, v19, v19
  ds_read_b128 v[104:107], v44 offset:96
s_waitcnt lgkmcnt(10)
s_nop 0
  v_mfma_f32_16x16x32_bf16 v[24:27], v[12:15], v[156:159], v[24:27]
  v_mfma_f32_32x32x16_bf16 v[60:75], a[32:35], v[128:131], v[60:75]
  ds_read_b64_tr_b16 v[112:113], v7 offset:36864
  ds_read_b64_tr_b16 v[114:115], v7 offset:37376
  v_add_u32_e64 v56, s63, v7
  ds_read_b64_tr_b16 v[152:153], v56 offset:40960
  ds_read_b64_tr_b16 v[154:155], v56 offset:41472
  ds_read_b64_tr_b16 v[156:157], v56 offset:45056
  ds_read_b64_tr_b16 v[158:159], v56 offset:45568
  v_mfma_f32_32x32x16_bf16 v[76:91], a[160:163], v[128:131], v[76:91]
  v_fma_f32 v178, v178, v19, v19
  v_fma_f32 v179, v179, v19, v19
  v_fma_f32 v180, v180, v19, v19
  v_fma_f32 v181, v181, v19, v19
s_waitcnt lgkmcnt(11)
  v_mul_f32_e32 v224, v224, v92
  v_mul_f32_e32 v225, v225, v93
  v_mul_f32_e32 v226, v226, v94
  v_mfma_f32_32x32x16_bf16 v[60:75], a[36:39], v[132:135], v[60:75]
  ds_read_b64_tr_b16 v[116:117], v7 offset:38912
  ds_read_b64_tr_b16 v[118:119], v7 offset:39424
  v_fma_f32 v182, v182, v19, v19
  v_fma_f32 v183, v183, v19, v19
  v_mfma_f32_32x32x16_bf16 v[76:91], a[164:167], v[132:135], v[76:91]
  v_rcp_f32_e32 v176, v176
  v_rcp_f32_e32 v177, v177
  v_mul_f32_e32 v227, v227, v95
s_waitcnt lgkmcnt(12)
  v_mul_f32_e32 v228, v228, v96
  v_mul_f32_e32 v229, v229, v97
s_waitcnt vmcnt(22)
  s_barrier
  v_mfma_f32_32x32x16_bf16 v[60:75], a[40:43], v[136:139], v[60:75]
  ds_read_b64_tr_b16 v[120:121], v7 offset:24576
  ds_read_b64_tr_b16 v[122:123], v7 offset:25088
  v_rcp_f32_e32 v178, v178
  v_rcp_f32_e32 v179, v179
  v_mfma_f32_32x32x16_bf16 v[76:91], a[168:171], v[136:139], v[76:91]
  v_rcp_f32_e32 v180, v180
  v_rcp_f32_e32 v181, v181
  v_mul_f32_e32 v230, v230, v98
  v_mul_f32_e32 v231, v231, v99
s_waitcnt lgkmcnt(13)
  v_mul_f32_e32 v232, v232, v100
s_waitcnt lgkmcnt(6)
s_nop 0
  v_mfma_f32_16x16x32_bf16 v[24:27], v[12:15], v[152:155], v[24:27]
  v_mfma_f32_32x32x16_bf16 v[60:75], a[44:47], v[140:143], v[60:75]
  ds_read_b64_tr_b16 v[124:125], v7 offset:26624
  ds_read_b64_tr_b16 v[126:127], v7 offset:27136
  v_rcp_f32_e32 v182, v182
  v_rcp_f32_e32 v183, v183
  v_mfma_f32_32x32x16_bf16 v[76:91], a[172:175], v[140:143], v[76:91]
  v_mul_f32_e32 v208, v208, v176
  v_mul_f32_e32 v233, v233, v101
  v_mul_f32_e32 v234, v234, v102
  v_mul_f32_e32 v235, v235, v103
s_waitcnt lgkmcnt(6)
s_nop 0
  v_mfma_f32_16x16x32_bf16 v[24:27], v[12:15], v[156:159], v[24:27]
  v_mfma_f32_32x32x16_bf16 v[60:75], a[48:51], v[144:147], v[60:75]
  ds_read_b64_tr_b16 v[128:129], v7 offset:28672
  ds_read_b64_tr_b16 v[130:131], v7 offset:29184
  v_add_u32_e64 v56, s63, v7
  ds_read_b64_tr_b16 v[152:153], v56 offset:32768
  ds_read_b64_tr_b16 v[154:155], v56 offset:33280
  ds_read_b64_tr_b16 v[156:157], v56 offset:36864
  v_mfma_f32_32x32x16_bf16 v[76:91], a[176:179], v[144:147], v[76:91]
  ds_read_b64_tr_b16 v[158:159], v56 offset:37376
  v_mul_f32_e32 v209, v209, v177
  v_mul_f32_e32 v210, v210, v178
  v_mul_f32_e32 v211, v211, v179
  v_mul_f32_e32 v236, v236, v104
  v_mul_f32_e32 v237, v237, v105
  v_mul_f32_e32 v238, v238, v106
  v_mfma_f32_32x32x16_bf16 v[60:75], a[52:55], v[148:151], v[60:75]
  ds_read_b64_tr_b16 v[132:133], v7 offset:30720
  ds_read_b64_tr_b16 v[134:135], v7 offset:31232
  v_mul_f32_e32 v212, v212, v180
  v_mul_f32_e32 v213, v213, v181
  v_mfma_f32_32x32x16_bf16 v[76:91], a[180:183], v[148:151], v[76:91]
  v_mul_f32_e32 v214, v214, v182
  v_mul_f32_e32 v239, v239, v107
  v_cvt_pk_bf16_f32 v224, v224, v225
  v_cvt_pk_bf16_f32 v225, v226, v227
  v_mfma_f32_32x32x16_bf16 v[60:75], a[56:59], v[112:115], v[60:75]
  ds_read_b64_tr_b16 v[136:137], v8 offset:49152
  ds_read_b64_tr_b16 v[138:139], v8 offset:49664
  v_mul_f32_e64 v215, v215, v183
  v_cvt_pk_bf16_f32 v176, v208, v209
  v_mfma_f32_32x32x16_bf16 v[76:91], a[184:187], v[112:115], v[76:91]
  v_cvt_pk_bf16_f32 v177, v210, v211
  v_cvt_pk_bf16_f32 v226, v228, v229
  v_cvt_pk_bf16_f32 v227, v230, v231
  buffer_store_dwordx4 v[224:227], v11, s[24:27], s50 offen offset:0 sc1
s_waitcnt lgkmcnt(6)
s_nop 0
  v_mfma_f32_16x16x32_bf16 v[24:27], v[12:15], v[152:155], v[24:27]
  v_mfma_f32_32x32x16_bf16 v[60:75], a[60:63], v[116:119], v[60:75]
  ds_read_b64_tr_b16 v[140:141], v8 offset:51200
  ds_read_b64_tr_b16 v[142:143], v8 offset:51712
  v_cvt_pk_bf16_f32 v178, v212, v213
  v_cvt_pk_bf16_f32 v179, v214, v215
  v_mfma_f32_32x32x16_bf16 v[76:91], a[188:191], v[116:119], v[76:91]
  buffer_store_dwordx4 v[176:179], v10, s[24:27], s49 offen offset:0 sc1
  v_cvt_pk_bf16_f32 v232, v232, v233
  v_cvt_pk_bf16_f32 v233, v234, v235
  v_cvt_pk_bf16_f32 v234, v236, v237
s_waitcnt lgkmcnt(6)
s_nop 0
  v_mfma_f32_16x16x32_bf16 v[24:27], v[12:15], v[156:159], v[24:27]
  v_mfma_f32_32x32x16_bf16 v[60:75], a[64:67], v[120:123], v[60:75]
  ds_read_b64_tr_b16 v[144:145], v8 offset:53248
  ds_read_b64_tr_b16 v[146:147], v8 offset:53760
  v_add_u32_e64 v56, s63, v7
  ds_read_b64_tr_b16 v[152:153], v56 offset:24576
  ds_read_b64_tr_b16 v[154:155], v56 offset:25088
  ds_read_b64_tr_b16 v[156:157], v56 offset:28672
  v_mfma_f32_32x32x16_bf16 v[76:91], a[192:195], v[120:123], v[76:91]
  ds_read_b64_tr_b16 v[158:159], v56 offset:29184
  v_mul_f32_e32 v184, v184, v17
  v_mul_f32_e32 v185, v185, v17
  v_mul_f32_e64 v186, v186, v17
  v_cvt_pk_bf16_f32 v235, v238, v239
  buffer_store_dwordx4 v[232:235], v11, s[24:27], s50 offen offset:512 sc1
  ds_read_b128 v[92:95], v44 offset:128
  v_mfma_f32_32x32x16_bf16 v[60:75], a[68:71], v[124:127], v[60:75]
  ds_read_b64_tr_b16 v[148:149], v8 offset:55296
  ds_read_b64_tr_b16 v[150:151], v8 offset:55808
  v_mul_f32_e32 v187, v187, v17
  v_mul_f32_e32 v188, v188, v17
  v_mfma_f32_32x32x16_bf16 v[76:91], a[196:199], v[124:127], v[76:91]
  v_mul_f32_e64 v189, v189, v17
  ds_read_b128 v[96:99], v44 offset:160
  ds_read_b128 v[100:103], v44 offset:192
  ds_read_b128 v[104:107], v44 offset:224
s_waitcnt vmcnt(21)
  s_barrier
  v_mfma_f32_32x32x16_bf16 v[60:75], a[72:75], v[128:131], v[60:75]
  ds_read_b64_tr_b16 v[112:113], v8 offset:40960
  ds_read_b64_tr_b16 v[114:115], v8 offset:41472
  v_mfma_f32_32x32x16_bf16 v[76:91], a[200:203], v[128:131], v[76:91]
  v_mul_f32_e32 v190, v190, v17
  v_mul_f32_e32 v191, v191, v17
  v_exp_f32_e32 v184, v184
s_waitcnt lgkmcnt(10)
  v_mfma_f32_16x16x32_bf16 v[24:27], v[12:15], v[152:155], v[24:27]
  v_mfma_f32_32x32x16_bf16 v[60:75], a[76:79], v[132:135], v[60:75]
  ds_read_b64_tr_b16 v[116:117], v8 offset:43008
  ds_read_b64_tr_b16 v[118:119], v8 offset:43520
  v_exp_f32_e32 v185, v185
  v_exp_f32_e32 v186, v186
  v_mfma_f32_32x32x16_bf16 v[76:91], a[204:207], v[132:135], v[76:91]
  v_exp_f32_e32 v187, v187
s_waitcnt lgkmcnt(9)
  v_mul_f32_e32 v240, v240, v92
  v_mul_f32_e32 v241, v241, v93
  v_mul_f32_e64 v242, v242, v94
  v_mfma_f32_16x16x32_bf16 v[24:27], v[12:15], v[156:159], v[24:27]
  v_mfma_f32_32x32x16_bf16 v[60:75], a[80:83], v[136:139], v[60:75]
  ds_read_b64_tr_b16 v[120:121], v8 offset:45056
  ds_read_b64_tr_b16 v[122:123], v8 offset:45568
  v_add_u32_e64 v56, s63, v8
  ds_read_b64_tr_b16 v[152:153], v56 offset:49152
  ds_read_b64_tr_b16 v[154:155], v56 offset:49664
  ds_read_b64_tr_b16 v[156:157], v56 offset:53248
  v_mfma_f32_32x32x16_bf16 v[76:91], a[208:211], v[136:139], v[76:91]
  ds_read_b64_tr_b16 v[158:159], v56 offset:53760
  v_exp_f32_e32 v188, v188
  v_exp_f32_e32 v189, v189
  v_exp_f32_e32 v190, v190
  v_mul_f32_e32 v243, v243, v95
s_waitcnt lgkmcnt(12)
  v_mul_f32_e32 v244, v244, v96
  v_mul_f32_e64 v245, v245, v97
  v_mfma_f32_32x32x16_bf16 v[60:75], a[84:87], v[140:143], v[60:75]
  ds_read_b64_tr_b16 v[124:125], v8 offset:47104
  ds_read_b64_tr_b16 v[126:127], v8 offset:47616
  v_exp_f32_e64 v191, v191
  v_mfma_f32_32x32x16_bf16 v[76:91], a[212:215], v[140:143], v[76:91]
  v_fma_f32 v184, v184, v19, v19
  v_fma_f32 v185, v185, v19, v19
  v_mul_f32_e32 v246, v246, v98
  v_mul_f32_e32 v247, v247, v99
  v_mfma_f32_32x32x16_bf16 v[60:75], a[88:91], v[144:147], v[60:75]
  ds_read_b64_tr_b16 v[128:129], v7 offset:57344
  ds_read_b64_tr_b16 v[130:131], v7 offset:57856
  v_fma_f32 v186, v186, v19, v19
  v_mfma_f32_32x32x16_bf16 v[76:91], a[216:219], v[144:147], v[76:91]
  v_fma_f32 v187, v187, v19, v19
  v_fma_f32 v188, v188, v19, v19
s_waitcnt lgkmcnt(15)
  v_mul_f32_e32 v248, v248, v100
  v_mul_f32_e32 v249, v249, v101
s_waitcnt lgkmcnt(6)
  v_mfma_f32_16x16x32_bf16 v[24:27], v[12:15], v[152:155], v[24:27]
  v_mfma_f32_32x32x16_bf16 v[60:75], a[92:95], v[148:151], v[60:75]
  ds_read_b64_tr_b16 v[132:133], v7 offset:59392
  ds_read_b64_tr_b16 v[134:135], v7 offset:59904
  v_fma_f32 v189, v189, v19, v19
  v_mfma_f32_32x32x16_bf16 v[76:91], a[220:223], v[148:151], v[76:91]
  v_fma_f32 v190, v190, v19, v19
  v_fma_f32 v191, v191, v19, v19
  v_mul_f32_e32 v250, v250, v102
  v_mul_f32_e32 v251, v251, v103
s_waitcnt lgkmcnt(6)
s_nop 0
  v_mfma_f32_16x16x32_bf16 v[24:27], v[12:15], v[156:159], v[24:27]
  v_mfma_f32_32x32x16_bf16 v[60:75], a[96:99], v[112:115], v[60:75]
  ds_read_b64_tr_b16 v[136:137], v7 offset:61440
  ds_read_b64_tr_b16 v[138:139], v7 offset:61952
  v_add_u32_e64 v56, s63, v8
  ds_read_b64_tr_b16 v[152:153], v56 offset:40960
  ds_read_b64_tr_b16 v[154:155], v56 offset:41472
  ds_read_b64_tr_b16 v[156:157], v56 offset:45056
  v_mfma_f32_32x32x16_bf16 v[76:91], a[224:227], v[112:115], v[76:91]
  ds_read_b64_tr_b16 v[158:159], v56 offset:45568
  v_rcp_f32_e32 v184, v184
  v_rcp_f32_e32 v185, v185
  v_rcp_f32_e32 v186, v186
  v_mul_f32_e32 v252, v252, v104
  v_mul_f32_e64 v253, v253, v105
  v_mfma_f32_32x32x16_bf16 v[60:75], a[100:103], v[116:119], v[60:75]
  ds_read_b64_tr_b16 v[140:141], v7 offset:63488
  ds_read_b64_tr_b16 v[142:143], v7 offset:64000
  v_rcp_f32_e64 v187, v187
  v_mfma_f32_32x32x16_bf16 v[76:91], a[228:231], v[116:119], v[76:91]
  v_rcp_f32_e32 v188, v188
  v_rcp_f32_e32 v189, v189
  v_mul_f32_e32 v254, v254, v106
  v_mul_f32_e32 v255, v255, v107
s_waitcnt vmcnt(17)
  s_barrier
  v_mfma_f32_32x32x16_bf16 v[60:75], a[104:107], v[120:123], v[60:75]
  ds_read_b64_tr_b16 v[144:145], v7 offset:49152
  ds_read_b64_tr_b16 v[146:147], v7 offset:49664
  v_rcp_f32_e64 v190, v190
  v_mfma_f32_32x32x16_bf16 v[76:91], a[232:235], v[120:123], v[76:91]
  v_rcp_f32_e32 v191, v191
  v_mul_f32_e32 v216, v216, v184
  v_cvt_pk_bf16_f32 v240, v240, v241
  v_cvt_pk_bf16_f32 v241, v242, v243
s_waitcnt lgkmcnt(6)
s_nop 0
  v_mfma_f32_16x16x32_bf16 v[24:27], v[12:15], v[152:155], v[24:27]
  v_mfma_f32_32x32x16_bf16 v[60:75], a[108:111], v[124:127], v[60:75]
  ds_read_b64_tr_b16 v[148:149], v7 offset:51200
  ds_read_b64_tr_b16 v[150:151], v7 offset:51712
  v_mul_f32_e64 v217, v217, v185
  v_mfma_f32_32x32x16_bf16 v[76:91], a[236:239], v[124:127], v[76:91]
  v_mul_f32_e32 v218, v218, v186
  v_mul_f32_e32 v219, v219, v187
  v_cvt_pk_bf16_f32 v242, v244, v245
  v_cvt_pk_bf16_f32 v243, v246, v247
s_waitcnt lgkmcnt(6)
s_nop 0
  v_mfma_f32_16x16x32_bf16 v[24:27], v[12:15], v[156:159], v[24:27]
  v_mfma_f32_32x32x16_bf16 v[60:75], a[112:115], v[128:131], v[60:75]
  ds_read_b64_tr_b16 v[112:113], v7 offset:53248
  ds_read_b64_tr_b16 v[114:115], v7 offset:53760
  v_add_u32_e64 v56, s63, v7
  ds_read_b64_tr_b16 v[152:153], v56 offset:57344
  ds_read_b64_tr_b16 v[154:155], v56 offset:57856
  ds_read_b64_tr_b16 v[156:157], v56 offset:61440
  v_mfma_f32_32x32x16_bf16 v[76:91], a[240:243], v[128:131], v[76:91]
  ds_read_b64_tr_b16 v[158:159], v56 offset:61952
  v_mul_f32_e32 v220, v220, v188
  v_mul_f32_e32 v221, v221, v189
  v_mul_f32_e64 v222, v222, v190
  buffer_store_dwordx4 v[240:243], v11, s[24:27], s50 offen offset:1024 sc1
  v_cvt_pk_bf16_f32 v248, v248, v249
  v_mfma_f32_32x32x16_bf16 v[60:75], a[116:119], v[132:135], v[60:75]
  ds_read_b64_tr_b16 v[116:117], v7 offset:55296
  ds_read_b64_tr_b16 v[118:119], v7 offset:55808
  v_mul_f32_e64 v223, v223, v191
  v_mfma_f32_32x32x16_bf16 v[76:91], a[244:247], v[132:135], v[76:91]
  v_cvt_pk_bf16_f32 v184, v216, v217
  v_cvt_pk_bf16_f32 v185, v218, v219
  v_cvt_pk_bf16_f32 v249, v250, v251
  v_cvt_pk_bf16_f32 v250, v252, v253
  v_mfma_f32_32x32x16_bf16 v[60:75], a[120:123], v[136:139], v[60:75]
  ds_read_b64_tr_b16 v[120:121], v8 offset:32768
  ds_read_b64_tr_b16 v[122:123], v8 offset:33280
  v_cvt_pk_bf16_f32 v186, v220, v221
  v_mfma_f32_32x32x16_bf16 v[76:91], a[248:251], v[136:139], v[76:91]
  v_cvt_pk_bf16_f32 v187, v222, v223
  buffer_store_dwordx4 v[184:187], v10, s[24:27], s49 offen offset:1024 sc1
  v_cvt_pk_bf16_f32 v251, v254, v255
  buffer_store_dwordx4 v[248:251], v11, s[24:27], s50 offen offset:1536 sc1
s_waitcnt lgkmcnt(6)
s_nop 0
  v_mfma_f32_16x16x32_bf16 v[24:27], v[12:15], v[152:155], v[24:27]
  v_mfma_f32_32x32x16_bf16 v[60:75], a[124:127], v[140:143], v[60:75]
  ds_read_b64_tr_b16 v[124:125], v8 offset:34816
  v_mfma_f32_32x32x16_bf16 v[76:91], a[252:255], v[140:143], v[76:91]
  ds_read_b64_tr_b16 v[126:127], v8 offset:35328
s_waitcnt lgkmcnt(6)
s_nop 0
  v_mfma_f32_16x16x32_bf16 v[24:27], v[12:15], v[156:159], v[24:27]
s_nop 7
s_nop 0
  ds_write_b32 v41, v24 offset:5120
  v_mfma_f32_32x32x16_bf16 v[160:175], v[144:147], a[0:3], 0
  ds_read_b64_tr_b16 v[128:129], v8 offset:36864
  ds_read_b64_tr_b16 v[130:131], v8 offset:37376
  v_add_u32_e64 v56, s63, v7
  ds_read_b64_tr_b16 v[152:153], v56 offset:49152
  v_mfma_f32_32x32x16_bf16 v[176:191], v[144:147], a[128:131], 0
  ds_read_b64_tr_b16 v[154:155], v56 offset:49664
  ds_read_b64_tr_b16 v[156:157], v56 offset:53248
  ds_read_b64_tr_b16 v[158:159], v56 offset:53760
  s_cmp_ge_u32 s2, 144
  s_cbranch_scc1 K1B_w2b
s_nop 0
  s_mul_i32 s43, s57, 576
  s_add_u32 s43, s43, s2
  s_lshl_b32 s43, s43, 10
  s_add_u32 s43, s43, 15728640
  s_waitcnt vmcnt(18)
s_nop 0
  ds_read_b64_tr_b16 v[92:93], v46 offset:0
  ds_read_b64_tr_b16 v[94:95], v46 offset:2048
  ds_read_b64_tr_b16 v[96:97], v46 offset:64
  ds_read_b64_tr_b16 v[98:99], v46 offset:2112
  ds_read_b64_tr_b16 v[100:101], v46 offset:128
  ds_read_b64_tr_b16 v[102:103], v46 offset:2176
  ds_read_b64_tr_b16 v[104:105], v46 offset:192
  ds_read_b64_tr_b16 v[106:107], v46 offset:2240
s_waitcnt lgkmcnt(0)
s_nop 0
  buffer_store_dwordx4 v[92:95], v10, s[24:27], s43 offen sc1
  s_add_u32 s43, s43, 147456
  buffer_store_dwordx4 v[96:99], v10, s[24:27], s43 offen sc1
  s_add_u32 s43, s43, 147456
  buffer_store_dwordx4 v[100:103], v10, s[24:27], s43 offen sc1
  s_add_u32 s43, s43, 147456
  buffer_store_dwordx4 v[104:107], v10, s[24:27], s43 offen sc1
s_nop 1
s_nop 0
K1B_w2b:
  v_mfma_f32_32x32x16_bf16 v[160:175], v[148:151], a[4:7], v[160:175]
  ds_read_b64_tr_b16 v[132:133], v8 offset:38912
  v_mfma_f32_32x32x16_bf16 v[176:191], v[148:151], a[132:135], v[176:191]
  ds_read_b64_tr_b16 v[134:135], v8 offset:39424
s_waitcnt lgkmcnt(0)
s_waitcnt vmcnt(16)
  s_barrier
s_nop 0
  v_mfma_f32_32x32x16_bf16 v[160:175], v[112:115], a[8:11], v[160:175]
  ds_read_b64_tr_b16 v[136:137], v8 offset:24576
  v_mfma_f32_32x32x16_bf16 v[176:191], v[112:115], a[136:139], v[176:191]
  ds_read_b64_tr_b16 v[138:139], v8 offset:25088
  ds_read_b64 v[48:49], v42 offset:5120
  v_mfma_f32_16x16x32_bf16 v[24:27], v[12:15], v[152:155], 0
  v_mfma_f32_32x32x16_bf16 v[160:175], v[116:119], a[12:15], v[160:175]
  ds_read_b64_tr_b16 v[140:141], v8 offset:26624
  ds_read_b64_tr_b16 v[142:143], v8 offset:27136
  v_mfma_f32_32x32x16_bf16 v[176:191], v[116:119], a[140:143], v[176:191]
s_waitcnt lgkmcnt(2)
  v_add_f32_e32 v48, v48, v49
  v_cvt_pk_bf16_f32 v49, v48, v48
  v_and_b32_e64 v49, s46, v49
  v_mfma_f32_16x16x32_bf16 v[24:27], v[12:15], v[156:159], v[24:27]
  v_mfma_f32_32x32x16_bf16 v[160:175], v[120:123], a[16:19], v[160:175]
  ds_read_b64_tr_b16 v[144:145], v8 offset:28672
  ds_read_b64_tr_b16 v[146:147], v8 offset:29184
  v_add_u32_e64 v56, s63, v8
  ds_read_b64_tr_b16 v[152:153], v56 offset:32768
  v_mfma_f32_32x32x16_bf16 v[176:191], v[120:123], a[144:147], v[176:191]
  ds_read_b64_tr_b16 v[154:155], v56 offset:33280
  ds_read_b64_tr_b16 v[156:157], v56 offset:36864
  ds_read_b64_tr_b16 v[158:159], v56 offset:37376
  v_sub_f32_e64 v49, v48, v49
  v_cvt_pk_bf16_f32 v36, v48, v49
  v_mfma_f32_32x32x16_bf16 v[160:175], v[124:127], a[20:23], v[160:175]
  ds_read_b64_tr_b16 v[148:149], v8 offset:30720
  v_mfma_f32_32x32x16_bf16 v[176:191], v[124:127], a[148:151], v[176:191]
  ds_read_b64_tr_b16 v[150:151], v8 offset:31232
  v_mfma_f32_32x32x16_bf16 v[160:175], v[128:131], a[24:27], v[160:175]
  ds_read_b64_tr_b16 v[112:113], v8 offset:16384
  ds_read_b64_tr_b16 v[114:115], v8 offset:16896
  v_mfma_f32_32x32x16_bf16 v[60:75], v[28:31], v[36:39], v[60:75]
  v_mfma_f32_32x32x16_bf16 v[176:191], v[128:131], a[152:155], v[176:191]
  v_mfma_f32_32x32x16_bf16 v[76:91], v[32:35], v[36:39], v[76:91]
  ds_read_b128 v[92:95], v44 offset:0
  ds_read_b128 v[96:99], v44 offset:32
  ds_read_b128 v[100:103], v44 offset:64
s_waitcnt lgkmcnt(9)
s_nop 0
  v_mfma_f32_16x16x32_bf16 v[24:27], v[12:15], v[152:155], v[24:27]
  v_mfma_f32_32x32x16_bf16 v[160:175], v[132:135], a[28:31], v[160:175]
  ds_read_b64_tr_b16 v[116:117], v8 offset:18432
  v_mfma_f32_32x32x16_bf16 v[176:191], v[132:135], a[156:159], v[176:191]
  ds_read_b64_tr_b16 v[118:119], v8 offset:18944
  ds_read_b128 v[104:107], v44 offset:96
s_waitcnt lgkmcnt(10)
s_nop 0
  v_mfma_f32_16x16x32_bf16 v[24:27], v[12:15], v[156:159], v[24:27]
  v_mfma_f32_32x32x16_bf16 v[160:175], v[136:139], a[32:35], v[160:175]
  ds_read_b64_tr_b16 v[120:121], v8 offset:20480
  ds_read_b64_tr_b16 v[122:123], v8 offset:20992
  v_add_u32_e64 v56, s63, v8
  ds_read_b64_tr_b16 v[152:153], v56 offset:24576
  ds_read_b64_tr_b16 v[154:155], v56 offset:25088
  v_mfma_f32_32x32x16_bf16 v[176:191], v[136:139], a[160:163], v[176:191]
  ds_read_b64_tr_b16 v[156:157], v56 offset:28672
  ds_read_b64_tr_b16 v[158:159], v56 offset:29184
s_waitcnt lgkmcnt(11)
  v_mul_f32_e32 v60, v60, v92
  v_mul_f32_e32 v61, v61, v93
  v_mul_f32_e32 v62, v62, v94
  v_mfma_f32_32x32x16_bf16 v[160:175], v[140:143], a[36:39], v[160:175]
  ds_read_b64_tr_b16 v[124:125], v8 offset:22528
  ds_read_b64_tr_b16 v[126:127], v8 offset:23040
  v_mfma_f32_32x32x16_bf16 v[176:191], v[140:143], a[164:167], v[176:191]
  v_mul_f32_e32 v63, v63, v95
s_waitcnt lgkmcnt(12)
  v_mul_f32_e32 v64, v64, v96
  v_mul_f32_e32 v65, v65, v97
s_waitcnt vmcnt(11)
  s_barrier
  v_mfma_f32_32x32x16_bf16 v[160:175], v[144:147], a[40:43], v[160:175]
  ds_read_b64_tr_b16 v[128:129], v8 offset:8192
  ds_read_b64_tr_b16 v[130:131], v8 offset:8704
  v_mfma_f32_32x32x16_bf16 v[176:191], v[144:147], a[168:171], v[176:191]
  v_mul_f32_e32 v66, v66, v98
  v_mul_f32_e32 v67, v67, v99
s_waitcnt lgkmcnt(13)
  v_mul_f32_e32 v68, v68, v100
s_waitcnt lgkmcnt(6)
s_nop 0
  v_mfma_f32_16x16x32_bf16 v[24:27], v[12:15], v[152:155], v[24:27]
  v_mfma_f32_32x32x16_bf16 v[160:175], v[148:151], a[44:47], v[160:175]
  ds_read_b64_tr_b16 v[132:133], v8 offset:10240
  ds_read_b64_tr_b16 v[134:135], v8 offset:10752
  v_mfma_f32_32x32x16_bf16 v[176:191], v[148:151], a[172:175], v[176:191]
  v_mul_f32_e32 v69, v69, v101
  v_mul_f32_e32 v70, v70, v102
  v_mul_f32_e32 v71, v71, v103
s_waitcnt lgkmcnt(6)
  v_mfma_f32_16x16x32_bf16 v[24:27], v[12:15], v[156:159], v[24:27]
  v_mfma_f32_32x32x16_bf16 v[160:175], v[112:115], a[48:51], v[160:175]
  ds_read_b64_tr_b16 v[136:137], v8 offset:12288
  ds_read_b64_tr_b16 v[138:139], v8 offset:12800
  v_add_u32_e64 v56, s63, v8
  ds_read_b64_tr_b16 v[152:153], v56 offset:16384
  ds_read_b64_tr_b16 v[154:155], v56 offset:16896
  v_mfma_f32_32x32x16_bf16 v[176:191], v[112:115], a[176:179], v[176:191]
  ds_read_b64_tr_b16 v[156:157], v56 offset:20480
  ds_read_b64_tr_b16 v[158:159], v56 offset:20992
  v_mul_f32_e32 v72, v72, v104
  v_mul_f32_e32 v73, v73, v105
  v_mul_f32_e64 v74, v74, v106
  v_mfma_f32_32x32x16_bf16 v[160:175], v[116:119], a[52:55], v[160:175]
  ds_read_b64_tr_b16 v[140:141], v8 offset:14336
  ds_read_b64_tr_b16 v[142:143], v8 offset:14848
  v_mfma_f32_32x32x16_bf16 v[176:191], v[116:119], a[180:183], v[176:191]
  v_mul_f32_e64 v75, v75, v107
  v_cvt_pk_bf16_f32 v60, v60, v61
  v_cvt_pk_bf16_f32 v61, v62, v63
  v_mfma_f32_32x32x16_bf16 v[160:175], v[120:123], a[56:59], v[160:175]
  ds_read_b64_tr_b16 v[144:145], v9 offset:24576
  ds_read_b64_tr_b16 v[146:147], v9 offset:25088
  v_mfma_f32_32x32x16_bf16 v[176:191], v[120:123], a[184:187], v[176:191]
  v_cvt_pk_bf16_f32 v62, v64, v65
  v_cvt_pk_bf16_f32 v63, v66, v67
  buffer_store_dwordx4 v[60:63], v11, s[24:27], s51 offen offset:0 sc1
s_waitcnt lgkmcnt(6)
s_nop 0
  v_mfma_f32_16x16x32_bf16 v[24:27], v[12:15], v[152:155], v[24:27]
  v_mfma_f32_32x32x16_bf16 v[160:175], v[124:127], a[60:63], v[160:175]
  ds_read_b64_tr_b16 v[148:149], v9 offset:26624
  ds_read_b64_tr_b16 v[150:151], v9 offset:27136
  v_mfma_f32_32x32x16_bf16 v[176:191], v[124:127], a[188:191], v[176:191]
  v_cvt_pk_bf16_f32 v68, v68, v69
  v_cvt_pk_bf16_f32 v69, v70, v71
  v_cvt_pk_bf16_f32 v70, v72, v73
s_waitcnt lgkmcnt(6)
s_nop 0
  v_mfma_f32_16x16x32_bf16 v[24:27], v[12:15], v[156:159], v[24:27]
  v_mfma_f32_32x32x16_bf16 v[160:175], v[128:131], a[64:67], v[160:175]
  ds_read_b64_tr_b16 v[112:113], v9 offset:28672
  ds_read_b64_tr_b16 v[114:115], v9 offset:29184
  v_add_u32_e64 v56, s63, v8
  ds_read_b64_tr_b16 v[152:153], v56 offset:8192
  ds_read_b64_tr_b16 v[154:155], v56 offset:8704
  v_mfma_f32_32x32x16_bf16 v[176:191], v[128:131], a[192:195], v[176:191]
  ds_read_b64_tr_b16 v[156:157], v56 offset:12288
  ds_read_b64_tr_b16 v[158:159], v56 offset:12800
  v_cvt_pk_bf16_f32 v71, v74, v75
  buffer_store_dwordx4 v[68:71], v11, s[24:27], s51 offen offset:512 sc1
  ds_read_b128 v[92:95], v44 offset:128
  v_mfma_f32_32x32x16_bf16 v[160:175], v[132:135], a[68:71], v[160:175]
  ds_read_b64_tr_b16 v[116:117], v9 offset:30720
  ds_read_b64_tr_b16 v[118:119], v9 offset:31232
  v_mfma_f32_32x32x16_bf16 v[176:191], v[132:135], a[196:199], v[176:191]
  ds_read_b128 v[96:99], v44 offset:160
  ds_read_b128 v[100:103], v44 offset:192
  ds_read_b128 v[104:107], v44 offset:224
s_waitcnt vmcnt(9)
  s_barrier
  v_mfma_f32_32x32x16_bf16 v[160:175], v[136:139], a[72:75], v[160:175]
  ds_read_b64_tr_b16 v[120:121], v8 offset:0
  v_mfma_f32_32x32x16_bf16 v[176:191], v[136:139], a[200:203], v[176:191]
  ds_read_b64_tr_b16 v[122:123], v8 offset:512
s_waitcnt lgkmcnt(10)
s_nop 0
  v_mfma_f32_16x16x32_bf16 v[24:27], v[12:15], v[152:155], v[24:27]
  v_mfma_f32_32x32x16_bf16 v[160:175], v[140:143], a[76:79], v[160:175]
  ds_read_b64_tr_b16 v[124:125], v8 offset:2048
  ds_read_b64_tr_b16 v[126:127], v8 offset:2560
  v_mfma_f32_32x32x16_bf16 v[176:191], v[140:143], a[204:207], v[176:191]
s_waitcnt lgkmcnt(9)
  v_mul_f32_e32 v76, v76, v92
  v_mul_f32_e32 v77, v77, v93
  v_mul_f32_e32 v78, v78, v94
  v_mfma_f32_16x16x32_bf16 v[24:27], v[12:15], v[156:159], v[24:27]
  v_mfma_f32_32x32x16_bf16 v[160:175], v[144:147], a[80:83], v[160:175]
  ds_read_b64_tr_b16 v[128:129], v8 offset:4096
  ds_read_b64_tr_b16 v[130:131], v8 offset:4608
  v_add_u32_e64 v56, s63, v9
  ds_read_b64_tr_b16 v[152:153], v56 offset:24576
  ds_read_b64_tr_b16 v[154:155], v56 offset:25088
  v_mfma_f32_32x32x16_bf16 v[176:191], v[144:147], a[208:211], v[176:191]
  ds_read_b64_tr_b16 v[156:157], v56 offset:28672
  ds_read_b64_tr_b16 v[158:159], v56 offset:29184
  v_mul_f32_e32 v79, v79, v95
s_waitcnt lgkmcnt(12)
  v_mul_f32_e32 v80, v80, v96
  v_mul_f32_e32 v81, v81, v97
  v_mfma_f32_32x32x16_bf16 v[160:175], v[148:151], a[84:87], v[160:175]
  ds_read_b64_tr_b16 v[132:133], v8 offset:6144
  ds_read_b64_tr_b16 v[134:135], v8 offset:6656
  v_mfma_f32_32x32x16_bf16 v[176:191], v[148:151], a[212:215], v[176:191]
  v_mul_f32_e32 v82, v82, v98
  v_mul_f32_e32 v83, v83, v99
  v_mfma_f32_32x32x16_bf16 v[160:175], v[112:115], a[88:91], v[160:175]
  ds_read_b64_tr_b16 v[136:137], v9 offset:16384
  ds_read_b64_tr_b16 v[138:139], v9 offset:16896
  v_mfma_f32_32x32x16_bf16 v[176:191], v[112:115], a[216:219], v[176:191]
s_waitcnt lgkmcnt(15)
  v_mul_f32_e32 v84, v84, v100
  v_mul_f32_e32 v85, v85, v101
s_waitcnt lgkmcnt(6)
  v_mfma_f32_16x16x32_bf16 v[24:27], v[12:15], v[152:155], v[24:27]
  v_mfma_f32_32x32x16_bf16 v[160:175], v[116:119], a[92:95], v[160:175]
  ds_read_b64_tr_b16 v[140:141], v9 offset:18432
  ds_read_b64_tr_b16 v[142:143], v9 offset:18944
  v_mfma_f32_32x32x16_bf16 v[176:191], v[116:119], a[220:223], v[176:191]
  v_mul_f32_e32 v86, v86, v102
  v_mul_f32_e32 v87, v87, v103
s_waitcnt lgkmcnt(6)
s_nop 0
  v_mfma_f32_16x16x32_bf16 v[24:27], v[12:15], v[156:159], v[24:27]
  v_mfma_f32_32x32x16_bf16 v[160:175], v[120:123], a[96:99], v[160:175]
  ds_read_b64_tr_b16 v[144:145], v9 offset:20480
  ds_read_b64_tr_b16 v[146:147], v9 offset:20992
  v_add_u32_e64 v56, s63, v8
  ds_read_b64_tr_b16 v[152:153], v56 offset:0
  v_mfma_f32_32x32x16_bf16 v[176:191], v[120:123], a[224:227], v[176:191]
  ds_read_b64_tr_b16 v[154:155], v56 offset:512
  ds_read_b64_tr_b16 v[156:157], v56 offset:4096
  ds_read_b64_tr_b16 v[158:159], v56 offset:4608
  v_mul_f32_e32 v88, v88, v104
  v_mul_f32_e32 v89, v89, v105
  v_mfma_f32_32x32x16_bf16 v[160:175], v[124:127], a[100:103], v[160:175]
  ds_read_b64_tr_b16 v[148:149], v9 offset:22528
  ds_read_b64_tr_b16 v[150:151], v9 offset:23040
  v_mfma_f32_32x32x16_bf16 v[176:191], v[124:127], a[228:231], v[176:191]
  v_mul_f32_e32 v90, v90, v106
  v_mul_f32_e32 v91, v91, v107
  v_mfma_f32_32x32x16_bf16 v[160:175], v[128:131], a[104:107], v[160:175]
  v_cvt_pk_bf16_f32 v76, v76, v77
  v_mfma_f32_32x32x16_bf16 v[176:191], v[128:131], a[232:235], v[176:191]
  v_cvt_pk_bf16_f32 v77, v78, v79
s_waitcnt lgkmcnt(4)
s_nop 0
  v_mfma_f32_16x16x32_bf16 v[24:27], v[12:15], v[152:155], v[24:27]
  v_mfma_f32_32x32x16_bf16 v[160:175], v[132:135], a[108:111], v[160:175]
  v_cvt_pk_bf16_f32 v78, v80, v81
  v_mfma_f32_32x32x16_bf16 v[176:191], v[132:135], a[236:239], v[176:191]
  v_cvt_pk_bf16_f32 v79, v82, v83
s_waitcnt lgkmcnt(2)
s_nop 0
  v_mfma_f32_16x16x32_bf16 v[24:27], v[12:15], v[156:159], v[24:27]
  v_mfma_f32_32x32x16_bf16 v[160:175], v[136:139], a[112:115], v[160:175]
  v_add_u32_e64 v56, s63, v9
  ds_read_b64_tr_b16 v[152:153], v56 offset:16384
  ds_read_b64_tr_b16 v[154:155], v56 offset:16896
  v_mfma_f32_32x32x16_bf16 v[176:191], v[136:139], a[240:243], v[176:191]
  ds_read_b64_tr_b16 v[156:157], v56 offset:20480
  ds_read_b64_tr_b16 v[158:159], v56 offset:20992
  buffer_store_dwordx4 v[76:79], v11, s[24:27], s51 offen offset:1024 sc1
  v_cvt_pk_bf16_f32 v84, v84, v85
  v_mfma_f32_32x32x16_bf16 v[160:175], v[140:143], a[116:119], v[160:175]
  v_cvt_pk_bf16_f32 v85, v86, v87
  v_mfma_f32_32x32x16_bf16 v[176:191], v[140:143], a[244:247], v[176:191]
  v_cvt_pk_bf16_f32 v86, v88, v89
  v_mfma_f32_32x32x16_bf16 v[160:175], v[144:147], a[120:123], v[160:175]
  v_cvt_pk_bf16_f32 v87, v90, v91
  v_mfma_f32_32x32x16_bf16 v[176:191], v[144:147], a[248:251], v[176:191]
  buffer_store_dwordx4 v[84:87], v11, s[24:27], s51 offen offset:1536 sc1
s_waitcnt lgkmcnt(2)
s_nop 0
  v_mfma_f32_16x16x32_bf16 v[24:27], v[12:15], v[152:155], v[24:27]
  v_mfma_f32_32x32x16_bf16 v[160:175], v[148:151], a[124:127], v[160:175]
  v_mfma_f32_32x32x16_bf16 v[176:191], v[148:151], a[252:255], v[176:191]
s_waitcnt lgkmcnt(0)
s_nop 0
  v_mfma_f32_16x16x32_bf16 v[24:27], v[12:15], v[156:159], v[24:27]
s_nop 7
s_nop 0
  ds_write_b32 v41, v24 offset:4096
s_waitcnt lgkmcnt(0)
  s_barrier
  ds_read_b64 v[48:49], v42 offset:4096
s_waitcnt lgkmcnt(0)
  v_add_f32_e32 v48, v48, v49
  v_cvt_pk_bf16_f32 v49, v48, v48
  v_and_b32_e32 v49, s46, v49
  v_sub_f32_e32 v49, v48, v49
  v_cvt_pk_bf16_f32 v36, v48, v49
s_nop 1
s_nop 0
  v_mfma_f32_32x32x16_bf16 v[160:175], v[36:39], v[28:31], v[160:175]
  v_mfma_f32_32x32x16_bf16 v[176:191], v[36:39], v[32:35], v[176:191]
s_nop 10
  v_mul_f32_e32 v160, v160, v20
  v_mul_f32_e32 v161, v161, v20
  v_mul_f32_e32 v162, v162, v20
  v_mul_f32_e32 v163, v163, v20
  v_mul_f32_e32 v164, v164, v20
  v_mul_f32_e32 v165, v165, v20
  v_mul_f32_e32 v166, v166, v20
  v_mul_f32_e32 v167, v167, v20
  v_mul_f32_e32 v168, v168, v20
  v_mul_f32_e32 v169, v169, v20
  v_mul_f32_e32 v170, v170, v20
  v_mul_f32_e32 v171, v171, v20
  v_mul_f32_e32 v172, v172, v20
  v_mul_f32_e32 v173, v173, v20
  v_mul_f32_e32 v174, v174, v20
  v_mul_f32_e64 v175, v175, v20
  v_cvt_pk_bf16_f32 v160, v160, v161
  v_cvt_pk_bf16_f32 v161, v162, v163
  v_cvt_pk_bf16_f32 v162, v164, v165
  v_cvt_pk_bf16_f32 v163, v166, v167
  buffer_store_dwordx4 v[160:163], v10, s[24:27], s52 offen offset:0 sc1
  v_cvt_pk_bf16_f32 v168, v168, v169
  v_cvt_pk_bf16_f32 v169, v170, v171
  v_cvt_pk_bf16_f32 v170, v172, v173
  v_cvt_pk_bf16_f32 v171, v174, v175
  buffer_store_dwordx4 v[168:171], v10, s[24:27], s53 offen offset:0 sc1
  v_mul_f32_e32 v176, v176, v21
  v_mul_f32_e32 v177, v177, v21
  v_mul_f32_e32 v178, v178, v21
  v_mul_f32_e32 v179, v179, v21
  v_mul_f32_e32 v180, v180, v21
  v_mul_f32_e32 v181, v181, v21
  v_mul_f32_e32 v182, v182, v21
  v_mul_f32_e32 v183, v183, v21
  v_mul_f32_e32 v184, v184, v21
  v_mul_f32_e32 v185, v185, v21
  v_mul_f32_e32 v186, v186, v21
  v_mul_f32_e32 v187, v187, v21
  v_mul_f32_e32 v188, v188, v21
  v_mul_f32_e32 v189, v189, v21
  v_mul_f32_e32 v190, v190, v21
  v_mul_f32_e32 v191, v191, v21
  v_cvt_pk_bf16_f32 v176, v176, v177
  v_cvt_pk_bf16_f32 v177, v178, v179
  v_cvt_pk_bf16_f32 v178, v180, v181
  v_cvt_pk_bf16_f32 v179, v182, v183
  buffer_store_dwordx4 v[176:179], v10, s[24:27], s52 offen offset:1024 sc1
  v_cvt_pk_bf16_f32 v184, v184, v185
  v_cvt_pk_bf16_f32 v185, v186, v187
  v_cvt_pk_bf16_f32 v186, v188, v189
  v_cvt_pk_bf16_f32 v187, v190, v191
  buffer_store_dwordx4 v[184:187], v10, s[24:27], s53 offen offset:1024 sc1
  s_endpgm
K1_END:
  s_endpgm
.globl k2_kernel
.p2align 8
.type k2_kernel,@function
k2_kernel:
  s_cmp_ge_u32 s2, 256
  s_cbranch_scc1 K2_END
s_nop 0
  s_load_dwordx2 s[64:65], s[0:1], 72
  s_load_dwordx2 s[66:67], s[0:1], 56
  s_load_dwordx2 s[68:69], s[0:1], 0
  v_lshrrev_b32_e32 v2, 6, v0
  v_and_b32_e32 v5, 63, v0
  v_readfirstlane_b32 s4, v2
  s_and_b32 s5, s2, 7
  s_lshl_b32 s5, s5, 2
  s_lshr_b32 s6, s2, 3
  s_and_b32 s7, s6, 3
  s_add_u32 s5, s5, s7
  s_lshr_b32 s6, s6, 2
  s_waitcnt lgkmcnt(0)
  s_mov_b32 s8, s64
s_nop 0
  s_and_b32 s9, s65, 0xffff
  s_mov_b32 s10, 29360128
  s_mov_b32 s11, 0x20000
  s_lshl_b32 s90, s5, 7
s_nop 0
  s_add_u32 s90, s90, 18874368
  s_add_u32 s88, s64, s90
  s_addc_u32 s89, s65, 0
  s_lshl_b32 s94, s2, 11
  s_lshl_b32 s95, s4, 8
  s_add_u32 s94, s94, s95
s_nop 0
  s_add_u32 s94, s94, 20447232
  s_cmp_lt_u32 s4, 4
  s_cbranch_scc1 K2_ATTN
  s_sub_u32 s4, s4, 4
s_nop 0
  v_and_b32_e32 v0, 255, v0
  s_mov_b32 s12, s66
s_nop 0
  s_and_b32 s13, s67, 0xffff
  s_mov_b32 s14, 2097152
  s_mov_b32 s15, 0x20000
  s_mov_b32 s16, s68
s_nop 0
  s_and_b32 s17, s69, 0xffff
  s_mov_b32 s18, 2097152
  s_mov_b32 s19, 0x20000
  v_lshlrev_b32_e64 v1, 4, v5
  v_add_u32_e32 v2, 147456, v1
  s_mul_i32 s20, s5, 288
  s_lshl_b32 s20, s20, 10
s_nop 0
  s_add_u32 s20, s20, 6291456
  s_mul_i32 s21, s6, 288
  s_lshl_b32 s21, s21, 10
s_nop 0
  s_add_u32 s21, s21, 15728640
  s_mul_i32 s22, s4, 28
  s_lshl_b32 s22, s22, 10
  s_lshl_b32 s23, s4, 3
s_nop 0
  s_add_u32 s23, s23, 112
  s_lshl_b32 s23, s23, 10
  s_add_u32 s24, s20, s22
  s_add_u32 s25, s21, s22
  s_add_u32 s26, s20, s23
  s_add_u32 s27, s21, s23
  s_mov_b32 s28, s27
  v_lshrrev_b32_e32 v6, 2, v0
  v_and_b32_e32 v7, 3, v0
  s_lshl_b32 s32, s5, 16
  s_lshl_b32 s33, s6, 7
  s_add_u32 s32, s32, s33
  v_lshlrev_b32_e32 v8, 10, v6
  v_lshl_add_u32 v8, v7, 5, v8
  buffer_load_dwordx4 v[16:19], v8, s[16:19], s32 offen
  buffer_load_dwordx4 v[20:23], v8, s[16:19], s32 offen offset:16
  s_barrier
s_nop 0
  buffer_load_dwordx4 v[64:67], v1, s[8:11], s25 offen offset:0
  buffer_load_dwordx4 v[68:71], v2, s[8:11], s25 offen offset:0
  buffer_load_dwordx4 v[72:75], v1, s[8:11], s24 offen offset:0
  buffer_load_dwordx4 v[76:79], v2, s[8:11], s24 offen offset:0
  buffer_load_dwordx4 v[80:83], v1, s[8:11], s25 offen offset:1024
  buffer_load_dwordx4 v[84:87], v2, s[8:11], s25 offen offset:1024
  buffer_load_dwordx4 v[88:91], v1, s[8:11], s24 offen offset:1024
  buffer_load_dwordx4 v[92:95], v2, s[8:11], s24 offen offset:1024
  buffer_load_dwordx4 v[96:99], v1, s[8:11], s25 offen offset:2048
  buffer_load_dwordx4 v[100:103], v2, s[8:11], s25 offen offset:2048
  buffer_load_dwordx4 v[104:107], v1, s[8:11], s24 offen offset:2048
  buffer_load_dwordx4 v[108:111], v2, s[8:11], s24 offen offset:2048
  buffer_load_dwordx4 v[112:115], v1, s[8:11], s25 offen offset:3072
  buffer_load_dwordx4 v[116:119], v2, s[8:11], s25 offen offset:3072
  buffer_load_dwordx4 v[120:123], v1, s[8:11], s24 offen offset:3072
  buffer_load_dwordx4 v[124:127], v2, s[8:11], s24 offen offset:3072
  s_add_u32 s25, s25, 4096
  buffer_load_dwordx4 v[128:131], v1, s[8:11], s25 offen offset:0
  buffer_load_dwordx4 v[132:135], v2, s[8:11], s25 offen offset:0
  s_add_u32 s24, s24, 4096
  buffer_load_dwordx4 v[136:139], v1, s[8:11], s24 offen offset:0
  buffer_load_dwordx4 v[140:143], v2, s[8:11], s24 offen offset:0
  buffer_load_dwordx4 v[144:147], v1, s[8:11], s25 offen offset:1024
  buffer_load_dwordx4 v[148:151], v2, s[8:11], s25 offen offset:1024
  buffer_load_dwordx4 v[152:155], v1, s[8:11], s24 offen offset:1024
  buffer_load_dwordx4 v[156:159], v2, s[8:11], s24 offen offset:1024
  buffer_load_dwordx4 v[160:163], v1, s[8:11], s25 offen offset:2048
  buffer_load_dwordx4 v[164:167], v2, s[8:11], s25 offen offset:2048
  buffer_load_dwordx4 v[168:171], v1, s[8:11], s24 offen offset:2048
  buffer_load_dwordx4 v[172:175], v2, s[8:11], s24 offen offset:2048
  buffer_load_dwordx4 v[176:179], v1, s[8:11], s25 offen offset:3072
  buffer_load_dwordx4 v[180:183], v2, s[8:11], s25 offen offset:3072
  buffer_load_dwordx4 v[184:187], v1, s[8:11], s24 offen offset:3072
  buffer_load_dwordx4 v[188:191], v2, s[8:11], s24 offen offset:3072
s_waitcnt vmcnt(29)
s_nop 0
  v_mfma_f32_32x32x16_bf16 v[192:207], v[64:67], v[72:75], 0
s_waitcnt vmcnt(28)
s_nop 0
  v_mfma_f32_32x32x16_bf16 v[208:223], v[64:67], v[76:79], 0
  v_mfma_f32_32x32x16_bf16 v[224:239], v[68:71], v[72:75], 0
  v_mfma_f32_32x32x16_bf16 v[240:255], v[68:71], v[76:79], 0
  s_add_u32 s25, s25, 4096
  buffer_load_dwordx4 v[64:67], v1, s[8:11], s25 offen offset:0
  buffer_load_dwordx4 v[68:71], v2, s[8:11], s25 offen offset:0
  s_add_u32 s24, s24, 4096
  buffer_load_dwordx4 v[72:75], v1, s[8:11], s24 offen offset:0
  buffer_load_dwordx4 v[76:79], v2, s[8:11], s24 offen offset:0
s_waitcnt vmcnt(29)
s_nop 0
  v_mfma_f32_32x32x16_bf16 v[192:207], v[80:83], v[88:91], v[192:207]
s_waitcnt vmcnt(28)
s_nop 0
  v_mfma_f32_32x32x16_bf16 v[208:223], v[80:83], v[92:95], v[208:223]
  v_mfma_f32_32x32x16_bf16 v[224:239], v[84:87], v[88:91], v[224:239]
  v_mfma_f32_32x32x16_bf16 v[240:255], v[84:87], v[92:95], v[240:255]
  buffer_load_dwordx4 v[80:83], v1, s[8:11], s25 offen offset:1024
  buffer_load_dwordx4 v[84:87], v2, s[8:11], s25 offen offset:1024
  buffer_load_dwordx4 v[88:91], v1, s[8:11], s24 offen offset:1024
  buffer_load_dwordx4 v[92:95], v2, s[8:11], s24 offen offset:1024
s_waitcnt vmcnt(29)
s_nop 0
  v_mfma_f32_32x32x16_bf16 v[192:207], v[96:99], v[104:107], v[192:207]
s_waitcnt vmcnt(28)
s_nop 0
  v_mfma_f32_32x32x16_bf16 v[208:223], v[96:99], v[108:111], v[208:223]
  v_mfma_f32_32x32x16_bf16 v[224:239], v[100:103], v[104:107], v[224:239]
  v_mfma_f32_32x32x16_bf16 v[240:255], v[100:103], v[108:111], v[240:255]
  buffer_load_dwordx4 v[96:99], v1, s[8:11], s25 offen offset:2048
  buffer_load_dwordx4 v[100:103], v2, s[8:11], s25 offen offset:2048
  buffer_load_dwordx4 v[104:107], v1, s[8:11], s24 offen offset:2048
  buffer_load_dwordx4 v[108:111], v2, s[8:11], s24 offen offset:2048
s_waitcnt vmcnt(29)
s_nop 0
  v_mfma_f32_32x32x16_bf16 v[192:207], v[112:115], v[120:123], v[192:207]
s_waitcnt vmcnt(28)
s_nop 0
  v_mfma_f32_32x32x16_bf16 v[208:223], v[112:115], v[124:127], v[208:223]
  v_mfma_f32_32x32x16_bf16 v[224:239], v[116:119], v[120:123], v[224:239]
  v_mfma_f32_32x32x16_bf16 v[240:255], v[116:119], v[124:127], v[240:255]
  buffer_load_dwordx4 v[112:115], v1, s[8:11], s25 offen offset:3072
  buffer_load_dwordx4 v[116:119], v2, s[8:11], s25 offen offset:3072
  buffer_load_dwordx4 v[120:123], v1, s[8:11], s24 offen offset:3072
  buffer_load_dwordx4 v[124:127], v2, s[8:11], s24 offen offset:3072
s_waitcnt vmcnt(29)
s_nop 0
  v_mfma_f32_32x32x16_bf16 v[192:207], v[128:131], v[136:139], v[192:207]
s_waitcnt vmcnt(28)
s_nop 0
  v_mfma_f32_32x32x16_bf16 v[208:223], v[128:131], v[140:143], v[208:223]
  v_mfma_f32_32x32x16_bf16 v[224:239], v[132:135], v[136:139], v[224:239]
  v_mfma_f32_32x32x16_bf16 v[240:255], v[132:135], v[140:143], v[240:255]
  s_add_u32 s25, s25, 4096
  buffer_load_dwordx4 v[128:131], v1, s[8:11], s25 offen offset:0
  buffer_load_dwordx4 v[132:135], v2, s[8:11], s25 offen offset:0
  s_add_u32 s24, s24, 4096
  buffer_load_dwordx4 v[136:139], v1, s[8:11], s24 offen offset:0
  buffer_load_dwordx4 v[140:143], v2, s[8:11], s24 offen offset:0
s_waitcnt vmcnt(29)
s_nop 0
  v_mfma_f32_32x32x16_bf16 v[192:207], v[144:147], v[152:155], v[192:207]
s_waitcnt vmcnt(28)
s_nop 0
  v_mfma_f32_32x32x16_bf16 v[208:223], v[144:147], v[156:159], v[208:223]
  v_mfma_f32_32x32x16_bf16 v[224:239], v[148:151], v[152:155], v[224:239]
  v_mfma_f32_32x32x16_bf16 v[240:255], v[148:151], v[156:159], v[240:255]
  buffer_load_dwordx4 v[144:147], v1, s[8:11], s25 offen offset:1024
  buffer_load_dwordx4 v[148:151], v2, s[8:11], s25 offen offset:1024
  buffer_load_dwordx4 v[152:155], v1, s[8:11], s24 offen offset:1024
  buffer_load_dwordx4 v[156:159], v2, s[8:11], s24 offen offset:1024
s_waitcnt vmcnt(29)
s_nop 0
  v_mfma_f32_32x32x16_bf16 v[192:207], v[160:163], v[168:171], v[192:207]
s_waitcnt vmcnt(28)
s_nop 0
  v_mfma_f32_32x32x16_bf16 v[208:223], v[160:163], v[172:175], v[208:223]
  v_mfma_f32_32x32x16_bf16 v[224:239], v[164:167], v[168:171], v[224:239]
  v_mfma_f32_32x32x16_bf16 v[240:255], v[164:167], v[172:175], v[240:255]
  buffer_load_dwordx4 v[160:163], v1, s[8:11], s25 offen offset:2048
  buffer_load_dwordx4 v[164:167], v2, s[8:11], s25 offen offset:2048
  buffer_load_dwordx4 v[168:171], v1, s[8:11], s24 offen offset:2048
  buffer_load_dwordx4 v[172:175], v2, s[8:11], s24 offen offset:2048
s_waitcnt vmcnt(29)
s_nop 0
  v_mfma_f32_32x32x16_bf16 v[192:207], v[176:179], v[184:187], v[192:207]
s_waitcnt vmcnt(28)
s_nop 0
  v_mfma_f32_32x32x16_bf16 v[208:223], v[176:179], v[188:191], v[208:223]
  v_mfma_f32_32x32x16_bf16 v[224:239], v[180:183], v[184:187], v[224:239]
  v_mfma_f32_32x32x16_bf16 v[240:255], v[180:183], v[188:191], v[240:255]
  buffer_load_dwordx4 v[176:179], v1, s[8:11], s25 offen offset:3072
  buffer_load_dwordx4 v[180:183], v2, s[8:11], s25 offen offset:3072
  buffer_load_dwordx4 v[184:187], v1, s[8:11], s24 offen offset:3072
  buffer_load_dwordx4 v[188:191], v2, s[8:11], s24 offen offset:3072
s_waitcnt vmcnt(29)
s_nop 0
  v_mfma_f32_32x32x16_bf16 v[192:207], v[64:67], v[72:75], v[192:207]
s_waitcnt vmcnt(28)
s_nop 0
  v_mfma_f32_32x32x16_bf16 v[208:223], v[64:67], v[76:79], v[208:223]
  v_mfma_f32_32x32x16_bf16 v[224:239], v[68:71], v[72:75], v[224:239]
  v_mfma_f32_32x32x16_bf16 v[240:255], v[68:71], v[76:79], v[240:255]
  s_add_u32 s25, s25, 4096
  buffer_load_dwordx4 v[64:67], v1, s[8:11], s25 offen offset:0
  buffer_load_dwordx4 v[68:71], v2, s[8:11], s25 offen offset:0
  s_add_u32 s24, s24, 4096
  buffer_load_dwordx4 v[72:75], v1, s[8:11], s24 offen offset:0
  buffer_load_dwordx4 v[76:79], v2, s[8:11], s24 offen offset:0
s_waitcnt vmcnt(29)
s_nop 0
  v_mfma_f32_32x32x16_bf16 v[192:207], v[80:83], v[88:91], v[192:207]
s_waitcnt vmcnt(28)
s_nop 0
  v_mfma_f32_32x32x16_bf16 v[208:223], v[80:83], v[92:95], v[208:223]
  v_mfma_f32_32x32x16_bf16 v[224:239], v[84:87], v[88:91], v[224:239]
  v_mfma_f32_32x32x16_bf16 v[240:255], v[84:87], v[92:95], v[240:255]
  buffer_load_dwordx4 v[80:83], v1, s[8:11], s25 offen offset:1024
  buffer_load_dwordx4 v[84:87], v2, s[8:11], s25 offen offset:1024
  buffer_load_dwordx4 v[88:91], v1, s[8:11], s24 offen offset:1024
  buffer_load_dwordx4 v[92:95], v2, s[8:11], s24 offen offset:1024
s_waitcnt vmcnt(29)
s_nop 0
  v_mfma_f32_32x32x16_bf16 v[192:207], v[96:99], v[104:107], v[192:207]
s_waitcnt vmcnt(28)
s_nop 0
  v_mfma_f32_32x32x16_bf16 v[208:223], v[96:99], v[108:111], v[208:223]
  v_mfma_f32_32x32x16_bf16 v[224:239], v[100:103], v[104:107], v[224:239]
  v_mfma_f32_32x32x16_bf16 v[240:255], v[100:103], v[108:111], v[240:255]
  buffer_load_dwordx4 v[96:99], v1, s[8:11], s25 offen offset:2048
  buffer_load_dwordx4 v[100:103], v2, s[8:11], s25 offen offset:2048
  buffer_load_dwordx4 v[104:107], v1, s[8:11], s24 offen offset:2048
  buffer_load_dwordx4 v[108:111], v2, s[8:11], s24 offen offset:2048
s_waitcnt vmcnt(29)
s_nop 0
  v_mfma_f32_32x32x16_bf16 v[192:207], v[112:115], v[120:123], v[192:207]
s_waitcnt vmcnt(28)
s_nop 0
  v_mfma_f32_32x32x16_bf16 v[208:223], v[112:115], v[124:127], v[208:223]
  v_mfma_f32_32x32x16_bf16 v[224:239], v[116:119], v[120:123], v[224:239]
  v_mfma_f32_32x32x16_bf16 v[240:255], v[116:119], v[124:127], v[240:255]
  buffer_load_dwordx4 v[112:115], v1, s[8:11], s25 offen offset:3072
  buffer_load_dwordx4 v[116:119], v2, s[8:11], s25 offen offset:3072
  buffer_load_dwordx4 v[120:123], v1, s[8:11], s24 offen offset:3072
  buffer_load_dwordx4 v[124:127], v2, s[8:11], s24 offen offset:3072
s_waitcnt vmcnt(29)
s_nop 0
  v_mfma_f32_32x32x16_bf16 v[192:207], v[128:131], v[136:139], v[192:207]
s_waitcnt vmcnt(28)
s_nop 0
  v_mfma_f32_32x32x16_bf16 v[208:223], v[128:131], v[140:143], v[208:223]
  v_mfma_f32_32x32x16_bf16 v[224:239], v[132:135], v[136:139], v[224:239]
  v_mfma_f32_32x32x16_bf16 v[240:255], v[132:135], v[140:143], v[240:255]
  s_add_u32 s25, s25, 4096
  buffer_load_dwordx4 v[128:131], v1, s[8:11], s25 offen offset:0
  buffer_load_dwordx4 v[132:135], v2, s[8:11], s25 offen offset:0
  s_add_u32 s24, s24, 4096
  buffer_load_dwordx4 v[136:139], v1, s[8:11], s24 offen offset:0
  buffer_load_dwordx4 v[140:143], v2, s[8:11], s24 offen offset:0
s_waitcnt vmcnt(29)
s_nop 0
  v_mfma_f32_32x32x16_bf16 v[192:207], v[144:147], v[152:155], v[192:207]
s_waitcnt vmcnt(28)
s_nop 0
  v_mfma_f32_32x32x16_bf16 v[208:223], v[144:147], v[156:159], v[208:223]
  v_mfma_f32_32x32x16_bf16 v[224:239], v[148:151], v[152:155], v[224:239]
  v_mfma_f32_32x32x16_bf16 v[240:255], v[148:151], v[156:159], v[240:255]
  buffer_load_dwordx4 v[144:147], v1, s[8:11], s25 offen offset:1024
  buffer_load_dwordx4 v[148:151], v2, s[8:11], s25 offen offset:1024
  buffer_load_dwordx4 v[152:155], v1, s[8:11], s24 offen offset:1024
  buffer_load_dwordx4 v[156:159], v2, s[8:11], s24 offen offset:1024
s_waitcnt vmcnt(29)
s_nop 0
  v_mfma_f32_32x32x16_bf16 v[192:207], v[160:163], v[168:171], v[192:207]
s_waitcnt vmcnt(28)
s_nop 0
  v_mfma_f32_32x32x16_bf16 v[208:223], v[160:163], v[172:175], v[208:223]
  v_mfma_f32_32x32x16_bf16 v[224:239], v[164:167], v[168:171], v[224:239]
  v_mfma_f32_32x32x16_bf16 v[240:255], v[164:167], v[172:175], v[240:255]
  buffer_load_dwordx4 v[160:163], v1, s[8:11], s25 offen offset:2048
  buffer_load_dwordx4 v[164:167], v2, s[8:11], s25 offen offset:2048
  buffer_load_dwordx4 v[168:171], v1, s[8:11], s24 offen offset:2048
  buffer_load_dwordx4 v[172:175], v2, s[8:11], s24 offen offset:2048
s_waitcnt vmcnt(29)
s_nop 0
  v_mfma_f32_32x32x16_bf16 v[192:207], v[176:179], v[184:187], v[192:207]
s_waitcnt vmcnt(28)
s_nop 0
  v_mfma_f32_32x32x16_bf16 v[208:223], v[176:179], v[188:191], v[208:223]
  v_mfma_f32_32x32x16_bf16 v[224:239], v[180:183], v[184:187], v[224:239]
  v_mfma_f32_32x32x16_bf16 v[240:255], v[180:183], v[188:191], v[240:255]
  buffer_load_dwordx4 v[176:179], v1, s[8:11], s25 offen offset:3072
  buffer_load_dwordx4 v[180:183], v2, s[8:11], s25 offen offset:3072
  buffer_load_dwordx4 v[184:187], v1, s[8:11], s24 offen offset:3072
  buffer_load_dwordx4 v[188:191], v2, s[8:11], s24 offen offset:3072
s_waitcnt vmcnt(29)
s_nop 0
  v_mfma_f32_32x32x16_bf16 v[192:207], v[64:67], v[72:75], v[192:207]
s_waitcnt vmcnt(28)
s_nop 0
  v_mfma_f32_32x32x16_bf16 v[208:223], v[64:67], v[76:79], v[208:223]
  v_mfma_f32_32x32x16_bf16 v[224:239], v[68:71], v[72:75], v[224:239]
  v_mfma_f32_32x32x16_bf16 v[240:255], v[68:71], v[76:79], v[240:255]
  s_add_u32 s25, s25, 4096
  buffer_load_dwordx4 v[64:67], v1, s[8:11], s25 offen offset:0
  buffer_load_dwordx4 v[68:71], v2, s[8:11], s25 offen offset:0
  s_add_u32 s24, s24, 4096
  buffer_load_dwordx4 v[72:75], v1, s[8:11], s24 offen offset:0
  buffer_load_dwordx4 v[76:79], v2, s[8:11], s24 offen offset:0
s_waitcnt vmcnt(29)
s_nop 0
  v_mfma_f32_32x32x16_bf16 v[192:207], v[80:83], v[88:91], v[192:207]
s_waitcnt vmcnt(28)
s_nop 0
  v_mfma_f32_32x32x16_bf16 v[208:223], v[80:83], v[92:95], v[208:223]
  v_mfma_f32_32x32x16_bf16 v[224:239], v[84:87], v[88:91], v[224:239]
  v_mfma_f32_32x32x16_bf16 v[240:255], v[84:87], v[92:95], v[240:255]
  buffer_load_dwordx4 v[80:83], v1, s[8:11], s25 offen offset:1024
  buffer_load_dwordx4 v[84:87], v2, s[8:11], s25 offen offset:1024
  buffer_load_dwordx4 v[88:91], v1, s[8:11], s24 offen offset:1024
  buffer_load_dwordx4 v[92:95], v2, s[8:11], s24 offen offset:1024
s_waitcnt vmcnt(29)
s_nop 0
  v_mfma_f32_32x32x16_bf16 v[192:207], v[96:99], v[104:107], v[192:207]
s_waitcnt vmcnt(28)
s_nop 0
  v_mfma_f32_32x32x16_bf16 v[208:223], v[96:99], v[108:111], v[208:223]
  v_mfma_f32_32x32x16_bf16 v[224:239], v[100:103], v[104:107], v[224:239]
  v_mfma_f32_32x32x16_bf16 v[240:255], v[100:103], v[108:111], v[240:255]
  buffer_load_dwordx4 v[96:99], v1, s[8:11], s25 offen offset:2048
  buffer_load_dwordx4 v[100:103], v2, s[8:11], s25 offen offset:2048
  buffer_load_dwordx4 v[104:107], v1, s[8:11], s24 offen offset:2048
  buffer_load_dwordx4 v[108:111], v2, s[8:11], s24 offen offset:2048
s_waitcnt vmcnt(29)
s_nop 0
  v_mfma_f32_32x32x16_bf16 v[192:207], v[112:115], v[120:123], v[192:207]
s_waitcnt vmcnt(28)
s_nop 0
  v_mfma_f32_32x32x16_bf16 v[208:223], v[112:115], v[124:127], v[208:223]
  v_mfma_f32_32x32x16_bf16 v[224:239], v[116:119], v[120:123], v[224:239]
  v_mfma_f32_32x32x16_bf16 v[240:255], v[116:119], v[124:127], v[240:255]
  buffer_load_dwordx4 v[112:115], v1, s[8:11], s25 offen offset:3072
  buffer_load_dwordx4 v[116:119], v2, s[8:11], s25 offen offset:3072
  buffer_load_dwordx4 v[120:123], v1, s[8:11], s24 offen offset:3072
  buffer_load_dwordx4 v[124:127], v2, s[8:11], s24 offen offset:3072
s_waitcnt vmcnt(29)
s_nop 0
  v_mfma_f32_32x32x16_bf16 v[192:207], v[128:131], v[136:139], v[192:207]
s_waitcnt vmcnt(28)
s_nop 0
  v_mfma_f32_32x32x16_bf16 v[208:223], v[128:131], v[140:143], v[208:223]
  v_mfma_f32_32x32x16_bf16 v[224:239], v[132:135], v[136:139], v[224:239]
  v_mfma_f32_32x32x16_bf16 v[240:255], v[132:135], v[140:143], v[240:255]
  buffer_load_dwordx4 v[128:131], v1, s[8:11], s27 offen offset:0
  buffer_load_dwordx4 v[132:135], v2, s[8:11], s27 offen offset:0
s_waitcnt vmcnt(27)
s_nop 0
  v_mfma_f32_32x32x16_bf16 v[192:207], v[144:147], v[152:155], v[192:207]
s_waitcnt vmcnt(26)
s_nop 0
  v_mfma_f32_32x32x16_bf16 v[208:223], v[144:147], v[156:159], v[208:223]
  v_mfma_f32_32x32x16_bf16 v[224:239], v[148:151], v[152:155], v[224:239]
  v_mfma_f32_32x32x16_bf16 v[240:255], v[148:151], v[156:159], v[240:255]
  buffer_load_dwordx4 v[144:147], v1, s[8:11], s27 offen offset:1024
  buffer_load_dwordx4 v[148:151], v2, s[8:11], s27 offen offset:1024
s_waitcnt vmcnt(25)
s_nop 0
  v_mfma_f32_32x32x16_bf16 v[192:207], v[160:163], v[168:171], v[192:207]
s_waitcnt vmcnt(24)
s_nop 0
  v_mfma_f32_32x32x16_bf16 v[208:223], v[160:163], v[172:175], v[208:223]
  v_mfma_f32_32x32x16_bf16 v[224:239], v[164:167], v[168:171], v[224:239]
  v_mfma_f32_32x32x16_bf16 v[240:255], v[164:167], v[172:175], v[240:255]
  buffer_load_dwordx4 v[160:163], v1, s[8:11], s27 offen offset:2048
  buffer_load_dwordx4 v[164:167], v2, s[8:11], s27 offen offset:2048
s_waitcnt vmcnt(23)
s_nop 0
  v_mfma_f32_32x32x16_bf16 v[192:207], v[176:179], v[184:187], v[192:207]
s_waitcnt vmcnt(22)
s_nop 0
  v_mfma_f32_32x32x16_bf16 v[208:223], v[176:179], v[188:191], v[208:223]
  v_mfma_f32_32x32x16_bf16 v[224:239], v[180:183], v[184:187], v[224:239]
  v_mfma_f32_32x32x16_bf16 v[240:255], v[180:183], v[188:191], v[240:255]
  buffer_load_dwordx4 v[176:179], v1, s[8:11], s27 offen offset:3072
  buffer_load_dwordx4 v[180:183], v2, s[8:11], s27 offen offset:3072
s_waitcnt vmcnt(21)
s_nop 0
  v_mfma_f32_32x32x16_bf16 v[192:207], v[64:67], v[72:75], v[192:207]
s_waitcnt vmcnt(20)
s_nop 0
  v_mfma_f32_32x32x16_bf16 v[208:223], v[64:67], v[76:79], v[208:223]
  v_mfma_f32_32x32x16_bf16 v[224:239], v[68:71], v[72:75], v[224:239]
  v_mfma_f32_32x32x16_bf16 v[240:255], v[68:71], v[76:79], v[240:255]
  s_add_u32 s27, s27, 4096
  buffer_load_dwordx4 v[64:67], v1, s[8:11], s27 offen offset:0
  buffer_load_dwordx4 v[68:71], v2, s[8:11], s27 offen offset:0
s_waitcnt vmcnt(19)
s_nop 0
  v_mfma_f32_32x32x16_bf16 v[192:207], v[80:83], v[88:91], v[192:207]
s_waitcnt vmcnt(18)
s_nop 0
  v_mfma_f32_32x32x16_bf16 v[208:223], v[80:83], v[92:95], v[208:223]
  v_mfma_f32_32x32x16_bf16 v[224:239], v[84:87], v[88:91], v[224:239]
  v_mfma_f32_32x32x16_bf16 v[240:255], v[84:87], v[92:95], v[240:255]
  buffer_load_dwordx4 v[80:83], v1, s[8:11], s27 offen offset:1024
  buffer_load_dwordx4 v[84:87], v2, s[8:11], s27 offen offset:1024
s_waitcnt vmcnt(17)
s_nop 0
  v_mfma_f32_32x32x16_bf16 v[192:207], v[96:99], v[104:107], v[192:207]
s_waitcnt vmcnt(16)
s_nop 0
  v_mfma_f32_32x32x16_bf16 v[208:223], v[96:99], v[108:111], v[208:223]
  v_mfma_f32_32x32x16_bf16 v[224:239], v[100:103], v[104:107], v[224:239]
  v_mfma_f32_32x32x16_bf16 v[240:255], v[100:103], v[108:111], v[240:255]
  buffer_load_dwordx4 v[96:99], v1, s[8:11], s27 offen offset:2048
  buffer_load_dwordx4 v[100:103], v2, s[8:11], s27 offen offset:2048
s_waitcnt vmcnt(15)
s_nop 0
  v_mfma_f32_32x32x16_bf16 v[192:207], v[112:115], v[120:123], v[192:207]
s_waitcnt vmcnt(14)
s_nop 0
  v_mfma_f32_32x32x16_bf16 v[208:223], v[112:115], v[124:127], v[208:223]
  v_mfma_f32_32x32x16_bf16 v[224:239], v[116:119], v[120:123], v[224:239]
  v_mfma_f32_32x32x16_bf16 v[240:255], v[116:119], v[124:127], v[240:255]
  buffer_load_dwordx4 v[112:115], v1, s[8:11], s27 offen offset:3072
  buffer_load_dwordx4 v[116:119], v2, s[8:11], s27 offen offset:3072
  v_mov_b32_e32 v9, 0
  s_mov_b32 s34, 0
K2_POLL:
  global_load_dword v10, v9, s[88:89] sc1
  s_waitcnt vmcnt(0)
  v_readfirstlane_b32 s35, v10
  s_add_u32 s34, s34, 1
  s_cmp_ge_u32 s35, 32
  s_cbranch_scc1 K2_GO
  s_sleep 2
  s_cmp_lt_u32 s34, 0x10000
  s_cbranch_scc1 K2_POLL
s_nop 0
K2_GO:
  buffer_load_dwordx4 v[136:139], v1, s[8:11], s26 offen offset:0 sc1
  buffer_load_dwordx4 v[140:143], v2, s[8:11], s26 offen offset:0 sc1
  buffer_load_dwordx4 v[152:155], v1, s[8:11], s26 offen offset:1024 sc1
  buffer_load_dwordx4 v[156:159], v2, s[8:11], s26 offen offset:1024 sc1
  buffer_load_dwordx4 v[168:171], v1, s[8:11], s26 offen offset:2048 sc1
  buffer_load_dwordx4 v[172:175], v2, s[8:11], s26 offen offset:2048 sc1
  buffer_load_dwordx4 v[184:187], v1, s[8:11], s26 offen offset:3072 sc1
  buffer_load_dwordx4 v[188:191], v2, s[8:11], s26 offen offset:3072 sc1
  s_add_u32 s26, s26, 4096
  buffer_load_dwordx4 v[72:75], v1, s[8:11], s26 offen offset:0 sc1
  buffer_load_dwordx4 v[76:79], v2, s[8:11], s26 offen offset:0 sc1
  buffer_load_dwordx4 v[88:91], v1, s[8:11], s26 offen offset:1024 sc1
  buffer_load_dwordx4 v[92:95], v2, s[8:11], s26 offen offset:1024 sc1
  buffer_load_dwordx4 v[104:107], v1, s[8:11], s26 offen offset:2048 sc1
  buffer_load_dwordx4 v[108:111], v2, s[8:11], s26 offen offset:2048 sc1
  buffer_load_dwordx4 v[120:123], v1, s[8:11], s26 offen offset:3072 sc1
  buffer_load_dwordx4 v[124:127], v2, s[8:11], s26 offen offset:3072 sc1
s_waitcnt vmcnt(15)
s_nop 0
  v_mfma_f32_32x32x16_bf16 v[192:207], v[128:131], v[136:139], v[192:207]
s_waitcnt vmcnt(14)
s_nop 0
  v_mfma_f32_32x32x16_bf16 v[208:223], v[128:131], v[140:143], v[208:223]
  v_mfma_f32_32x32x16_bf16 v[224:239], v[132:135], v[136:139], v[224:239]
  v_mfma_f32_32x32x16_bf16 v[240:255], v[132:135], v[140:143], v[240:255]
s_waitcnt vmcnt(13)
s_nop 0
  v_mfma_f32_32x32x16_bf16 v[192:207], v[144:147], v[152:155], v[192:207]
s_waitcnt vmcnt(12)
s_nop 0
  v_mfma_f32_32x32x16_bf16 v[208:223], v[144:147], v[156:159], v[208:223]
  v_mfma_f32_32x32x16_bf16 v[224:239], v[148:151], v[152:155], v[224:239]
  v_mfma_f32_32x32x16_bf16 v[240:255], v[148:151], v[156:159], v[240:255]
s_waitcnt vmcnt(11)
s_nop 0
  v_mfma_f32_32x32x16_bf16 v[192:207], v[160:163], v[168:171], v[192:207]
s_waitcnt vmcnt(10)
s_nop 0
  v_mfma_f32_32x32x16_bf16 v[208:223], v[160:163], v[172:175], v[208:223]
  v_mfma_f32_32x32x16_bf16 v[224:239], v[164:167], v[168:171], v[224:239]
  v_mfma_f32_32x32x16_bf16 v[240:255], v[164:167], v[172:175], v[240:255]
s_waitcnt vmcnt(9)
s_nop 0
  v_mfma_f32_32x32x16_bf16 v[192:207], v[176:179], v[184:187], v[192:207]
s_waitcnt vmcnt(8)
s_nop 0
  v_mfma_f32_32x32x16_bf16 v[208:223], v[176:179], v[188:191], v[208:223]
  v_mfma_f32_32x32x16_bf16 v[224:239], v[180:183], v[184:187], v[224:239]
  v_mfma_f32_32x32x16_bf16 v[240:255], v[180:183], v[188:191], v[240:255]
s_waitcnt vmcnt(7)
s_nop 0
  v_mfma_f32_32x32x16_bf16 v[192:207], v[64:67], v[72:75], v[192:207]
s_waitcnt vmcnt(6)
s_nop 0
  v_mfma_f32_32x32x16_bf16 v[208:223], v[64:67], v[76:79], v[208:223]
  v_mfma_f32_32x32x16_bf16 v[224:239], v[68:71], v[72:75], v[224:239]
  v_mfma_f32_32x32x16_bf16 v[240:255], v[68:71], v[76:79], v[240:255]
s_waitcnt vmcnt(5)
s_nop 0
  v_mfma_f32_32x32x16_bf16 v[192:207], v[80:83], v[88:91], v[192:207]
s_waitcnt vmcnt(4)
s_nop 0
  v_mfma_f32_32x32x16_bf16 v[208:223], v[80:83], v[92:95], v[208:223]
  v_mfma_f32_32x32x16_bf16 v[224:239], v[84:87], v[88:91], v[224:239]
  v_mfma_f32_32x32x16_bf16 v[240:255], v[84:87], v[92:95], v[240:255]
s_waitcnt vmcnt(3)
s_nop 0
  v_mfma_f32_32x32x16_bf16 v[192:207], v[96:99], v[104:107], v[192:207]
s_waitcnt vmcnt(2)
s_nop 0
  v_mfma_f32_32x32x16_bf16 v[208:223], v[96:99], v[108:111], v[208:223]
  v_mfma_f32_32x32x16_bf16 v[224:239], v[100:103], v[104:107], v[224:239]
  v_mfma_f32_32x32x16_bf16 v[240:255], v[100:103], v[108:111], v[240:255]
s_waitcnt vmcnt(1)
s_nop 0
  v_mfma_f32_32x32x16_bf16 v[192:207], v[112:115], v[120:123], v[192:207]
s_waitcnt vmcnt(0)
s_nop 0
  v_mfma_f32_32x32x16_bf16 v[208:223], v[112:115], v[124:127], v[208:223]
  v_mfma_f32_32x32x16_bf16 v[224:239], v[116:119], v[120:123], v[224:239]
  v_mfma_f32_32x32x16_bf16 v[240:255], v[116:119], v[124:127], v[240:255]
  v_and_b32_e32 v3, 31, v5
  v_lshrrev_b32_e32 v4, 5, v5
  s_mov_b32 s30, 272
  v_mul_lo_u32 v3, v3, s30
  v_lshl_add_u32 v3, v4, 4, v3
  s_mul_i32 s31, s4, 17408
  v_add_u32_e64 v3, s31, v3
  ds_write_b128 v3, v[192:195] offset:0
  ds_write_b128 v3, v[196:199] offset:32
  ds_write_b128 v3, v[200:203] offset:64
  ds_write_b128 v3, v[204:207] offset:96
  ds_write_b128 v3, v[208:211] offset:8704
  ds_write_b128 v3, v[212:215] offset:8736
  ds_write_b128 v3, v[216:219] offset:8768
  ds_write_b128 v3, v[220:223] offset:8800
  ds_write_b128 v3, v[224:227] offset:128
  ds_write_b128 v3, v[228:231] offset:160
  ds_write_b128 v3, v[232:235] offset:192
  ds_write_b128 v3, v[236:239] offset:224
  ds_write_b128 v3, v[240:243] offset:8832
  ds_write_b128 v3, v[244:247] offset:8864
  ds_write_b128 v3, v[248:251] offset:8896
  ds_write_b128 v3, v[252:255] offset:8928
  v_mul_lo_u32 v9, v6, s30
  v_lshl_add_u32 v9, v7, 6, v9
  v_lshlrev_b32_e64 v32, 16, v16
  v_and_b32_e32 v33, 0xffff0000, v16
  v_lshlrev_b32_e64 v34, 16, v17
  v_and_b32_e32 v35, 0xffff0000, v17
  v_lshlrev_b32_e64 v36, 16, v18
  v_and_b32_e32 v37, 0xffff0000, v18
  v_lshlrev_b32_e64 v38, 16, v19
  v_and_b32_e32 v39, 0xffff0000, v19
  v_lshlrev_b32_e64 v40, 16, v20
  v_and_b32_e32 v41, 0xffff0000, v20
  v_lshlrev_b32_e64 v42, 16, v21
  v_and_b32_e32 v43, 0xffff0000, v21
  v_lshlrev_b32_e64 v44, 16, v22
  v_and_b32_e32 v45, 0xffff0000, v22
  v_lshlrev_b32_e64 v46, 16, v23
  v_and_b32_e32 v47, 0xffff0000, v23
s_waitcnt lgkmcnt(0)
  s_barrier
  ds_read_b128 v[64:67], v9 offset:0
  ds_read_b128 v[68:71], v9 offset:16
  ds_read_b128 v[72:75], v9 offset:32
  ds_read_b128 v[76:79], v9 offset:48
  ds_read_b128 v[80:83], v9 offset:17408
  ds_read_b128 v[84:87], v9 offset:17424
  ds_read_b128 v[88:91], v9 offset:17440
  ds_read_b128 v[92:95], v9 offset:17456
  ds_read_b128 v[96:99], v9 offset:34816
  ds_read_b128 v[100:103], v9 offset:34832
  ds_read_b128 v[104:107], v9 offset:34848
  ds_read_b128 v[108:111], v9 offset:34864
  ds_read_b128 v[112:115], v9 offset:52224
  ds_read_b128 v[116:119], v9 offset:52240
  ds_read_b128 v[120:123], v9 offset:52256
  ds_read_b128 v[124:127], v9 offset:52272
s_waitcnt lgkmcnt(11)
  v_add_f32_e32 v64, v64, v80
s_waitcnt lgkmcnt(3)
  v_add_f32_e32 v96, v96, v112
  v_add_f32_e32 v65, v65, v81
  v_add_f32_e32 v97, v97, v113
  v_add_f32_e32 v66, v66, v82
  v_add_f32_e32 v98, v98, v114
  v_add_f32_e32 v67, v67, v83
  v_add_f32_e32 v99, v99, v115
  v_add_f32_e32 v68, v68, v84
s_waitcnt lgkmcnt(2)
  v_add_f32_e32 v100, v100, v116
  v_add_f32_e32 v69, v69, v85
  v_add_f32_e32 v101, v101, v117
  v_add_f32_e32 v70, v70, v86
  v_add_f32_e32 v102, v102, v118
  v_add_f32_e32 v71, v71, v87
  v_add_f32_e32 v103, v103, v119
  v_add_f32_e32 v72, v72, v88
s_waitcnt lgkmcnt(1)
  v_add_f32_e32 v104, v104, v120
  v_add_f32_e32 v73, v73, v89
  v_add_f32_e32 v105, v105, v121
  v_add_f32_e32 v74, v74, v90
  v_add_f32_e32 v106, v106, v122
  v_add_f32_e32 v75, v75, v91
  v_add_f32_e32 v107, v107, v123
  v_add_f32_e32 v76, v76, v92
s_waitcnt lgkmcnt(0)
  v_add_f32_e32 v108, v108, v124
  v_add_f32_e32 v77, v77, v93
  v_add_f32_e32 v109, v109, v125
  v_add_f32_e32 v78, v78, v94
  v_add_f32_e32 v110, v110, v126
  v_add_f32_e32 v79, v79, v95
  v_add_f32_e32 v111, v111, v127
  v_add_f32_e32 v64, v64, v32
  v_add_f32_e32 v65, v65, v33
  v_add_f32_e32 v66, v66, v34
  v_add_f32_e32 v67, v67, v35
  v_add_f32_e32 v68, v68, v36
  v_add_f32_e32 v69, v69, v37
  v_add_f32_e32 v70, v70, v38
  v_add_f32_e32 v71, v71, v39
  v_add_f32_e32 v72, v72, v40
  v_add_f32_e32 v73, v73, v41
  v_add_f32_e32 v74, v74, v42
  v_add_f32_e32 v75, v75, v43
  v_add_f32_e32 v76, v76, v44
  v_add_f32_e32 v77, v77, v45
  v_add_f32_e32 v78, v78, v46
  v_add_f32_e32 v79, v79, v47
  v_add_f32_e32 v64, v64, v96
  v_add_f32_e32 v65, v65, v97
  v_add_f32_e32 v66, v66, v98
  v_add_f32_e32 v67, v67, v99
  v_add_f32_e32 v68, v68, v100
  v_add_f32_e32 v69, v69, v101
  v_add_f32_e32 v70, v70, v102
  v_add_f32_e32 v71, v71, v103
  v_add_f32_e32 v72, v72, v104
  v_add_f32_e32 v73, v73, v105
  v_add_f32_e32 v74, v74, v106
  v_add_f32_e32 v75, v75, v107
  v_add_f32_e32 v76, v76, v108
  v_add_f32_e32 v77, v77, v109
  v_add_f32_e32 v78, v78, v110
  v_add_f32_e64 v79, v79, v111
  v_cvt_pk_bf16_f32 v16, v64, v65
  v_cvt_pk_bf16_f32 v17, v66, v67
  v_cvt_pk_bf16_f32 v18, v68, v69
  v_cvt_pk_bf16_f32 v19, v70, v71
  v_cvt_pk_bf16_f32 v20, v72, v73
  v_cvt_pk_bf16_f32 v21, v74, v75
  v_cvt_pk_bf16_f32 v22, v76, v77
  v_cvt_pk_bf16_f32 v23, v78, v79
  buffer_store_dwordx4 v[16:19], v8, s[12:15], s32 offen
  buffer_store_dwordx4 v[20:23], v8, s[12:15], s32 offen offset:16
  s_endpgm
s_nop 0
K2_ATTN:
  s_setprio 1
  s_lshl_b32 s6, s6, 2
  s_add_u32 s6, s6, s4
  v_and_b32_e32 v5, 63, v0
  v_lshlrev_b32_e32 v1, 4, v5
  v_lshrrev_b32_e32 v6, 5, v5
  v_lshlrev_b32_e32 v2, 9, v6
  v_and_b32_e32 v7, 15, v5
  v_lshlrev_b32_e64 v7, 4, v7
  v_lshl_add_u32 v3, v6, 8, v7
  s_lshl_b32 s72, s6, 16
  s_lshl_b32 s74, s5, 11
  s_add_u32 s75, s72, s74
s_nop 0
  buffer_load_dwordx4 v[128:131], v1, s[8:11], s75 offen
  buffer_load_dwordx4 v[132:135], v1, s[8:11], s75 offen offset:1024
  s_add_u32 s70, s72, 2097152
  s_add_u32 s71, s72, 4194304
  s_sub_u32 s74, s74, 8192
  s_cmp_ge_i32 s74, 0
  s_cselect_b64 vcc, -1, 0
  s_cselect_b32 s72, s74, 0
  s_add_u32 s72, s72, s70
  v_cndmask_b32_e64 v4, v2, v1, vcc
  buffer_load_dwordx4 v[8:11], v4, s[8:11], s72 offen
  s_add_u32 s74, s74, 1024
  s_cmp_ge_i32 s74, 0
  s_cselect_b64 vcc, -1, 0
  s_cselect_b32 s72, s74, 0
  s_add_u32 s72, s72, s70
  v_cndmask_b32_e64 v4, v2, v1, vcc
  buffer_load_dwordx4 v[12:15], v4, s[8:11], s72 offen
  s_add_u32 s74, s74, 1024
  s_cmp_ge_i32 s74, 0
  s_cselect_b64 vcc, -1, 0
  s_cselect_b32 s72, s74, 0
  s_add_u32 s72, s72, s70
  v_cndmask_b32_e64 v4, v2, v1, vcc
  buffer_load_dwordx4 v[16:19], v4, s[8:11], s72 offen
  s_add_u32 s74, s74, 1024
  s_cmp_ge_i32 s74, 0
  s_cselect_b64 vcc, -1, 0
  s_cselect_b32 s72, s74, 0
  s_add_u32 s72, s72, s70
  v_cndmask_b32_e64 v4, v2, v1, vcc
  buffer_load_dwordx4 v[20:23], v4, s[8:11], s72 offen
  s_add_u32 s74, s74, 1024
  s_cmp_ge_i32 s74, 0
  s_cselect_b64 vcc, -1, 0
  s_cselect_b32 s72, s74, 0
  s_add_u32 s72, s72, s70
  v_cndmask_b32_e64 v4, v2, v1, vcc
  buffer_load_dwordx4 v[24:27], v4, s[8:11], s72 offen
  s_add_u32 s74, s74, 1024
  s_cmp_ge_i32 s74, 0
  s_cselect_b64 vcc, -1, 0
  s_cselect_b32 s72, s74, 0
  s_add_u32 s72, s72, s70
  v_cndmask_b32_e64 v4, v2, v1, vcc
  buffer_load_dwordx4 v[28:31], v4, s[8:11], s72 offen
  s_add_u32 s74, s74, 1024
  s_cmp_ge_i32 s74, 0
  s_cselect_b64 vcc, -1, 0
  s_cselect_b32 s72, s74, 0
  s_add_u32 s72, s72, s70
  v_cndmask_b32_e64 v4, v2, v1, vcc
  buffer_load_dwordx4 v[32:35], v4, s[8:11], s72 offen
  s_add_u32 s74, s74, 1024
  s_cmp_ge_i32 s74, 0
  s_cselect_b64 vcc, -1, 0
  s_cselect_b32 s72, s74, 0
  s_add_u32 s72, s72, s70
  v_cndmask_b32_e64 v4, v2, v1, vcc
  buffer_load_dwordx4 v[36:39], v4, s[8:11], s72 offen
  s_add_u32 s74, s74, 1024
  s_cmp_ge_i32 s74, 0
  s_cselect_b64 vcc, -1, 0
  s_cselect_b32 s72, s74, 0
  s_add_u32 s72, s72, s70
  v_cndmask_b32_e64 v4, v2, v1, vcc
  buffer_load_dwordx4 v[40:43], v4, s[8:11], s72 offen
  s_add_u32 s74, s74, 1024
  s_cmp_ge_i32 s74, 0
  s_cselect_b64 vcc, -1, 0
  s_cselect_b32 s72, s74, 0
  s_add_u32 s72, s72, s70
  v_cndmask_b32_e64 v4, v2, v1, vcc
  buffer_load_dwordx4 v[44:47], v4, s[8:11], s72 offen
  s_add_u32 s74, s74, 1024
  s_sub_u32 s74, s74, 10240
  s_cmp_ge_i32 s74, 0
s_nop 0
  s_cselect_b32 s73, 0x3f803f80, 0
  s_add_u32 s72, s74, s71
  s_cmp_ge_i32 s74, 0
  s_cselect_b32 s72, s72, 0x7ff00000
  v_mov_b32_e32 v48, s73
  v_mov_b32_e32 v49, s73
  v_mov_b32_e32 v50, s73
  v_mov_b32_e32 v51, s73
  v_mov_b32_e32 v52, s73
  v_mov_b32_e32 v53, s73
  v_mov_b32_e32 v54, s73
  v_mov_b32_e32 v55, s73
  s_mov_b32 exec_lo, 0xffff
  s_mov_b32 exec_hi, 0xffff
  buffer_load_dwordx4 v[48:51], v3, s[8:11], s72 offen offset:0
  buffer_load_dwordx4 v[52:55], v3, s[8:11], s72 offen offset:512
  s_mov_b64 exec, -1
s_nop 0
  s_add_u32 s74, s74, 1024
  s_cmp_ge_i32 s74, 0
s_nop 0
  s_cselect_b32 s73, 0x3f803f80, 0
  s_add_u32 s72, s74, s71
  s_cmp_ge_i32 s74, 0
  s_cselect_b32 s72, s72, 0x7ff00000
  v_mov_b32_e32 v56, s73
  v_mov_b32_e32 v57, s73
  v_mov_b32_e32 v58, s73
  v_mov_b32_e32 v59, s73
  v_mov_b32_e32 v60, s73
  v_mov_b32_e32 v61, s73
  v_mov_b32_e32 v62, s73
  v_mov_b32_e32 v63, s73
  s_mov_b32 exec_lo, 0xffff
  s_mov_b32 exec_hi, 0xffff
  buffer_load_dwordx4 v[56:59], v3, s[8:11], s72 offen offset:0
  buffer_load_dwordx4 v[60:63], v3, s[8:11], s72 offen offset:512
  s_mov_b64 exec, -1
s_nop 0
  s_add_u32 s74, s74, 1024
  s_cmp_ge_i32 s74, 0
s_nop 0
  s_cselect_b32 s73, 0x3f803f80, 0
  s_add_u32 s72, s74, s71
  s_cmp_ge_i32 s74, 0
  s_cselect_b32 s72, s72, 0x7ff00000
  v_mov_b32_e32 v64, s73
  v_mov_b32_e32 v65, s73
  v_mov_b32_e32 v66, s73
  v_mov_b32_e32 v67, s73
  v_mov_b32_e32 v68, s73
  v_mov_b32_e32 v69, s73
  v_mov_b32_e32 v70, s73
  v_mov_b32_e32 v71, s73
  s_mov_b32 exec_lo, 0xffff
  s_mov_b32 exec_hi, 0xffff
  buffer_load_dwordx4 v[64:67], v3, s[8:11], s72 offen offset:0
  buffer_load_dwordx4 v[68:71], v3, s[8:11], s72 offen offset:512
  s_mov_b64 exec, -1
s_nop 0
  s_add_u32 s74, s74, 1024
  s_cmp_ge_i32 s74, 0
s_nop 0
  s_cselect_b32 s73, 0x3f803f80, 0
  s_add_u32 s72, s74, s71
  s_cmp_ge_i32 s74, 0
  s_cselect_b32 s72, s72, 0x7ff00000
  v_mov_b32_e32 v72, s73
  v_mov_b32_e32 v73, s73
  v_mov_b32_e32 v74, s73
  v_mov_b32_e32 v75, s73
  v_mov_b32_e32 v76, s73
  v_mov_b32_e32 v77, s73
  v_mov_b32_e32 v78, s73
  v_mov_b32_e32 v79, s73
  s_mov_b32 exec_lo, 0xffff
  s_mov_b32 exec_hi, 0xffff
  buffer_load_dwordx4 v[72:75], v3, s[8:11], s72 offen offset:0
  buffer_load_dwordx4 v[76:79], v3, s[8:11], s72 offen offset:512
  s_mov_b64 exec, -1
s_nop 0
  s_add_u32 s74, s74, 1024
  s_cmp_ge_i32 s74, 0
s_nop 0
  s_cselect_b32 s73, 0x3f803f80, 0
  s_add_u32 s72, s74, s71
  s_cmp_ge_i32 s74, 0
  s_cselect_b32 s72, s72, 0x7ff00000
  v_mov_b32_e32 v80, s73
  v_mov_b32_e32 v81, s73
  v_mov_b32_e32 v82, s73
  v_mov_b32_e32 v83, s73
  v_mov_b32_e32 v84, s73
  v_mov_b32_e32 v85, s73
  v_mov_b32_e32 v86, s73
  v_mov_b32_e32 v87, s73
  s_mov_b32 exec_lo, 0xffff
  s_mov_b32 exec_hi, 0xffff
  buffer_load_dwordx4 v[80:83], v3, s[8:11], s72 offen offset:0
  buffer_load_dwordx4 v[84:87], v3, s[8:11], s72 offen offset:512
  s_mov_b64 exec, -1
s_nop 0
  s_add_u32 s74, s74, 1024
  s_cmp_ge_i32 s74, 0
s_nop 0
  s_cselect_b32 s73, 0x3f803f80, 0
  s_add_u32 s72, s74, s71
  s_cmp_ge_i32 s74, 0
  s_cselect_b32 s72, s72, 0x7ff00000
  v_mov_b32_e32 v88, s73
  v_mov_b32_e32 v89, s73
  v_mov_b32_e32 v90, s73
  v_mov_b32_e32 v91, s73
  v_mov_b32_e32 v92, s73
  v_mov_b32_e32 v93, s73
  v_mov_b32_e32 v94, s73
  v_mov_b32_e32 v95, s73
  s_mov_b32 exec_lo, 0xffff
  s_mov_b32 exec_hi, 0xffff
  buffer_load_dwordx4 v[88:91], v3, s[8:11], s72 offen offset:0
  buffer_load_dwordx4 v[92:95], v3, s[8:11], s72 offen offset:512
  s_mov_b64 exec, -1
s_nop 0
  s_add_u32 s74, s74, 1024
  s_cmp_ge_i32 s74, 0
s_nop 0
  s_cselect_b32 s73, 0x3f803f80, 0
  s_add_u32 s72, s74, s71
  s_cmp_ge_i32 s74, 0
  s_cselect_b32 s72, s72, 0x7ff00000
  v_mov_b32_e32 v96, s73
  v_mov_b32_e32 v97, s73
  v_mov_b32_e32 v98, s73
  v_mov_b32_e32 v99, s73
  v_mov_b32_e32 v100, s73
  v_mov_b32_e32 v101, s73
  v_mov_b32_e32 v102, s73
  v_mov_b32_e32 v103, s73
  s_mov_b32 exec_lo, 0xffff
  s_mov_b32 exec_hi, 0xffff
  buffer_load_dwordx4 v[96:99], v3, s[8:11], s72 offen offset:0
  buffer_load_dwordx4 v[100:103], v3, s[8:11], s72 offen offset:512
  s_mov_b64 exec, -1
s_nop 0
  s_add_u32 s74, s74, 1024
  s_cmp_ge_i32 s74, 0
s_nop 0
  s_cselect_b32 s73, 0x3f803f80, 0
  s_add_u32 s72, s74, s71
  s_cmp_ge_i32 s74, 0
  s_cselect_b32 s72, s72, 0x7ff00000
  v_mov_b32_e32 v104, s73
  v_mov_b32_e32 v105, s73
  v_mov_b32_e32 v106, s73
  v_mov_b32_e32 v107, s73
  v_mov_b32_e32 v108, s73
  v_mov_b32_e32 v109, s73
  v_mov_b32_e32 v110, s73
  v_mov_b32_e32 v111, s73
  s_mov_b32 exec_lo, 0xffff
  s_mov_b32 exec_hi, 0xffff
  buffer_load_dwordx4 v[104:107], v3, s[8:11], s72 offen offset:0
  buffer_load_dwordx4 v[108:111], v3, s[8:11], s72 offen offset:512
  s_mov_b64 exec, -1
s_nop 0
  s_add_u32 s74, s74, 1024
  s_cmp_ge_i32 s74, 0
s_nop 0
  s_cselect_b32 s73, 0x3f803f80, 0
  s_add_u32 s72, s74, s71
  s_cmp_ge_i32 s74, 0
  s_cselect_b32 s72, s72, 0x7ff00000
  v_mov_b32_e32 v112, s73
  v_mov_b32_e32 v113, s73
  v_mov_b32_e32 v114, s73
  v_mov_b32_e32 v115, s73
  v_mov_b32_e32 v116, s73
  v_mov_b32_e32 v117, s73
  v_mov_b32_e32 v118, s73
  v_mov_b32_e32 v119, s73
  s_mov_b32 exec_lo, 0xffff
  s_mov_b32 exec_hi, 0xffff
  buffer_load_dwordx4 v[112:115], v3, s[8:11], s72 offen offset:0
  buffer_load_dwordx4 v[116:119], v3, s[8:11], s72 offen offset:512
  s_mov_b64 exec, -1
s_nop 0
  s_add_u32 s74, s74, 1024
  s_cmp_ge_i32 s74, 0
s_nop 0
  s_cselect_b32 s73, 0x3f803f80, 0
  s_add_u32 s72, s74, s71
  s_cmp_ge_i32 s74, 0
  s_cselect_b32 s72, s72, 0x7ff00000
  v_mov_b32_e32 v120, s73
  v_mov_b32_e32 v121, s73
  v_mov_b32_e32 v122, s73
  v_mov_b32_e32 v123, s73
  v_mov_b32_e32 v124, s73
  v_mov_b32_e32 v125, s73
  v_mov_b32_e32 v126, s73
  v_mov_b32_e32 v127, s73
  s_mov_b32 exec_lo, 0xffff
  s_mov_b32 exec_hi, 0xffff
  buffer_load_dwordx4 v[120:123], v3, s[8:11], s72 offen offset:0
  buffer_load_dwordx4 v[124:127], v3, s[8:11], s72 offen offset:512
  s_mov_b64 exec, -1
s_nop 0
  s_add_u32 s74, s74, 1024
  s_barrier
s_nop 0
  s_mov_b32 s36, 0xffffffff
  s_mov_b32 s37, 0xfffffff0
  s_mov_b32 s38, 0xfffffffe
  s_mov_b32 s39, 0xffffffe0
  s_mov_b32 s40, 0xfffffffc
  s_mov_b32 s41, 0xffffffc0
  s_mov_b32 s42, 0xfffffff8
  s_mov_b32 s43, 0xffffff80
  s_mov_b32 s44, 0xffffff00
  s_mov_b32 s45, 0xfffff000
  s_mov_b32 s46, 0xfffffe00
  s_mov_b32 s47, 0xffffe000
  s_mov_b32 s48, 0xfffffc00
  s_mov_b32 s49, 0xffffc000
  s_mov_b32 s50, 0xfffff800
  s_mov_b32 s51, 0xffff8000
  s_mov_b32 s52, 0xffff0000
  s_mov_b32 s53, 0xfff00000
  s_mov_b32 s54, 0xfffe0000
  s_mov_b32 s55, 0xffe00000
  s_mov_b32 s56, 0xfffc0000
  s_mov_b32 s57, 0xffc00000
  s_mov_b32 s58, 0xfff80000
  s_mov_b32 s59, 0xff800000
  s_mov_b32 s60, 0xff000000
  s_mov_b32 s61, 0xf0000000
  s_mov_b32 s62, 0xfe000000
  s_mov_b32 s63, 0xe0000000
  s_mov_b32 s64, 0xfc000000
  s_mov_b32 s65, 0xc0000000
  s_mov_b32 s66, 0xf8000000
  s_mov_b32 s67, 0x80000000
  v_mov_b32_e32 v240, 0xffff
  v_mov_b32_e32 v241, 0xffff0000
  v_cndmask_b32_e64 v232, 0, v240, s[36:37]
  v_cndmask_b32_e64 v242, 0, v241, s[38:39]
  v_or_b32_e64 v232, v232, v242
  v_cndmask_b32_e64 v233, 0, v240, s[40:41]
  v_cndmask_b32_e64 v242, 0, v241, s[42:43]
  v_or_b32_e64 v233, v233, v242
  v_cndmask_b32_e64 v234, 0, v240, s[44:45]
  v_cndmask_b32_e64 v242, 0, v241, s[46:47]
  v_or_b32_e64 v234, v234, v242
  v_cndmask_b32_e64 v235, 0, v240, s[48:49]
  v_cndmask_b32_e64 v242, 0, v241, s[50:51]
  v_or_b32_e64 v235, v235, v242
  v_cndmask_b32_e64 v236, 0, v240, s[52:53]
  v_cndmask_b32_e64 v242, 0, v241, s[54:55]
  v_or_b32_e64 v236, v236, v242
  v_cndmask_b32_e64 v237, 0, v240, s[56:57]
  v_cndmask_b32_e64 v242, 0, v241, s[58:59]
  v_or_b32_e64 v237, v237, v242
  v_cndmask_b32_e64 v238, 0, v240, s[60:61]
  v_cndmask_b32_e64 v242, 0, v241, s[62:63]
  v_or_b32_e64 v238, v238, v242
  v_cndmask_b32_e64 v239, 0, v240, s[64:65]
  v_cndmask_b32_e64 v242, 0, v241, s[66:67]
  v_or_b32_e64 v239, v239, v242
  s_mul_i32 s80, s5, 288
  s_add_u32 s80, s80, s6
s_nop 0
  s_add_u32 s80, s80, 112
  s_lshl_b32 s80, s80, 10
s_nop 0
  s_add_u32 s80, s80, 6291456
  s_add_u32 s81, s80, 147456
s_waitcnt vmcnt(29)
s_nop 0
  v_mfma_f32_32x32x16_bf16 v[136:151], v[8:11], v[128:131], 0
s_waitcnt vmcnt(21)
s_nop 0
  v_mfma_f32_32x32x16_bf16 v[152:167], v[40:43], v[128:131], 0
  v_mfma_f32_32x32x16_bf16 v[168:183], v[12:15], v[128:131], 0
s_nop 10
s_nop 0
  v_cndmask_b32_e64 v152, v136, v152, s[36:37]
  v_cndmask_b32_e64 v153, v137, v153, s[38:39]
  v_cndmask_b32_e64 v154, v138, v154, s[40:41]
  v_cndmask_b32_e64 v155, v139, v155, s[42:43]
  v_cndmask_b32_e64 v156, v140, v156, s[44:45]
  v_cndmask_b32_e64 v157, v141, v157, s[46:47]
  v_cndmask_b32_e64 v158, v142, v158, s[48:49]
  v_cndmask_b32_e64 v159, v143, v159, s[50:51]
  v_cndmask_b32_e64 v160, v144, v160, s[52:53]
  v_cndmask_b32_e64 v161, v145, v161, s[54:55]
  v_cndmask_b32_e64 v162, v146, v162, s[56:57]
  v_cndmask_b32_e64 v163, v147, v163, s[58:59]
  v_cndmask_b32_e64 v164, v148, v164, s[60:61]
  v_cndmask_b32_e64 v165, v149, v165, s[62:63]
  v_cndmask_b32_e64 v166, v150, v166, s[64:65]
  v_cndmask_b32_e64 v167, v151, v167, s[66:67]
  v_mfma_f32_32x32x16_bf16 v[136:151], v[16:19], v[128:131], 0
  v_max_f32_e32 v240, v152, v153
  v_max_f32_e32 v241, v154, v155
  v_max3_f32 v240, v156, v157, v240
  v_max3_f32 v241, v158, v159, v241
  v_max3_f32 v240, v160, v161, v240
  v_max3_f32 v241, v162, v163, v241
  v_max3_f32 v240, v164, v165, v240
  v_max3_f32 v241, v166, v167, v241
  v_mfma_f32_32x32x16_bf16 v[152:167], v[20:23], v[128:131], 0
  v_max3_f32 v240, v168, v169, v240
  v_max3_f32 v241, v170, v171, v241
  v_max3_f32 v240, v172, v173, v240
  v_max3_f32 v241, v174, v175, v241
  v_max3_f32 v240, v176, v177, v240
  v_max3_f32 v241, v178, v179, v241
  v_max3_f32 v240, v180, v181, v240
  v_max3_f32 v241, v182, v183, v241
  v_mfma_f32_32x32x16_bf16 v[168:183], v[24:27], v[128:131], 0
  v_max3_f32 v240, v136, v137, v240
  v_max3_f32 v241, v138, v139, v241
  v_max3_f32 v240, v140, v141, v240
  v_max3_f32 v241, v142, v143, v241
  v_max3_f32 v240, v144, v145, v240
  v_max3_f32 v241, v146, v147, v241
  v_max3_f32 v240, v148, v149, v240
  v_max3_f32 v241, v150, v151, v241
  v_mfma_f32_32x32x16_bf16 v[136:151], v[28:31], v[128:131], 0
  v_max3_f32 v240, v152, v153, v240
  v_max3_f32 v241, v154, v155, v241
  v_max3_f32 v240, v156, v157, v240
  v_max3_f32 v241, v158, v159, v241
  v_max3_f32 v240, v160, v161, v240
  v_max3_f32 v241, v162, v163, v241
  v_max3_f32 v240, v164, v165, v240
  v_max3_f32 v241, v166, v167, v241
  v_mfma_f32_32x32x16_bf16 v[152:167], v[32:35], v[128:131], 0
  v_max3_f32 v240, v168, v169, v240
  v_max3_f32 v241, v170, v171, v241
  v_max3_f32 v240, v172, v173, v240
  v_max3_f32 v241, v174, v175, v241
  v_max3_f32 v240, v176, v177, v240
  v_max3_f32 v241, v178, v179, v241
  v_max3_f32 v240, v180, v181, v240
  v_max3_f32 v241, v182, v183, v241
  v_mfma_f32_32x32x16_bf16 v[168:183], v[36:39], v[128:131], 0
  v_max3_f32 v240, v136, v137, v240
  v_max3_f32 v241, v138, v139, v241
  v_max3_f32 v240, v140, v141, v240
  v_max3_f32 v241, v142, v143, v241
  v_max3_f32 v240, v144, v145, v240
  v_max3_f32 v241, v146, v147, v241
  v_max3_f32 v240, v148, v149, v240
  v_max3_f32 v241, v150, v151, v241
  v_max3_f32 v240, v152, v153, v240
  v_max3_f32 v241, v154, v155, v241
  v_max3_f32 v240, v156, v157, v240
  v_max3_f32 v241, v158, v159, v241
  v_max3_f32 v240, v160, v161, v240
  v_max3_f32 v241, v162, v163, v241
  v_max3_f32 v240, v164, v165, v240
  v_max3_f32 v241, v166, v167, v241
  v_max3_f32 v240, v168, v169, v240
  v_max3_f32 v241, v170, v171, v241
  v_max3_f32 v240, v172, v173, v240
  v_max3_f32 v241, v174, v175, v241
  v_max3_f32 v240, v176, v177, v240
  v_max3_f32 v241, v178, v179, v241
  v_max3_f32 v240, v180, v181, v240
  v_max3_f32 v241, v182, v183, v241
  v_max_f32_e32 v240, v240, v241
  v_mov_b32_e32 v241, v240
s_nop 1
  v_permlane32_swap_b32 v240, v241
  v_max_f32_e32 v240, v240, v241
  v_sub_f32_e32 v216, 0, v240
  v_sub_f32_e32 v217, 0, v240
  v_sub_f32_e32 v218, 0, v240
  v_sub_f32_e32 v219, 0, v240
  v_sub_f32_e32 v220, 0, v240
  v_sub_f32_e32 v221, 0, v240
  v_sub_f32_e32 v222, 0, v240
  v_sub_f32_e32 v223, 0, v240
  v_sub_f32_e32 v224, 0, v240
  v_sub_f32_e32 v225, 0, v240
  v_sub_f32_e32 v226, 0, v240
  v_sub_f32_e32 v227, 0, v240
  v_sub_f32_e32 v228, 0, v240
  v_sub_f32_e32 v229, 0, v240
  v_sub_f32_e32 v230, 0, v240
  v_sub_f32_e32 v231, 0, v240
s_nop 1
  v_mfma_f32_32x32x16_bf16 v[136:151], v[8:11], v[128:131], v[216:231]
  v_mfma_f32_32x32x16_bf16 v[152:167], v[40:43], v[128:131], v[216:231]
  v_mfma_f32_32x32x16_bf16 v[168:183], v[12:15], v[128:131], v[216:231]
s_nop 10
s_nop 0
  v_cndmask_b32_e64 v152, v136, v152, s[36:37]
  v_cndmask_b32_e64 v153, v137, v153, s[38:39]
  v_cndmask_b32_e64 v154, v138, v154, s[40:41]
  v_cndmask_b32_e64 v155, v139, v155, s[42:43]
  v_cndmask_b32_e64 v156, v140, v156, s[44:45]
  v_cndmask_b32_e64 v157, v141, v157, s[46:47]
  v_cndmask_b32_e64 v158, v142, v158, s[48:49]
  v_cndmask_b32_e64 v159, v143, v159, s[50:51]
  v_cndmask_b32_e64 v160, v144, v160, s[52:53]
  v_cndmask_b32_e64 v161, v145, v161, s[54:55]
  v_cndmask_b32_e64 v162, v146, v162, s[56:57]
  v_cndmask_b32_e64 v163, v147, v163, s[58:59]
  v_cndmask_b32_e64 v164, v148, v164, s[60:61]
  v_cndmask_b32_e64 v165, v149, v165, s[62:63]
  v_cndmask_b32_e64 v166, v150, v166, s[64:65]
  v_cndmask_b32_e64 v167, v151, v167, s[66:67]
  v_mfma_f32_32x32x16_bf16 v[136:151], v[16:19], v[128:131], v[216:231]
  v_exp_f32_e32 v152, v152
  v_exp_f32_e32 v153, v153
  v_exp_f32_e32 v154, v154
  v_exp_f32_e32 v155, v155
  v_exp_f32_e32 v156, v156
  v_exp_f32_e32 v157, v157
  v_exp_f32_e32 v158, v158
  v_exp_f32_e32 v159, v159
  v_cvt_pk_bf16_f32 v184, v152, v153
  v_cvt_pk_bf16_f32 v185, v154, v155
  v_cvt_pk_bf16_f32 v186, v156, v157
  v_cvt_pk_bf16_f32 v187, v158, v159
  v_exp_f32_e32 v160, v160
  v_exp_f32_e32 v161, v161
  v_exp_f32_e32 v162, v162
  v_exp_f32_e32 v163, v163
  v_exp_f32_e32 v164, v164
  v_exp_f32_e32 v165, v165
  v_exp_f32_e32 v166, v166
  v_exp_f32_e32 v167, v167
  v_cvt_pk_bf16_f32 v188, v160, v161
  v_cvt_pk_bf16_f32 v189, v162, v163
  v_cvt_pk_bf16_f32 v190, v164, v165
  v_cvt_pk_bf16_f32 v191, v166, v167
  v_bfi_b32 v192, v232, 0, v184
  v_bfi_b32 v193, v233, 0, v185
  v_bfi_b32 v194, v234, 0, v186
  v_bfi_b32 v195, v235, 0, v187
  v_bfi_b32 v196, v236, 0, v188
  v_bfi_b32 v197, v237, 0, v189
  v_bfi_b32 v198, v238, 0, v190
  v_bfi_b32 v199, v239, 0, v191
  v_and_b32_e32 v184, v232, v184
  v_and_b32_e32 v185, v233, v185
  v_and_b32_e32 v186, v234, v186
  v_and_b32_e32 v187, v235, v187
  v_and_b32_e32 v188, v236, v188
  v_and_b32_e32 v189, v237, v189
  v_and_b32_e32 v190, v238, v190
  v_and_b32_e32 v191, v239, v191
s_waitcnt vmcnt(19)
s_nop 0
  v_mfma_f32_32x32x16_bf16 v[200:215], v[48:51], v[192:195], 0
s_waitcnt vmcnt(18)
s_nop 0
  v_mfma_f32_32x32x16_bf16 v[200:215], v[52:55], v[196:199], v[200:215]
s_waitcnt vmcnt(3)
s_nop 0
  v_mfma_f32_32x32x16_bf16 v[200:215], v[112:115], v[184:187], v[200:215]
s_waitcnt vmcnt(2)
s_nop 0
  v_mfma_f32_32x32x16_bf16 v[200:215], v[116:119], v[188:191], v[200:215]
  v_mfma_f32_32x32x16_bf16 v[152:167], v[20:23], v[128:131], v[216:231]
  v_exp_f32_e32 v168, v168
  v_exp_f32_e32 v169, v169
  v_exp_f32_e32 v170, v170
  v_exp_f32_e32 v171, v171
  v_exp_f32_e32 v172, v172
  v_exp_f32_e32 v173, v173
  v_exp_f32_e32 v174, v174
  v_exp_f32_e32 v175, v175
  v_cvt_pk_bf16_f32 v184, v168, v169
  v_cvt_pk_bf16_f32 v185, v170, v171
  v_cvt_pk_bf16_f32 v186, v172, v173
  v_cvt_pk_bf16_f32 v187, v174, v175
  v_exp_f32_e32 v176, v176
  v_exp_f32_e32 v177, v177
  v_exp_f32_e32 v178, v178
  v_exp_f32_e32 v179, v179
  v_exp_f32_e32 v180, v180
  v_exp_f32_e32 v181, v181
  v_exp_f32_e32 v182, v182
  v_exp_f32_e32 v183, v183
  v_cvt_pk_bf16_f32 v188, v176, v177
  v_cvt_pk_bf16_f32 v189, v178, v179
  v_cvt_pk_bf16_f32 v190, v180, v181
  v_cvt_pk_bf16_f32 v191, v182, v183
  v_mfma_f32_32x32x16_bf16 v[200:215], v[56:59], v[184:187], v[200:215]
s_nop 0
s_nop 0
  v_mfma_f32_32x32x16_bf16 v[200:215], v[60:63], v[188:191], v[200:215]
  v_mfma_f32_32x32x16_bf16 v[168:183], v[24:27], v[128:131], v[216:231]
  v_exp_f32_e32 v136, v136
  v_exp_f32_e32 v137, v137
  v_exp_f32_e32 v138, v138
  v_exp_f32_e32 v139, v139
  v_exp_f32_e32 v140, v140
  v_exp_f32_e32 v141, v141
  v_exp_f32_e32 v142, v142
  v_exp_f32_e32 v143, v143
  v_cvt_pk_bf16_f32 v192, v136, v137
  v_cvt_pk_bf16_f32 v193, v138, v139
  v_cvt_pk_bf16_f32 v194, v140, v141
  v_cvt_pk_bf16_f32 v195, v142, v143
  v_exp_f32_e32 v144, v144
  v_exp_f32_e32 v145, v145
  v_exp_f32_e32 v146, v146
  v_exp_f32_e32 v147, v147
  v_exp_f32_e32 v148, v148
  v_exp_f32_e32 v149, v149
  v_exp_f32_e32 v150, v150
  v_exp_f32_e32 v151, v151
  v_cvt_pk_bf16_f32 v196, v144, v145
  v_cvt_pk_bf16_f32 v197, v146, v147
  v_cvt_pk_bf16_f32 v198, v148, v149
  v_cvt_pk_bf16_f32 v199, v150, v151
  v_mfma_f32_32x32x16_bf16 v[200:215], v[64:67], v[192:195], v[200:215]
s_nop 0
s_nop 0
  v_mfma_f32_32x32x16_bf16 v[200:215], v[68:71], v[196:199], v[200:215]
  v_mfma_f32_32x32x16_bf16 v[136:151], v[28:31], v[128:131], v[216:231]
  v_exp_f32_e32 v152, v152
  v_exp_f32_e32 v153, v153
  v_exp_f32_e32 v154, v154
  v_exp_f32_e32 v155, v155
  v_exp_f32_e32 v156, v156
  v_exp_f32_e32 v157, v157
  v_exp_f32_e32 v158, v158
  v_exp_f32_e32 v159, v159
  v_cvt_pk_bf16_f32 v184, v152, v153
  v_cvt_pk_bf16_f32 v185, v154, v155
  v_cvt_pk_bf16_f32 v186, v156, v157
  v_cvt_pk_bf16_f32 v187, v158, v159
  v_exp_f32_e32 v160, v160
  v_exp_f32_e32 v161, v161
  v_exp_f32_e32 v162, v162
  v_exp_f32_e32 v163, v163
  v_exp_f32_e32 v164, v164
  v_exp_f32_e32 v165, v165
  v_exp_f32_e32 v166, v166
  v_exp_f32_e32 v167, v167
  v_cvt_pk_bf16_f32 v188, v160, v161
  v_cvt_pk_bf16_f32 v189, v162, v163
  v_cvt_pk_bf16_f32 v190, v164, v165
  v_cvt_pk_bf16_f32 v191, v166, v167
  v_mfma_f32_32x32x16_bf16 v[200:215], v[72:75], v[184:187], v[200:215]
s_nop 0
s_nop 0
  v_mfma_f32_32x32x16_bf16 v[200:215], v[76:79], v[188:191], v[200:215]
  v_mfma_f32_32x32x16_bf16 v[152:167], v[32:35], v[128:131], v[216:231]
  v_exp_f32_e32 v168, v168
  v_exp_f32_e32 v169, v169
  v_exp_f32_e32 v170, v170
  v_exp_f32_e32 v171, v171
  v_exp_f32_e32 v172, v172
  v_exp_f32_e32 v173, v173
  v_exp_f32_e32 v174, v174
  v_exp_f32_e32 v175, v175
  v_cvt_pk_bf16_f32 v192, v168, v169
  v_cvt_pk_bf16_f32 v193, v170, v171
  v_cvt_pk_bf16_f32 v194, v172, v173
  v_cvt_pk_bf16_f32 v195, v174, v175
  v_exp_f32_e32 v176, v176
  v_exp_f32_e32 v177, v177
  v_exp_f32_e32 v178, v178
  v_exp_f32_e32 v179, v179
  v_exp_f32_e32 v180, v180
  v_exp_f32_e32 v181, v181
  v_exp_f32_e32 v182, v182
  v_exp_f32_e32 v183, v183
  v_cvt_pk_bf16_f32 v196, v176, v177
  v_cvt_pk_bf16_f32 v197, v178, v179
  v_cvt_pk_bf16_f32 v198, v180, v181
  v_cvt_pk_bf16_f32 v199, v182, v183
  v_mfma_f32_32x32x16_bf16 v[200:215], v[80:83], v[192:195], v[200:215]
s_nop 0
s_nop 0
  v_mfma_f32_32x32x16_bf16 v[200:215], v[84:87], v[196:199], v[200:215]
  v_mfma_f32_32x32x16_bf16 v[168:183], v[36:39], v[128:131], v[216:231]
  v_exp_f32_e32 v136, v136
  v_exp_f32_e32 v137, v137
  v_exp_f32_e32 v138, v138
  v_exp_f32_e32 v139, v139
  v_exp_f32_e32 v140, v140
  v_exp_f32_e32 v141, v141
  v_exp_f32_e32 v142, v142
  v_exp_f32_e32 v143, v143
  v_cvt_pk_bf16_f32 v184, v136, v137
  v_cvt_pk_bf16_f32 v185, v138, v139
  v_cvt_pk_bf16_f32 v186, v140, v141
  v_cvt_pk_bf16_f32 v187, v142, v143
  v_exp_f32_e32 v144, v144
  v_exp_f32_e32 v145, v145
  v_exp_f32_e32 v146, v146
  v_exp_f32_e32 v147, v147
  v_exp_f32_e32 v148, v148
  v_exp_f32_e32 v149, v149
  v_exp_f32_e32 v150, v150
  v_exp_f32_e32 v151, v151
  v_cvt_pk_bf16_f32 v188, v144, v145
  v_cvt_pk_bf16_f32 v189, v146, v147
  v_cvt_pk_bf16_f32 v190, v148, v149
  v_cvt_pk_bf16_f32 v191, v150, v151
  v_mfma_f32_32x32x16_bf16 v[200:215], v[88:91], v[184:187], v[200:215]
s_nop 0
s_nop 0
  v_mfma_f32_32x32x16_bf16 v[200:215], v[92:95], v[188:191], v[200:215]
  v_exp_f32_e32 v152, v152
  v_exp_f32_e32 v153, v153
  v_exp_f32_e32 v154, v154
  v_exp_f32_e32 v155, v155
  v_exp_f32_e32 v156, v156
  v_exp_f32_e32 v157, v157
  v_exp_f32_e32 v158, v158
  v_exp_f32_e32 v159, v159
  v_cvt_pk_bf16_f32 v192, v152, v153
  v_cvt_pk_bf16_f32 v193, v154, v155
  v_cvt_pk_bf16_f32 v194, v156, v157
  v_cvt_pk_bf16_f32 v195, v158, v159
  v_exp_f32_e32 v160, v160
  v_exp_f32_e32 v161, v161
  v_exp_f32_e32 v162, v162
  v_exp_f32_e32 v163, v163
  v_exp_f32_e32 v164, v164
  v_exp_f32_e32 v165, v165
  v_exp_f32_e32 v166, v166
  v_exp_f32_e32 v167, v167
  v_cvt_pk_bf16_f32 v196, v160, v161
  v_cvt_pk_bf16_f32 v197, v162, v163
  v_cvt_pk_bf16_f32 v198, v164, v165
  v_cvt_pk_bf16_f32 v199, v166, v167
  v_mfma_f32_32x32x16_bf16 v[200:215], v[96:99], v[192:195], v[200:215]
s_nop 0
s_nop 0
  v_mfma_f32_32x32x16_bf16 v[200:215], v[100:103], v[196:199], v[200:215]
  v_exp_f32_e32 v168, v168
  v_exp_f32_e32 v169, v169
  v_exp_f32_e32 v170, v170
  v_exp_f32_e32 v171, v171
  v_exp_f32_e32 v172, v172
  v_exp_f32_e32 v173, v173
  v_exp_f32_e32 v174, v174
  v_exp_f32_e32 v175, v175
  v_cvt_pk_bf16_f32 v184, v168, v169
  v_cvt_pk_bf16_f32 v185, v170, v171
  v_cvt_pk_bf16_f32 v186, v172, v173
  v_cvt_pk_bf16_f32 v187, v174, v175
  v_exp_f32_e32 v176, v176
  v_exp_f32_e32 v177, v177
  v_exp_f32_e32 v178, v178
  v_exp_f32_e32 v179, v179
  v_exp_f32_e32 v180, v180
  v_exp_f32_e32 v181, v181
  v_exp_f32_e32 v182, v182
  v_exp_f32_e32 v183, v183
  v_cvt_pk_bf16_f32 v188, v176, v177
  v_cvt_pk_bf16_f32 v189, v178, v179
  v_cvt_pk_bf16_f32 v190, v180, v181
  v_cvt_pk_bf16_f32 v191, v182, v183
  v_mfma_f32_32x32x16_bf16 v[200:215], v[104:107], v[184:187], v[200:215]
s_nop 0
s_nop 0
  v_mfma_f32_32x32x16_bf16 v[200:215], v[108:111], v[188:191], v[200:215]
s_nop 11
  v_rcp_f32_e32 v240, v208
s_nop 0
  v_mul_f32_e32 v200, v200, v240
  v_mul_f32_e32 v201, v201, v240
  v_mul_f32_e32 v202, v202, v240
  v_mul_f32_e32 v203, v203, v240
  v_mul_f32_e32 v204, v204, v240
  v_mul_f32_e32 v205, v205, v240
  v_mul_f32_e32 v206, v206, v240
  v_mul_f32_e64 v207, v207, v240
  v_cvt_pk_bf16_f32 v200, v200, v201
  v_cvt_pk_bf16_f32 v201, v202, v203
  v_cvt_pk_bf16_f32 v202, v204, v205
  v_cvt_pk_bf16_f32 v203, v206, v207
  buffer_store_dwordx4 v[200:203], v1, s[8:11], s80 offen sc1
  v_mfma_f32_32x32x16_bf16 v[136:151], v[12:15], v[132:135], 0
  v_mfma_f32_32x32x16_bf16 v[152:167], v[44:47], v[132:135], 0
  v_mfma_f32_32x32x16_bf16 v[168:183], v[16:19], v[132:135], 0
s_nop 10
s_nop 0
  v_cndmask_b32_e64 v152, v136, v152, s[36:37]
  v_cndmask_b32_e64 v153, v137, v153, s[38:39]
  v_cndmask_b32_e64 v154, v138, v154, s[40:41]
  v_cndmask_b32_e64 v155, v139, v155, s[42:43]
  v_cndmask_b32_e64 v156, v140, v156, s[44:45]
  v_cndmask_b32_e64 v157, v141, v157, s[46:47]
  v_cndmask_b32_e64 v158, v142, v158, s[48:49]
  v_cndmask_b32_e64 v159, v143, v159, s[50:51]
  v_cndmask_b32_e64 v160, v144, v160, s[52:53]
  v_cndmask_b32_e64 v161, v145, v161, s[54:55]
  v_cndmask_b32_e64 v162, v146, v162, s[56:57]
  v_cndmask_b32_e64 v163, v147, v163, s[58:59]
  v_cndmask_b32_e64 v164, v148, v164, s[60:61]
  v_cndmask_b32_e64 v165, v149, v165, s[62:63]
  v_cndmask_b32_e64 v166, v150, v166, s[64:65]
  v_cndmask_b32_e64 v167, v151, v167, s[66:67]
  v_mfma_f32_32x32x16_bf16 v[136:151], v[20:23], v[132:135], 0
  v_max_f32_e32 v240, v152, v153
  v_max_f32_e32 v241, v154, v155
  v_max3_f32 v240, v156, v157, v240
  v_max3_f32 v241, v158, v159, v241
  v_max3_f32 v240, v160, v161, v240
  v_max3_f32 v241, v162, v163, v241
  v_max3_f32 v240, v164, v165, v240
  v_max3_f32 v241, v166, v167, v241
  v_mfma_f32_32x32x16_bf16 v[152:167], v[24:27], v[132:135], 0
  v_max3_f32 v240, v168, v169, v240
  v_max3_f32 v241, v170, v171, v241
  v_max3_f32 v240, v172, v173, v240
  v_max3_f32 v241, v174, v175, v241
  v_max3_f32 v240, v176, v177, v240
  v_max3_f32 v241, v178, v179, v241
  v_max3_f32 v240, v180, v181, v240
  v_max3_f32 v241, v182, v183, v241
  v_mfma_f32_32x32x16_bf16 v[168:183], v[28:31], v[132:135], 0
  v_max3_f32 v240, v136, v137, v240
  v_max3_f32 v241, v138, v139, v241
  v_max3_f32 v240, v140, v141, v240
  v_max3_f32 v241, v142, v143, v241
  v_max3_f32 v240, v144, v145, v240
  v_max3_f32 v241, v146, v147, v241
  v_max3_f32 v240, v148, v149, v240
  v_max3_f32 v241, v150, v151, v241
  v_mfma_f32_32x32x16_bf16 v[136:151], v[32:35], v[132:135], 0
  v_max3_f32 v240, v152, v153, v240
  v_max3_f32 v241, v154, v155, v241
  v_max3_f32 v240, v156, v157, v240
  v_max3_f32 v241, v158, v159, v241
  v_max3_f32 v240, v160, v161, v240
  v_max3_f32 v241, v162, v163, v241
  v_max3_f32 v240, v164, v165, v240
  v_max3_f32 v241, v166, v167, v241
  v_mfma_f32_32x32x16_bf16 v[152:167], v[36:39], v[132:135], 0
  v_max3_f32 v240, v168, v169, v240
  v_max3_f32 v241, v170, v171, v241
  v_max3_f32 v240, v172, v173, v240
  v_max3_f32 v241, v174, v175, v241
  v_max3_f32 v240, v176, v177, v240
  v_max3_f32 v241, v178, v179, v241
  v_max3_f32 v240, v180, v181, v240
  v_max3_f32 v241, v182, v183, v241
  v_mfma_f32_32x32x16_bf16 v[168:183], v[40:43], v[132:135], 0
  v_max3_f32 v240, v136, v137, v240
  v_max3_f32 v241, v138, v139, v241
  v_max3_f32 v240, v140, v141, v240
  v_max3_f32 v241, v142, v143, v241
  v_max3_f32 v240, v144, v145, v240
  v_max3_f32 v241, v146, v147, v241
  v_max3_f32 v240, v148, v149, v240
  v_max3_f32 v241, v150, v151, v241
  v_max3_f32 v240, v152, v153, v240
  v_max3_f32 v241, v154, v155, v241
  v_max3_f32 v240, v156, v157, v240
  v_max3_f32 v241, v158, v159, v241
  v_max3_f32 v240, v160, v161, v240
  v_max3_f32 v241, v162, v163, v241
  v_max3_f32 v240, v164, v165, v240
  v_max3_f32 v241, v166, v167, v241
  v_max3_f32 v240, v168, v169, v240
  v_max3_f32 v241, v170, v171, v241
  v_max3_f32 v240, v172, v173, v240
  v_max3_f32 v241, v174, v175, v241
  v_max3_f32 v240, v176, v177, v240
  v_max3_f32 v241, v178, v179, v241
  v_max3_f32 v240, v180, v181, v240
  v_max3_f32 v241, v182, v183, v241
  v_max_f32_e32 v240, v240, v241
  v_mov_b32_e32 v241, v240
s_nop 1
  v_permlane32_swap_b32 v240, v241
  v_max_f32_e32 v240, v240, v241
  v_sub_f32_e32 v216, 0, v240
  v_sub_f32_e32 v217, 0, v240
  v_sub_f32_e32 v218, 0, v240
  v_sub_f32_e32 v219, 0, v240
  v_sub_f32_e32 v220, 0, v240
  v_sub_f32_e32 v221, 0, v240
  v_sub_f32_e32 v222, 0, v240
  v_sub_f32_e32 v223, 0, v240
  v_sub_f32_e32 v224, 0, v240
  v_sub_f32_e32 v225, 0, v240
  v_sub_f32_e32 v226, 0, v240
  v_sub_f32_e32 v227, 0, v240
  v_sub_f32_e32 v228, 0, v240
  v_sub_f32_e32 v229, 0, v240
  v_sub_f32_e32 v230, 0, v240
  v_sub_f32_e32 v231, 0, v240
s_nop 1
  v_mfma_f32_32x32x16_bf16 v[136:151], v[12:15], v[132:135], v[216:231]
  v_mfma_f32_32x32x16_bf16 v[152:167], v[44:47], v[132:135], v[216:231]
  v_mfma_f32_32x32x16_bf16 v[168:183], v[16:19], v[132:135], v[216:231]
s_nop 10
s_nop 0
  v_cndmask_b32_e64 v152, v136, v152, s[36:37]
  v_cndmask_b32_e64 v153, v137, v153, s[38:39]
  v_cndmask_b32_e64 v154, v138, v154, s[40:41]
  v_cndmask_b32_e64 v155, v139, v155, s[42:43]
  v_cndmask_b32_e64 v156, v140, v156, s[44:45]
  v_cndmask_b32_e64 v157, v141, v157, s[46:47]
  v_cndmask_b32_e64 v158, v142, v158, s[48:49]
  v_cndmask_b32_e64 v159, v143, v159, s[50:51]
  v_cndmask_b32_e64 v160, v144, v160, s[52:53]
  v_cndmask_b32_e64 v161, v145, v161, s[54:55]
  v_cndmask_b32_e64 v162, v146, v162, s[56:57]
  v_cndmask_b32_e64 v163, v147, v163, s[58:59]
  v_cndmask_b32_e64 v164, v148, v164, s[60:61]
  v_cndmask_b32_e64 v165, v149, v165, s[62:63]
  v_cndmask_b32_e64 v166, v150, v166, s[64:65]
  v_cndmask_b32_e64 v167, v151, v167, s[66:67]
  v_mfma_f32_32x32x16_bf16 v[136:151], v[20:23], v[132:135], v[216:231]
  v_exp_f32_e32 v152, v152
  v_exp_f32_e32 v153, v153
  v_exp_f32_e32 v154, v154
  v_exp_f32_e32 v155, v155
  v_exp_f32_e32 v156, v156
  v_exp_f32_e32 v157, v157
  v_exp_f32_e32 v158, v158
  v_exp_f32_e32 v159, v159
  v_cvt_pk_bf16_f32 v184, v152, v153
  v_cvt_pk_bf16_f32 v185, v154, v155
  v_cvt_pk_bf16_f32 v186, v156, v157
  v_cvt_pk_bf16_f32 v187, v158, v159
  v_exp_f32_e32 v160, v160
  v_exp_f32_e32 v161, v161
  v_exp_f32_e32 v162, v162
  v_exp_f32_e32 v163, v163
  v_exp_f32_e32 v164, v164
  v_exp_f32_e32 v165, v165
  v_exp_f32_e32 v166, v166
  v_exp_f32_e32 v167, v167
  v_cvt_pk_bf16_f32 v188, v160, v161
  v_cvt_pk_bf16_f32 v189, v162, v163
  v_cvt_pk_bf16_f32 v190, v164, v165
  v_cvt_pk_bf16_f32 v191, v166, v167
  v_bfi_b32 v192, v232, 0, v184
  v_bfi_b32 v193, v233, 0, v185
  v_bfi_b32 v194, v234, 0, v186
  v_bfi_b32 v195, v235, 0, v187
  v_bfi_b32 v196, v236, 0, v188
  v_bfi_b32 v197, v237, 0, v189
  v_bfi_b32 v198, v238, 0, v190
  v_bfi_b32 v199, v239, 0, v191
  v_and_b32_e32 v184, v232, v184
  v_and_b32_e32 v185, v233, v185
  v_and_b32_e32 v186, v234, v186
  v_and_b32_e32 v187, v235, v187
  v_and_b32_e32 v188, v236, v188
  v_and_b32_e32 v189, v237, v189
  v_and_b32_e32 v190, v238, v190
  v_and_b32_e32 v191, v239, v191
  v_mfma_f32_32x32x16_bf16 v[200:215], v[56:59], v[192:195], 0
  v_mfma_f32_32x32x16_bf16 v[200:215], v[60:63], v[196:199], v[200:215]
s_waitcnt vmcnt(2)
s_nop 0
  v_mfma_f32_32x32x16_bf16 v[200:215], v[120:123], v[184:187], v[200:215]
s_waitcnt vmcnt(1)
s_nop 0
  v_mfma_f32_32x32x16_bf16 v[200:215], v[124:127], v[188:191], v[200:215]
  v_mfma_f32_32x32x16_bf16 v[152:167], v[24:27], v[132:135], v[216:231]
  v_exp_f32_e32 v168, v168
  v_exp_f32_e32 v169, v169
  v_exp_f32_e32 v170, v170
  v_exp_f32_e32 v171, v171
  v_exp_f32_e32 v172, v172
  v_exp_f32_e32 v173, v173
  v_exp_f32_e32 v174, v174
  v_exp_f32_e32 v175, v175
  v_cvt_pk_bf16_f32 v184, v168, v169
  v_cvt_pk_bf16_f32 v185, v170, v171
  v_cvt_pk_bf16_f32 v186, v172, v173
  v_cvt_pk_bf16_f32 v187, v174, v175
  v_exp_f32_e32 v176, v176
  v_exp_f32_e32 v177, v177
  v_exp_f32_e32 v178, v178
  v_exp_f32_e32 v179, v179
  v_exp_f32_e32 v180, v180
  v_exp_f32_e32 v181, v181
  v_exp_f32_e32 v182, v182
  v_exp_f32_e32 v183, v183
  v_cvt_pk_bf16_f32 v188, v176, v177
  v_cvt_pk_bf16_f32 v189, v178, v179
  v_cvt_pk_bf16_f32 v190, v180, v181
  v_cvt_pk_bf16_f32 v191, v182, v183
  v_mfma_f32_32x32x16_bf16 v[200:215], v[64:67], v[184:187], v[200:215]
s_nop 0
s_nop 0
  v_mfma_f32_32x32x16_bf16 v[200:215], v[68:71], v[188:191], v[200:215]
  v_mfma_f32_32x32x16_bf16 v[168:183], v[28:31], v[132:135], v[216:231]
  v_exp_f32_e32 v136, v136
  v_exp_f32_e32 v137, v137
  v_exp_f32_e32 v138, v138
  v_exp_f32_e32 v139, v139
  v_exp_f32_e32 v140, v140
  v_exp_f32_e32 v141, v141
  v_exp_f32_e32 v142, v142
  v_exp_f32_e32 v143, v143
  v_cvt_pk_bf16_f32 v192, v136, v137
  v_cvt_pk_bf16_f32 v193, v138, v139
  v_cvt_pk_bf16_f32 v194, v140, v141
  v_cvt_pk_bf16_f32 v195, v142, v143
  v_exp_f32_e32 v144, v144
  v_exp_f32_e32 v145, v145
  v_exp_f32_e32 v146, v146
  v_exp_f32_e32 v147, v147
  v_exp_f32_e32 v148, v148
  v_exp_f32_e32 v149, v149
  v_exp_f32_e32 v150, v150
  v_exp_f32_e32 v151, v151
  v_cvt_pk_bf16_f32 v196, v144, v145
  v_cvt_pk_bf16_f32 v197, v146, v147
  v_cvt_pk_bf16_f32 v198, v148, v149
  v_cvt_pk_bf16_f32 v199, v150, v151
  v_mfma_f32_32x32x16_bf16 v[200:215], v[72:75], v[192:195], v[200:215]
s_nop 0
s_nop 0
  v_mfma_f32_32x32x16_bf16 v[200:215], v[76:79], v[196:199], v[200:215]
  v_mfma_f32_32x32x16_bf16 v[136:151], v[32:35], v[132:135], v[216:231]
  v_exp_f32_e32 v152, v152
  v_exp_f32_e32 v153, v153
  v_exp_f32_e32 v154, v154
  v_exp_f32_e32 v155, v155
  v_exp_f32_e32 v156, v156
  v_exp_f32_e32 v157, v157
  v_exp_f32_e32 v158, v158
  v_exp_f32_e32 v159, v159
  v_cvt_pk_bf16_f32 v184, v152, v153
  v_cvt_pk_bf16_f32 v185, v154, v155
  v_cvt_pk_bf16_f32 v186, v156, v157
  v_cvt_pk_bf16_f32 v187, v158, v159
  v_exp_f32_e32 v160, v160
  v_exp_f32_e32 v161, v161
  v_exp_f32_e32 v162, v162
  v_exp_f32_e32 v163, v163
  v_exp_f32_e32 v164, v164
  v_exp_f32_e32 v165, v165
  v_exp_f32_e32 v166, v166
  v_exp_f32_e32 v167, v167
  v_cvt_pk_bf16_f32 v188, v160, v161
  v_cvt_pk_bf16_f32 v189, v162, v163
  v_cvt_pk_bf16_f32 v190, v164, v165
  v_cvt_pk_bf16_f32 v191, v166, v167
  v_mfma_f32_32x32x16_bf16 v[200:215], v[80:83], v[184:187], v[200:215]
s_nop 0
s_nop 0
  v_mfma_f32_32x32x16_bf16 v[200:215], v[84:87], v[188:191], v[200:215]
  v_mfma_f32_32x32x16_bf16 v[152:167], v[36:39], v[132:135], v[216:231]
  v_exp_f32_e32 v168, v168
  v_exp_f32_e32 v169, v169
  v_exp_f32_e32 v170, v170
  v_exp_f32_e32 v171, v171
  v_exp_f32_e32 v172, v172
  v_exp_f32_e32 v173, v173
  v_exp_f32_e32 v174, v174
  v_exp_f32_e32 v175, v175
  v_cvt_pk_bf16_f32 v192, v168, v169
  v_cvt_pk_bf16_f32 v193, v170, v171
  v_cvt_pk_bf16_f32 v194, v172, v173
  v_cvt_pk_bf16_f32 v195, v174, v175
  v_exp_f32_e32 v176, v176
  v_exp_f32_e32 v177, v177
  v_exp_f32_e32 v178, v178
  v_exp_f32_e32 v179, v179
  v_exp_f32_e32 v180, v180
  v_exp_f32_e32 v181, v181
  v_exp_f32_e32 v182, v182
  v_exp_f32_e32 v183, v183
  v_cvt_pk_bf16_f32 v196, v176, v177
  v_cvt_pk_bf16_f32 v197, v178, v179
  v_cvt_pk_bf16_f32 v198, v180, v181
  v_cvt_pk_bf16_f32 v199, v182, v183
  v_mfma_f32_32x32x16_bf16 v[200:215], v[88:91], v[192:195], v[200:215]
s_nop 0
s_nop 0
  v_mfma_f32_32x32x16_bf16 v[200:215], v[92:95], v[196:199], v[200:215]
  v_mfma_f32_32x32x16_bf16 v[168:183], v[40:43], v[132:135], v[216:231]
  v_exp_f32_e32 v136, v136
  v_exp_f32_e32 v137, v137
  v_exp_f32_e32 v138, v138
  v_exp_f32_e32 v139, v139
  v_exp_f32_e32 v140, v140
  v_exp_f32_e32 v141, v141
  v_exp_f32_e32 v142, v142
  v_exp_f32_e32 v143, v143
  v_cvt_pk_bf16_f32 v184, v136, v137
  v_cvt_pk_bf16_f32 v185, v138, v139
  v_cvt_pk_bf16_f32 v186, v140, v141
  v_cvt_pk_bf16_f32 v187, v142, v143
  v_exp_f32_e32 v144, v144
  v_exp_f32_e32 v145, v145
  v_exp_f32_e32 v146, v146
  v_exp_f32_e32 v147, v147
  v_exp_f32_e32 v148, v148
  v_exp_f32_e32 v149, v149
  v_exp_f32_e32 v150, v150
  v_exp_f32_e32 v151, v151
  v_cvt_pk_bf16_f32 v188, v144, v145
  v_cvt_pk_bf16_f32 v189, v146, v147
  v_cvt_pk_bf16_f32 v190, v148, v149
  v_cvt_pk_bf16_f32 v191, v150, v151
  v_mfma_f32_32x32x16_bf16 v[200:215], v[96:99], v[184:187], v[200:215]
s_nop 0
s_nop 0
  v_mfma_f32_32x32x16_bf16 v[200:215], v[100:103], v[188:191], v[200:215]
  v_exp_f32_e32 v152, v152
  v_exp_f32_e32 v153, v153
  v_exp_f32_e32 v154, v154
  v_exp_f32_e32 v155, v155
  v_exp_f32_e32 v156, v156
  v_exp_f32_e32 v157, v157
  v_exp_f32_e32 v158, v158
  v_exp_f32_e32 v159, v159
  v_cvt_pk_bf16_f32 v192, v152, v153
  v_cvt_pk_bf16_f32 v193, v154, v155
  v_cvt_pk_bf16_f32 v194, v156, v157
  v_cvt_pk_bf16_f32 v195, v158, v159
  v_exp_f32_e32 v160, v160
  v_exp_f32_e32 v161, v161
  v_exp_f32_e32 v162, v162
  v_exp_f32_e32 v163, v163
  v_exp_f32_e32 v164, v164
  v_exp_f32_e32 v165, v165
  v_exp_f32_e32 v166, v166
  v_exp_f32_e32 v167, v167
  v_cvt_pk_bf16_f32 v196, v160, v161
  v_cvt_pk_bf16_f32 v197, v162, v163
  v_cvt_pk_bf16_f32 v198, v164, v165
  v_cvt_pk_bf16_f32 v199, v166, v167
  v_mfma_f32_32x32x16_bf16 v[200:215], v[104:107], v[192:195], v[200:215]
s_nop 0
s_nop 0
  v_mfma_f32_32x32x16_bf16 v[200:215], v[108:111], v[196:199], v[200:215]
  v_exp_f32_e32 v168, v168
  v_exp_f32_e32 v169, v169
  v_exp_f32_e32 v170, v170
  v_exp_f32_e32 v171, v171
  v_exp_f32_e32 v172, v172
  v_exp_f32_e32 v173, v173
  v_exp_f32_e32 v174, v174
  v_exp_f32_e32 v175, v175
  v_cvt_pk_bf16_f32 v184, v168, v169
  v_cvt_pk_bf16_f32 v185, v170, v171
  v_cvt_pk_bf16_f32 v186, v172, v173
  v_cvt_pk_bf16_f32 v187, v174, v175
  v_exp_f32_e32 v176, v176
  v_exp_f32_e32 v177, v177
  v_exp_f32_e32 v178, v178
  v_exp_f32_e32 v179, v179
  v_exp_f32_e32 v180, v180
  v_exp_f32_e32 v181, v181
  v_exp_f32_e32 v182, v182
  v_exp_f32_e32 v183, v183
  v_cvt_pk_bf16_f32 v188, v176, v177
  v_cvt_pk_bf16_f32 v189, v178, v179
  v_cvt_pk_bf16_f32 v190, v180, v181
  v_cvt_pk_bf16_f32 v191, v182, v183
  v_mfma_f32_32x32x16_bf16 v[200:215], v[112:115], v[184:187], v[200:215]
s_nop 0
s_nop 0
  v_mfma_f32_32x32x16_bf16 v[200:215], v[116:119], v[188:191], v[200:215]
s_nop 11
  v_rcp_f32_e32 v240, v208
s_nop 0
  v_mul_f32_e32 v200, v200, v240
  v_mul_f32_e32 v201, v201, v240
  v_mul_f32_e32 v202, v202, v240
  v_mul_f32_e32 v203, v203, v240
  v_mul_f32_e32 v204, v204, v240
  v_mul_f32_e32 v205, v205, v240
  v_mul_f32_e32 v206, v206, v240
  v_mul_f32_e64 v207, v207, v240
  v_cvt_pk_bf16_f32 v200, v200, v201
  v_cvt_pk_bf16_f32 v201, v202, v203
  v_cvt_pk_bf16_f32 v202, v204, v205
  v_cvt_pk_bf16_f32 v203, v206, v207
  buffer_store_dwordx4 v[200:203], v1, s[8:11], s81 offen sc1
s_waitcnt vmcnt(0)
s_nop 0
K2_SIG:
  v_mov_b32_e32 v9, 0
  v_mov_b32_e32 v10, 1
  s_mov_b32 exec_lo, 1
  s_mov_b32 exec_hi, 0
  global_atomic_add v9, v10, s[88:89]
  s_mov_b64 exec, -1
K2_END:
  s_endpgm
CODE_END:
  s_endpgm
.section .rodata,"a"
.p2align 6
.amdhsa_kernel k1_kernel
  .amdhsa_next_free_vgpr 512
  .amdhsa_next_free_sgpr 102
  .amdhsa_accum_offset 256
  .amdhsa_group_segment_fixed_size 0
  .amdhsa_kernarg_size 80
  .amdhsa_user_sgpr_count 2
  .amdhsa_user_sgpr_kernarg_segment_ptr 1
  .amdhsa_system_sgpr_workgroup_id_x 1
.end_amdhsa_kernel
.p2align 6
.amdhsa_kernel k2_kernel
  .amdhsa_next_free_vgpr 256
  .amdhsa_next_free_sgpr 102
  .amdhsa_accum_offset 256
  .amdhsa_group_segment_fixed_size 0
  .amdhsa_kernarg_size 80
  .amdhsa_user_sgpr_count 2
  .amdhsa_user_sgpr_kernarg_segment_ptr 1
  .amdhsa_system_sgpr_workgroup_id_x 1
.end_amdhsa_kernel
```
